```python
import torch

def _softmax(x, axis=-1):
    return torch.softmax(x, dim=axis)
def _gelu(x):
    return torch.nn.functional.gelu(x, approximate="tanh")
def _silu(x):
    return torch.nn.functional.silu(x)
def _sigmoid(x):
    return torch.sigmoid(x)
def _layernorm(x, axis=-1, eps=1e-5):
    m = x.mean(dim=axis, keepdim=True)
    v = x.var(dim=axis, keepdim=True, unbiased=False)
    return (x - m) / torch.sqrt(v + eps)
def _scatter_add(tgt, idx, src, axis=0):
    return tgt.clone().index_add_(axis, idx, src)
def _segment_sum(src, seg, n):
    out = torch.zeros((n,) + src.shape[1:], dtype=src.dtype)
    return out.index_add_(0, seg, src)
def _pad(x, pw):
    flat = tuple(v for pair in reversed(pw) for v in pair)
    return torch.nn.functional.pad(x, flat)

kernel_name = 'interleave_layers__linear_attn_block__glu_gated_glu__prompt'

def setup_inputs():

    _w = (lambda a: (lambda t: t.to(torch.bfloat16) if t.is_floating_point() else t)(torch.as_tensor(a)))
    def _A_setup():
        B, S, D = 1, 2048, 448
        return {
            "x": _w((lambda *s: torch.randn(*s, dtype=torch.bfloat16) * 0.05)(B, S, D)),
            "wqkv": _w((lambda *s: torch.randn(*s, dtype=torch.bfloat16) * 0.1)(D, 3 * D)),
            "wo": _w((lambda *s: torch.randn(*s, dtype=torch.bfloat16) * 0.05)(D, D)),
        }
    _A_in = _A_setup()

    def _B_setup():
        B, S, D, F = 1, 2048, 448, 1792
        return {
            "x": _w((lambda *s: torch.randn(*s, dtype=torch.bfloat16) * 0.05)(B, S, D)),
            "w_gate": _w((lambda *s: torch.randn(*s, dtype=torch.bfloat16) * 0.05)(D, F)),
            "w_up": _w((lambda *s: torch.randn(*s, dtype=torch.bfloat16) * 0.05)(D, F)),
            "w_down": _w((lambda *s: torch.randn(*s, dtype=torch.bfloat16) * 0.05)(F, D)),
        }
    _B_in = _B_setup()

    return {
        "A_x": _A_in["x"],
        "A_wqkv": _A_in["wqkv"],
        "A_wo": _A_in["wo"],
        "B_x": _B_in["x"],
        "B_w_gate": _B_in["w_gate"],
        "B_w_up": _B_in["w_up"],
        "B_w_down": _B_in["w_down"],
    }

def reference(A_x, A_wqkv, A_wo, B_x, B_w_gate, B_w_up, B_w_down):
    def _A_ref(x, wqkv, wo):
        B, S, D = x.shape
        H = 16; Dh = D // H
        qkv = (lambda x, *d: x.permute(*d))((x @ wqkv).reshape(B, S, 3, H, Dh), 2, 0, 3, 1, 4)
        q, k, v = qkv[0], qkv[1], qkv[2]
        phi = lambda t: torch.where(t > 0, t + 1, torch.exp(t)) + 1e-6
        pq, pk = phi(q), phi(k)
        kv = torch.einsum("bhsd,bhse->bhde", pk, v)
        z = torch.einsum("bhsd->bhd", pk)
        num = torch.einsum("bhqd,bhde->bhqe", pq, kv)
        den = torch.einsum("bhqd,bhd->bhq", pq, z)[..., None] + 1e-6
        o = num / den
        return (lambda x, *d: x.permute(*d))(o, 0, 2, 1, 3).reshape(B, S, D) @ wo

    def _B_ref(x, w_gate, w_up, w_down):
        g = torch.einsum("bsd,df->bsf", x, w_gate)
        u = torch.einsum("bsd,df->bsf", x, w_up)
        h = _sigmoid(g) * u
        return torch.einsum("bsf,fd->bsd", h, w_down)

    x = A_x
    x = x + _A_ref(_layernorm(x, axis=-1), A_wqkv, A_wo)
    x = x + _B_ref(_layernorm(x, axis=-1), B_w_gate, B_w_up, B_w_down)
    x = x + _A_ref(_layernorm(x, axis=-1), A_wqkv, A_wo)
    x = x + _B_ref(_layernorm(x, axis=-1), B_w_gate, B_w_up, B_w_down)
    return x
```

```asm
; @launch grid=(256,1,1) block=(256,1,1) lds=163840
.amdgcn_target "amdgcn-amd-amdhsa--gfx950"
.text
.globl interleave_layers__linear_attn_block__glu_gated_glu__prompt_kernel
.p2align 8
.type interleave_layers__linear_attn_block__glu_gated_glu__prompt_kernel,@function
interleave_layers__linear_attn_block__glu_gated_glu__prompt_kernel:
  s_cmp_ge_u32 s2, 256
  s_cbranch_scc1 L_end
  s_load_dwordx2 s[12:13], s[0:1], 8
  s_load_dwordx2 s[20:21], s[0:1], 32
  s_load_dwordx2 s[24:25], s[0:1], 40
  s_load_dwordx2 s[28:29], s[0:1], 48
  s_load_dwordx2 s[16:17], s[0:1], 16
  s_load_dwordx2 s[8:9], s[0:1], 0
  s_load_dwordx2 s[4:5], s[0:1], 72
  s_getpc_b64 s[100:101]
L_pc:
  s_lshr_b32 s3, s2, 3
  s_lshl_b32 s3, s3, 11
  s_min_u32 s3, s3, (L_codeend - L_pc - 2048)
  s_add_u32 s100, s100, s3
  s_addc_u32 s101, s101, 0
  v_min_u32 v16, 15, v0
  v_lshlrev_b32 v16, 7, v16
  global_load_dword v17, v16, s[100:101]
  v_lshrrev_b32 v18, 6, v0
  v_and_b32 v0, 63, v0
  v_readfirstlane_b32 s48, v18
  v_lshlrev_b32 v1, 4, v0
  v_lshrrev_b32_e64 v207, 3, v0
  v_and_b32 v212, 0x70, v1
  s_mov_b32 s14, 1204224
  s_mov_b32 s15, 0x00020000
  s_mov_b32 s22, 1605632
  s_mov_b32 s23, 0x00020000
  s_mov_b32 s26, 1605632
  s_mov_b32 s27, 0x00020000
  s_mov_b32 s30, 1605632
  s_mov_b32 s31, 0x00020000
  s_mov_b32 s18, 401408
  s_mov_b32 s19, 0x00020000
  s_mov_b32 s10, 1835008
  s_mov_b32 s11, 0x00020000
  s_mov_b32 s6, 268435456
  s_mov_b32 s7, 0x00020000
  s_lshl_b32 s73, s48, 13
  s_add_u32 s73, s73, 4096
  s_lshl_b32 s86, s48, 3
  s_add_u32 s96, s86, s2
  s_cmp_lt_u32 s96, 8
  s_cbranch_scc1 Lc_1
Lr_2:
  s_cmp_ge_u32 s2, 168
  s_cbranch_scc1 L_r0bs
  s_mul_i32 s86, s2, 9363
  s_lshr_b32 s86, s86, 16
  s_mul_i32 s87, s86, 7
  s_sub_u32 s87, s2, s87
  s_lshr_b32 s88, s86, 3
  s_and_b32 s86, s86, 7
  s_mul_i32 s89, s88, 896
  s_mul_i32 s90, s86, 112
  s_add_u32 s89, s89, s90
  s_lshl_b32 s91, s87, 2
  s_add_u32 s91, s91, s48
  s_mul_i32 s90, s91, 43008
  s_add_u32 s89, s89, s90
  s_add_u32 s90, s89, 21504
  v_mul_u32_u24 v208, 2688, v207
  v_add_u32 v208, v208, v212
  v_cmp_eq_u32 vcc, 112, v212
  v_mov_b32 v209, 0x40000000
  s_nop 0
  v_cndmask_b32 v208, v208, v209, vcc
  s_waitcnt lgkmcnt(0)
  s_add_u32 m0, s73, 0
  s_nop 0
  buffer_load_dwordx4 v208, s[12:15], s89 offen  lds
  s_add_u32 m0, s73, 1024
  s_nop 0
  buffer_load_dwordx4 v208, s[12:15], s90 offen  lds
  s_branch L_r0es
L_r0bs:
  s_cmp_ge_u32 s2, 224
  s_cbranch_scc1 L_r0cs
  s_sub_u32 s94, s2, 168
  s_mul_i32 s86, s94, 9363
  s_lshr_b32 s86, s86, 16
  s_mul_i32 s87, s86, 7
  s_sub_u32 s87, s94, s87
  s_lshl_b32 s86, s86, 2
  s_add_u32 s86, s86, s48
  s_lshr_b32 s88, s86, 1
  s_mul_i32 s88, s88, 25088
  s_lshl_b32 s89, s87, 7
  s_add_u32 s88, s88, s89
  s_and_b32 s89, s86, 1
  s_cselect_b32 s89, 14336, 0
  s_cselect_b32 s90, 12544, 0
  s_add_u32 s89, s89, s88
  s_add_u32 s90, s90, s88
  s_add_u32 s90, s90, 7168
  v_mul_u32_u24 v208, 896, v207
  v_add_u32 v208, v208, v212
  s_waitcnt lgkmcnt(0)
  s_add_u32 m0, s73, 0
  s_nop 0
  buffer_load_dwordx4 v208, s[16:19], s89 offen  lds
  s_add_u32 m0, s73, 1024
  s_nop 0
  buffer_load_dwordx4 v208, s[16:19], s90 offen  lds
  s_branch L_r0es
L_r0cs:
  s_sub_u32 s94, s2, 224
  s_mul_i32 s86, s94, 9363
  s_lshr_b32 s86, s86, 16
  s_mul_i32 s87, s86, 7
  s_sub_u32 s87, s94, s87
  s_lshl_b32 s86, s86, 2
  s_add_u32 s86, s86, s48
  s_mul_i32 s88, s86, 14336
  s_lshl_b32 s89, s87, 7
  s_add_u32 s88, s88, s89
  s_add_u32 s89, s88, 7168
  v_mul_u32_u24 v208, 896, v207
  v_add_u32_e64 v208, v208, v212
  s_waitcnt lgkmcnt(0)
  s_add_u32 m0, s73, 0
  s_nop 0
  buffer_load_dwordx4 v208, s[28:31], s88 offen  lds
  s_add_u32 m0, s73, 1024
  s_nop 0
  buffer_load_dwordx4 v208, s[28:31], s89 offen  lds
L_r0es:
  s_mul_i32 s86, s2, 9363
  s_lshr_b32 s86, s86, 16
  s_mul_i32 s87, s86, 7
  s_sub_u32 s87, s2, s87
  s_cmp_ge_u32 s86, 28
  s_cselect_b32 s40, s24, s20
  s_cselect_b32 s41, s25, s21
  s_cselect_b32 s88, 28, 0
  s_cselect_b32 s89, 16, 0
  s_mov_b32 s42, 1605632
  s_mov_b32 s43, 0x00020000
  s_sub_u32 s86, s86, s88
  s_lshl_b32 s90, s87, 2
  s_add_u32 s90, s90, s48
  s_mul_i32 s88, s90, 57344
  s_lshl_b32 s91, s86, 7
  s_add_u32 s88, s88, s91
  s_add_u32 s91, s88, 28672
  v_mul_u32_u24 v208, 3584, v207
  v_add_u32_e64 v208, v208, v212
  s_add_u32 m0, s73, 2048
  s_nop 0
  buffer_load_dwordx4 v208, s[40:43], s88 offen  lds
  s_add_u32 m0, s73, 3072
  s_nop 0
  buffer_load_dwordx4 v208, s[40:43], s91 offen  lds
  s_cmp_ge_u32 s2, 136
  s_cbranch_scc1 L_r2bs
  s_add_u32 s94, s2, 256
  s_mul_i32 s86, s94, 9363
  s_lshr_b32 s86, s86, 16
  s_mul_i32 s87, s86, 7
  s_sub_u32 s87, s94, s87
  s_cmp_ge_u32 s86, 28
  s_cselect_b32 s44, s24, s20
  s_cselect_b32 s45, s25, s21
  s_cselect_b32 s88, 28, 0
  s_cselect_b32 s89, 16, 0
  s_mov_b32 s46, 1605632
  s_mov_b32 s47, 0x00020000
  s_sub_u32 s86, s86, s88
  s_lshl_b32 s90, s87, 2
  s_add_u32 s90, s90, s48
  s_mul_i32 s88, s90, 57344
  s_lshl_b32 s91, s86, 7
  s_add_u32 s88, s88, s91
  s_add_u32 s91, s88, 28672
  v_mul_u32_u24 v208, 3584, v207
  v_add_u32_e64 v208, v208, v212
  s_add_u32 m0, s73, 4096
  s_nop 0
  buffer_load_dwordx4 v208, s[44:47], s88 offen  lds
  s_add_u32 m0, s73, 5120
  s_nop 0
  buffer_load_dwordx4 v208, s[44:47], s91 offen  lds
  s_branch L_r2es
L_r2bs:
  s_sub_u32 s94, s2, 104
  s_mul_i32 s86, s94, 9363
  s_lshr_b32 s86, s86, 16
  s_mul_i32 s87, s86, 7
  s_sub_u32 s87, s94, s87
  s_lshl_b32 s86, s86, 2
  s_add_u32 s86, s86, s48
  s_mul_i32 s88, s86, 14336
  s_lshl_b32 s89, s87, 7
  s_add_u32 s88, s88, s89
  s_add_u32 s89, s88, 7168
  v_mul_u32_u24 v208, 896, v207
  v_add_u32_e64 v208, v208, v212
  s_add_u32 m0, s73, 4096
  s_nop 0
  buffer_load_dwordx4 v208, s[28:31], s88 offen  lds
  s_add_u32 m0, s73, 5120
  s_nop 0
  buffer_load_dwordx4 v208, s[28:31], s89 offen  lds
L_r2es:
  s_cmp_ge_u32 s2, 212
  s_cbranch_scc1 L_r3bs
  s_branch L_r3es
L_r3bs:
  s_sub_u32 s94, s2, 60
  s_mul_i32 s86, s94, 9363
  s_lshr_b32 s86, s86, 16
  s_mul_i32 s87, s86, 7
  s_sub_u32 s87, s94, s87
  s_lshl_b32 s86, s86, 2
  s_add_u32 s86, s86, s48
  s_mul_i32 s88, s86, 14336
  s_lshl_b32 s89, s87, 7
  s_add_u32 s88, s88, s89
  s_add_u32 s89, s88, 7168
  v_mul_u32_u24 v208, 896, v207
  v_add_u32_e64 v208, v208, v212
  s_add_u32 m0, s73, 6144
  s_nop 0
  buffer_load_dwordx4 v208, s[28:31], s88 offen  lds
  s_add_u32 m0, s73, 7168
  s_nop 0
  buffer_load_dwordx4 v208, s[28:31], s89 offen  lds
L_r3es:
  v_mov_b32 v216, 0
  v_mov_b32 v217, 0
  v_mov_b32 v218, 0
  v_mov_b32 v219, 0
  s_load_dwordx2 s[36:37], s[0:1], 64
  s_mov_b32 s38, 256
  s_mov_b32 s39, 0x00020000
  s_load_dwordx2 s[32:33], s[0:1], 56
  s_mov_b32 s34, 1835008
  s_mov_b32 s35, 0x00020000
  v_add_u32 v2, 0x10000, v1
  v_add_u32 v3, 0x20000, v1
  v_lshlrev_b32 v6, 2, v0
  v_and_b32 v18, 31, v0
  v_lshrrev_b32_e64 v19, 5, v0
  v_mul_u32_u24 v4, 896, v18
  v_lshl_add_u32 v4, v19, 4, v4
  v_lshlrev_b32_e64 v5, 2, v18
  v_lshl_add_u32 v5, v19, 9, v5
  s_and_b32 s88, s2, 7
  s_lshr_b32 s49, s2, 3
  s_mul_i32 s51, s49, 37
  s_lshr_b32 s51, s51, 8
  s_mul_i32 s52, s51, 7
  s_sub_u32 s52, s49, s52
  s_cmp_ge_u32 s49, 28
  s_cselect_b32 s51, s52, s51
  s_mov_b32 s53, 0
  s_mov_b32 s54, 100000
  s_lshl_b32 s57, s88, 3
  s_lshl_b32 s89, s51, 1
  s_add_u32 s57, s57, s89
  s_lshr_b32 s89, s48, 1
  s_add_u32 s58, s57, s89
  s_and_b32 s89, s48, 1
  s_lshl_b32 s59, s52, 1
  s_add_u32 s59, s59, s89
  s_and_b32 s89, s88, 0
  s_mul_i32 s50, s89, 16
  s_and_b32 s89, s49, 15
  s_add_u32 s50, s50, s89
  s_lshr_b32 s89, s88, 0
  s_lshl_b32 s90, s89, 1
  s_lshr_b32 s89, s49, 4
  s_add_u32 s90, s90, s89
  s_lshl_b32 s56, s90, 2
  s_add_u32 s56, s56, s48
  s_mov_b32 s60, 0x3f317218
  s_mov_b32 s61, 0x3f317218
  s_mov_b32 s62, 0x358637bd
  s_mov_b32 s63, 0x358637bd
  s_mov_b32 s84, 0x3f803f80
  v_and_b32 v204, 31, v0
  v_lshrrev_b32 v205, 5, v0
  v_and_b32 v206, 0x13, v204
  v_and_b32_e64 v208, 4, v204
  v_lshl_or_b32 v206, v208, 1, v206
  v_lshrrev_b32_e64 v208, 1, v204
  v_and_or_b32 v206, v208, 4, v206
  v_lshrrev_b32 v208, 4, v0
  v_lshlrev_b32 v208, 4, v208
  v_xor_b32_e64 v208, v208, v212
  v_mul_u32_u24 v209, 896, v207
  v_add_u32 v214, v209, v208
  v_xor_b32 v208, 64, v208
  v_add_u32 v215, v209, v208
  s_mov_b32 s71, s90
  s_and_b32 s72, s2, 3
  s_lshl_b32 s72, s72, 12
  s_lshl_b32 s64, s48, 10
  s_lshl_b32 s65, s48, 11
  s_lshl_b32 s66, s48, 12
  s_lshl_b32 s86, s48, 9
  s_add_u32 s100, s100, s86
  s_addc_u32 s101, s101, 0
  s_getreg_b32 s95, hwreg(HW_REG_XCC_ID)
  s_and_b32 s95, s95, 15
  s_add_u32 s95, s95, 1
  s_waitcnt lgkmcnt(0)
  s_mul_i32 s75, s56, 28672
  s_mul_i32 s74, s48, 28672
  s_add_u32 s74, s74, 40960
  s_mul_i32 s86, s50, 1792
  s_add_u32 s86, s86, s75
  v_min_u32 v208, 13, v0
  v_lshlrev_b32_e64 v208, 7, v208
  buffer_load_dword v17, v208, s[8:11], s86 offen
  s_cmp_ge_u32 s96, 8
  s_cbranch_scc1 L_z2
  s_waitcnt vmcnt(7)
  s_lshl_b32 s86, s2, 5
  v_mov_b32 v254, 1
  s_mov_b64 exec, 1
  buffer_store_dword v254, off, s[36:39], s86 offset:0 sc1
  s_mov_b64 exec, -1
L_z2:
  s_cmp_ge_u32 s2, 168
  s_cbranch_scc1 L_r0bd
  s_mul_i32 s86, s2, 9363
  s_lshr_b32 s86, s86, 16
  s_mul_i32 s87, s86, 7
  s_sub_u32 s87, s2, s87
  s_lshr_b32 s88, s86, 3
  s_and_b32 s86, s86, 7
  s_mul_i32 s89, s88, 896
  s_mul_i32 s90, s86, 112
  s_add_u32 s89, s89, s90
  s_lshl_b32 s91, s87, 2
  s_add_u32 s91, s91, s48
  s_mul_i32 s90, s91, 43008
  s_add_u32 s89, s89, s90
  s_add_u32 s90, s89, 21504
  v_mul_u32_u24 v208, 2688, v207
  v_add_u32 v208, v208, v212
  v_cmp_eq_u32 vcc, 112, v212
  v_mov_b32_e64 v209, 0x40000000
  s_nop 0
  v_cndmask_b32 v208, v208, v209, vcc
  v_cmp_le_u32 vcc, 24, v206
  v_subrev_u32 v208, 2, v206
  s_nop 0
  v_cndmask_b32 v208, v206, v208, vcc
  v_mad_u32_u24 v208, v205, 28, v208
  v_and_b32_e64 v209, 0x16, v206
  v_cmp_eq_u32 vcc, 0x16, v209
  s_nop 1
  v_cndmask_b32 v208, v208, 56, vcc
  v_lshl_add_u32 v192, v208, 1, s73
  s_sub_u32 s90, s88, 1
  s_cmp_eq_u32 s88, 0
  s_cselect_b32 s90, 2, s90
  s_mul_i32 s89, s91, 3
  s_add_u32 s89, s89, s90
  s_add_u32 s90, s90, 84
  s_mul_i32 s86, s86, 178176
  s_add_u32 s86, s86, 1048576
  s_lshl_b32 s89, s89, 10
  s_add_u32 s89, s89, s86
  s_lshl_b32 s90, s90, 10
  s_add_u32 s90, s90, s86
  s_lshl_b32 s87, s87, 7
  s_add_u32 s90, s90, s87
  v_mul_u32_u24 v208, 89088, v205
  v_lshl_add_u32 v193, v204, 4, v208
  v_add_u32 v193, s89, v193
  v_lshl_add_u32 v194, v204, 2, v208
  v_add_u32 v194, s90, v194
  s_branch L_r0ed
L_r0bd:
  s_cmp_ge_u32 s2, 224
  s_cbranch_scc1 L_r0cd
  s_sub_u32 s94, s2, 168
  s_mul_i32 s86, s94, 9363
  s_lshr_b32 s86, s86, 16
  s_mul_i32 s87, s86, 7
  s_sub_u32 s87, s94, s87
  s_lshl_b32 s86, s86, 2
  s_add_u32 s86, s86, s48
  s_lshr_b32 s88, s86, 1
  s_mul_i32 s88, s88, 25088
  s_lshl_b32 s89, s87, 7
  s_add_u32 s88, s88, s89
  s_and_b32 s89, s86, 1
  s_cselect_b32 s89, 14336, 0
  s_cselect_b32 s90, 12544, 0
  s_add_u32 s89, s89, s88
  s_add_u32 s90, s90, s88
  s_add_u32 s90, s90, 7168
  v_mul_u32_u24 v208, 896, v207
  v_add_u32_e64 v208, v208, v212
  v_lshl_add_u32 v208, v205, 5, v206
  v_lshl_add_u32 v192, v208, 1, s73
  v_lshlrev_b32_e64 v193, 10, v205
  v_lshl_add_u32 v193, v204, 4, v193
  v_mov_b32 v194, 0x40000000
  s_lshl_b32 s87, s87, 16
  s_lshl_b32 s88, s86, 11
  s_add_u32 s87, s87, s88
  s_add_u32 s87, s87, 2621440
  v_add_u32 v193, s87, v193
  s_branch L_r0ed
L_r0cd:
  s_sub_u32 s94, s2, 224
  s_mul_i32 s86, s94, 9363
  s_lshr_b32 s86, s86, 16
  s_mul_i32 s87, s86, 7
  s_sub_u32 s87, s94, s87
  s_lshl_b32 s86, s86, 2
  s_add_u32 s86, s86, s48
  s_mul_i32 s88, s86, 14336
  s_lshl_b32 s89, s87, 7
  s_add_u32 s88, s88, s89
  s_add_u32 s89, s88, 7168
  v_mul_u32_u24 v208, 896, v207
  v_add_u32 v208, v208, v212
  v_lshl_add_u32 v208, v205, 5, v206
  v_lshl_add_u32 v192, v208, 1, s73
  v_lshlrev_b32_e64 v193, 10, v205
  v_lshl_add_u32 v193, v204, 4, v193
  v_mov_b32_e64 v194, 0x40000000
  s_mul_i32 s88, s86, 9363
  s_lshr_b32 s88, s88, 16
  s_mul_i32 s89, s88, 7
  s_sub_u32 s89, s86, s89
  s_mul_i32 s87, s87, 229376
  s_lshr_b32 s90, s88, 2
  s_mul_i32 s90, s90, 57344
  s_add_u32 s87, s87, s90
  s_lshl_b32 s89, s89, 2
  s_and_b32 s88, s88, 3
  s_add_u32 s89, s89, s88
  s_lshl_b32 s89, s89, 11
  s_add_u32 s87, s87, s89
  s_add_u32 s87, s87, 6815744
  v_add_u32_e64 v193, s87, v193
L_r0ed:
  s_mul_i32 s86, s2, 9363
  s_lshr_b32 s86, s86, 16
  s_mul_i32 s87, s86, 7
  s_sub_u32 s87, s2, s87
  s_cmp_ge_u32 s86, 28
  s_cselect_b32 s40, s24, s20
  s_cselect_b32 s41, s25, s21
  s_cselect_b32 s88, 28, 0
  s_cselect_b32 s89, 16, 0
  s_mov_b32 s42, 1605632
  s_mov_b32 s43, 0x00020000
  s_sub_u32 s86, s86, s88
  s_lshl_b32 s90, s87, 2
  s_add_u32 s90, s90, s48
  s_mul_i32 s88, s90, 57344
  s_lshl_b32 s91, s86, 7
  s_add_u32 s88, s88, s91
  s_add_u32 s91, s88, 28672
  v_mul_u32_u24 v208, 3584, v207
  v_add_u32 v208, v208, v212
  v_and_b32_e64 v208, 48, v0
  v_and_or_b32 v208, v206, 15, v208
  v_lshl_add_u32 v195, v208, 1, s73
  v_lshrrev_b32 v208, 4, v0
  s_lshl_b32 s88, s86, 2
  v_add_u32_e64 v208, s88, v208
  v_mul_u32_u24 v209, 9363, v208
  v_lshrrev_b32 v209, 16, v209
  v_mul_u32_u24 v210, 7, v209
  v_sub_u32 v208, v208, v210
  s_mul_i32 s91, s90, 3
  v_add_u32_e64 v210, s91, v208
  v_add_u32 v197, 84, v208
  s_cmp_ge_u32 s90, 27
  s_cselect_b32 s88, 58, 0
  s_sub_u32 s88, s90, s88
  s_add_u32 s88, s88, 176
  v_cmp_eq_u32 vcc, 3, v208
  s_add_u32 s91, s90, 87
  v_mov_b32 v211, s91
  v_cndmask_b32 v210, v210, v211, vcc
  v_mov_b32 v211, 115
  v_cndmask_b32 v197, v197, v211, vcc
  v_cmp_eq_u32 vcc, 4, v208
  s_add_u32 s91, s90, 116
  v_mov_b32 v211, s91
  v_cndmask_b32 v210, v210, v211, vcc
  v_mov_b32 v211, 144
  v_cndmask_b32 v197, v197, v211, vcc
  v_cmp_eq_u32 vcc, 5, v208
  s_add_u32 s91, s90, 147
  v_mov_b32 v211, s91
  v_cndmask_b32 v210, v210, v211, vcc
  v_mov_b32 v211, 175
  v_cndmask_b32 v197, v197, v211, vcc
  v_cmp_eq_u32 vcc, 6, v208
  v_mov_b32_e64 v211, s88
  s_nop 0
  v_cndmask_b32 v210, v210, v211, vcc
  v_mov_b32 v211, 146
  v_cndmask_b32 v197, v197, v211, vcc
  v_mul_u32_u24 v209, 203, v209
  v_add_lshl_u32 v210, v210, v209, 10
  v_add_lshl_u32 v197, v197, v209, 10
  v_and_b32 v208, 15, v0
  v_add_u32_e64 v208, s89, v208
  v_lshl_add_u32 v196, v208, 4, v210
  v_add_u32 v196, 0x300000, v196
  v_lshl_add_u32 v197, v208, 2, v197
  s_lshl_b32 s87, s87, 7
  s_add_u32 s87, s87, 3145728
  v_add_u32 v197, s87, v197
  s_cmp_ge_u32 s2, 136
  s_cbranch_scc1 L_r2bd
  s_add_u32 s94, s2, 256
  s_mul_i32 s86, s94, 9363
  s_lshr_b32 s86, s86, 16
  s_mul_i32 s87, s86, 7
  s_sub_u32 s87, s94, s87
  s_cmp_ge_u32 s86, 28
  s_cselect_b32 s44, s24, s20
  s_cselect_b32 s45, s25, s21
  s_cselect_b32 s88, 28, 0
  s_cselect_b32 s89, 16, 0
  s_mov_b32 s46, 1605632
  s_mov_b32 s47, 0x00020000
  s_sub_u32 s86, s86, s88
  s_lshl_b32 s90, s87, 2
  s_add_u32 s90, s90, s48
  s_mul_i32 s88, s90, 57344
  s_lshl_b32 s91, s86, 7
  s_add_u32 s88, s88, s91
  s_add_u32 s91, s88, 28672
  v_mul_u32_u24 v208, 3584, v207
  v_add_u32 v208, v208, v212
  v_and_b32 v208, 48, v0
  v_and_or_b32 v208, v206, 15, v208
  v_lshl_add_u32 v198, v208, 1, s73
  v_lshrrev_b32 v208, 4, v0
  s_lshl_b32 s88, s86, 2
  v_add_u32_e64 v208, s88, v208
  v_mul_u32_u24 v209, 9363, v208
  v_lshrrev_b32 v209, 16, v209
  v_mul_u32_u24 v210, 7, v209
  v_sub_u32 v208, v208, v210
  s_mul_i32 s91, s90, 3
  v_add_u32_e64 v210, s91, v208
  v_add_u32 v200, 84, v208
  s_cmp_ge_u32 s90, 27
  s_cselect_b32 s88, 58, 0
  s_sub_u32 s88, s90, s88
  s_add_u32 s88, s88, 176
  v_cmp_eq_u32 vcc, 3, v208
  s_add_u32 s91, s90, 87
  v_mov_b32 v211, s91
  v_cndmask_b32 v210, v210, v211, vcc
  v_mov_b32 v211, 115
  v_cndmask_b32 v200, v200, v211, vcc
  v_cmp_eq_u32 vcc, 4, v208
  s_add_u32 s91, s90, 116
  v_mov_b32 v211, s91
  v_cndmask_b32 v210, v210, v211, vcc
  v_mov_b32 v211, 144
  v_cndmask_b32 v200, v200, v211, vcc
  v_cmp_eq_u32 vcc, 5, v208
  s_add_u32 s91, s90, 147
  v_mov_b32 v211, s91
  v_cndmask_b32 v210, v210, v211, vcc
  v_mov_b32 v211, 175
  v_cndmask_b32 v200, v200, v211, vcc
  v_cmp_eq_u32 vcc, 6, v208
  v_mov_b32_e64 v211, s88
  s_nop 0
  v_cndmask_b32 v210, v210, v211, vcc
  v_mov_b32 v211, 146
  v_cndmask_b32 v200, v200, v211, vcc
  v_mul_u32_u24 v209, 203, v209
  v_add_lshl_u32 v210, v210, v209, 10
  v_add_lshl_u32 v200, v200, v209, 10
  v_and_b32 v208, 15, v0
  v_add_u32_e64 v208, s89, v208
  v_lshl_add_u32 v199, v208, 4, v210
  v_add_u32 v199, 0x300000, v199
  v_lshl_add_u32 v200, v208, 2, v200
  s_lshl_b32 s87, s87, 7
  s_add_u32 s87, s87, 3145728
  v_add_u32_e64 v200, s87, v200
  s_branch L_r2ed
L_r2bd:
  s_sub_u32 s94, s2, 104
  s_mul_i32 s86, s94, 9363
  s_lshr_b32 s86, s86, 16
  s_mul_i32 s87, s86, 7
  s_sub_u32 s87, s94, s87
  s_lshl_b32 s86, s86, 2
  s_add_u32 s86, s86, s48
  s_mul_i32 s88, s86, 14336
  s_lshl_b32 s89, s87, 7
  s_add_u32 s88, s88, s89
  s_add_u32 s89, s88, 7168
  v_mul_u32_u24 v208, 896, v207
  v_add_u32 v208, v208, v212
  v_lshl_add_u32 v208, v205, 5, v206
  v_lshl_add_u32 v198, v208, 1, s73
  v_lshlrev_b32_e64 v199, 10, v205
  v_lshl_add_u32 v199, v204, 4, v199
  v_mov_b32_e64 v200, 0x40000000
  s_mul_i32 s88, s86, 9363
  s_lshr_b32 s88, s88, 16
  s_mul_i32 s89, s88, 7
  s_sub_u32 s89, s86, s89
  s_mul_i32 s87, s87, 229376
  s_lshr_b32 s90, s88, 2
  s_mul_i32 s90, s90, 57344
  s_add_u32 s87, s87, s90
  s_lshl_b32 s89, s89, 2
  s_and_b32 s88, s88, 3
  s_add_u32 s89, s89, s88
  s_lshl_b32 s89, s89, 11
  s_add_u32 s87, s87, s89
  s_add_u32 s87, s87, 6815744
  v_add_u32_e64 v199, s87, v199
L_r2ed:
  s_cmp_ge_u32 s2, 212
  s_cbranch_scc1 L_r3bd
  v_mov_b32 v201, 0
  v_mov_b32 v202, 0x40000000
  v_mov_b32 v203, 0x40000000
  s_branch L_r3ed
L_r3bd:
  s_sub_u32 s94, s2, 60
  s_mul_i32 s86, s94, 9363
  s_lshr_b32 s86, s86, 16
  s_mul_i32 s87, s86, 7
  s_sub_u32 s87, s94, s87
  s_lshl_b32 s86, s86, 2
  s_add_u32 s86, s86, s48
  s_mul_i32 s88, s86, 14336
  s_lshl_b32 s89, s87, 7
  s_add_u32 s88, s88, s89
  s_add_u32 s89, s88, 7168
  v_mul_u32_u24 v208, 896, v207
  v_add_u32 v208, v208, v212
  v_lshl_add_u32 v208, v205, 5, v206
  v_lshl_add_u32 v201, v208, 1, s73
  v_lshlrev_b32_e64 v202, 10, v205
  v_lshl_add_u32 v202, v204, 4, v202
  v_mov_b32_e64 v203, 0x40000000
  s_mul_i32 s88, s86, 9363
  s_lshr_b32 s88, s88, 16
  s_mul_i32 s89, s88, 7
  s_sub_u32 s89, s86, s89
  s_mul_i32 s87, s87, 229376
  s_lshr_b32 s90, s88, 2
  s_mul_i32 s90, s90, 57344
  s_add_u32 s87, s87, s90
  s_lshl_b32 s89, s89, 2
  s_and_b32 s88, s88, 3
  s_add_u32 s89, s89, s88
  s_lshl_b32 s89, s89, 11
  s_add_u32 s87, s87, s89
  s_add_u32 s87, s87, 6815744
  v_add_u32 v202, s87, v202
L_r3ed:
  s_lshl_b32 s86, s48, 8
  v_add_u32 v209, s86, v6
  v_and_b32 v211, 7, v0
  v_lshlrev_b32_e64 v211, 5, v211
  s_lshl_b32 s86, s2, 10
  s_add_u32 s87, s48, 1
  s_lshl_b32 s87, s87, 24
  s_add_u32 s86, s86, s87
  s_sub_u32 s87, s86, 33292288
  s_cmp_eq_u32 s48, 2
  s_cselect_b32 s86, s87, s86
  s_cmp_ge_u32 s48, 3
  s_cselect_b32 s86, 0x40000000, s86
  s_waitcnt vmcnt(1)
  buffer_store_dwordx4 v[216:219], v1, s[4:7], s86 offen sc1
  ds_read_u16 v128, v192 offset:0
  ds_read_u16 v129, v192 offset:128
  ds_read_u16 v130, v192 offset:256
  ds_read_u16 v131, v192 offset:384
  ds_read_u16 v132, v192 offset:512
  ds_read_u16 v133, v192 offset:640
  ds_read_u16 v134, v192 offset:768
  ds_read_u16 v135, v192 offset:896
  ds_read_u16 v136, v192 offset:1024
  ds_read_u16 v137, v192 offset:1152
  ds_read_u16 v138, v192 offset:1280
  ds_read_u16 v139, v192 offset:1408
  ds_read_u16 v140, v192 offset:1536
  ds_read_u16 v141, v192 offset:1664
  ds_read_u16 v142, v192 offset:1792
  ds_read_u16 v143, v192 offset:1920
  s_waitcnt lgkmcnt(8)
  v_lshl_or_b32 v128, v129, 16, v128
  v_lshl_or_b32 v129, v131, 16, v130
  v_lshl_or_b32 v130, v133, 16, v132
  v_lshl_or_b32 v131, v135, 16, v134
  buffer_store_dwordx4 v[128:131], v193, s[4:7], 0 offen offset:0 sc1
  ds_read_u16 v144, v195 offset:2048
  ds_read_u16 v145, v195 offset:2176
  ds_read_u16 v146, v195 offset:2304
  ds_read_u16 v147, v195 offset:2432
  ds_read_u16 v148, v195 offset:2560
  ds_read_u16 v149, v195 offset:2688
  ds_read_u16 v150, v195 offset:2816
  ds_read_u16 v151, v195 offset:2944
  s_waitcnt lgkmcnt(8)
  v_lshl_or_b32 v136, v137, 16, v136
  v_lshl_or_b32 v137, v139, 16, v138
  v_lshl_or_b32 v138, v141, 16, v140
  v_lshl_or_b32 v139, v143, 16, v142
  buffer_store_dwordx4 v[136:139], v193, s[4:7], 0 offen offset:512 sc1
  ds_read_u16 v152, v195 offset:3072
  ds_read_u16 v153, v195 offset:3200
  ds_read_u16 v154, v195 offset:3328
  ds_read_u16 v155, v195 offset:3456
  ds_read_u16 v156, v195 offset:3584
  ds_read_u16 v157, v195 offset:3712
  ds_read_u16 v158, v195 offset:3840
  ds_read_u16 v159, v195 offset:3968
  s_waitcnt lgkmcnt(8)
  v_lshl_or_b32 v144, v145, 16, v144
  v_lshl_or_b32 v145, v147, 16, v146
  v_lshl_or_b32 v146, v149, 16, v148
  v_lshl_or_b32 v147, v151, 16, v150
  buffer_store_dwordx4 v[144:147], v196, s[4:7], 0 offen offset:0 sc1
  ds_read_u16 v160, v198 offset:4096
  ds_read_u16 v161, v198 offset:4224
  ds_read_u16 v162, v198 offset:4352
  ds_read_u16 v163, v198 offset:4480
  ds_read_u16 v164, v198 offset:4608
  ds_read_u16 v165, v198 offset:4736
  ds_read_u16 v166, v198 offset:4864
  ds_read_u16 v167, v198 offset:4992
  s_waitcnt lgkmcnt(8)
  v_lshl_or_b32 v152, v153, 16, v152
  v_lshl_or_b32 v153, v155, 16, v154
  v_lshl_or_b32 v154, v157, 16, v156
  v_lshl_or_b32 v155, v159, 16, v158
  buffer_store_dwordx4 v[152:155], v196, s[4:7], 0 offen offset:512 sc1
  ds_read_u16 v168, v198 offset:5120
  ds_read_u16 v169, v198 offset:5248
  ds_read_u16 v170, v198 offset:5376
  ds_read_u16 v171, v198 offset:5504
  ds_read_u16 v172, v198 offset:5632
  ds_read_u16 v173, v198 offset:5760
  ds_read_u16 v174, v198 offset:5888
  ds_read_u16 v175, v198 offset:6016
  s_waitcnt lgkmcnt(8)
  v_lshl_or_b32 v160, v161, 16, v160
  v_lshl_or_b32 v161, v163, 16, v162
  v_lshl_or_b32 v162, v165, 16, v164
  v_lshl_or_b32 v163, v167, 16, v166
  buffer_store_dwordx4 v[160:163], v199, s[4:7], 0 offen offset:0 sc1
  ds_read_u16 v176, v201 offset:6144
  ds_read_u16 v177, v201 offset:6272
  ds_read_u16 v178, v201 offset:6400
  ds_read_u16 v179, v201 offset:6528
  ds_read_u16 v180, v201 offset:6656
  ds_read_u16 v181, v201 offset:6784
  ds_read_u16 v182, v201 offset:6912
  ds_read_u16 v183, v201 offset:7040
  s_waitcnt lgkmcnt(8)
  v_lshl_or_b32 v168, v169, 16, v168
  v_lshl_or_b32 v169, v171, 16, v170
  v_lshl_or_b32 v170, v173, 16, v172
  v_lshl_or_b32 v171, v175, 16, v174
  buffer_store_dwordx4 v[168:171], v199, s[4:7], 0 offen offset:512 sc1
  ds_read_u16 v184, v201 offset:7168
  ds_read_u16 v185, v201 offset:7296
  ds_read_u16 v186, v201 offset:7424
  ds_read_u16 v187, v201 offset:7552
  ds_read_u16 v188, v201 offset:7680
  ds_read_u16 v189, v201 offset:7808
  ds_read_u16 v190, v201 offset:7936
  ds_read_u16 v191, v201 offset:8064
  s_waitcnt lgkmcnt(8)
  v_lshl_or_b32 v176, v177, 16, v176
  v_lshl_or_b32 v177, v179, 16, v178
  v_lshl_or_b32 v178, v181, 16, v180
  v_lshl_or_b32 v179, v183, 16, v182
  buffer_store_dwordx4 v[176:179], v202, s[4:7], 0 offen offset:0 sc1
  s_waitcnt lgkmcnt(0)
  v_lshl_or_b32 v184, v185, 16, v184
  v_lshl_or_b32 v185, v187, 16, v186
  v_lshl_or_b32 v186, v189, 16, v188
  v_lshl_or_b32 v187, v191, 16, v190
  buffer_store_dwordx4 v[184:187], v202, s[4:7], 0 offen offset:512 sc1
  v_mov_b32_e64 v132, 0
  v_dot2c_f32_bf16 v132, s84, v128
  v_dot2c_f32_bf16 v132, s84, v136
  v_dot2c_f32_bf16 v132, s84, v129
  v_dot2c_f32_bf16 v132, s84, v137
  v_dot2c_f32_bf16 v132, s84, v130
  v_dot2c_f32_bf16 v132, s84, v138
  v_dot2c_f32_bf16 v132, s84, v131
  v_dot2c_f32_bf16 v132, s84, v139
  s_nop 2
  ds_write_b32 v209, v132 offset:0
  v_mov_b32 v148, 0
  v_dot2c_f32_bf16 v148, s84, v144
  v_dot2c_f32_bf16 v148, s84, v152
  v_dot2c_f32_bf16 v148, s84, v145
  v_dot2c_f32_bf16 v148, s84, v153
  v_dot2c_f32_bf16 v148, s84, v146
  v_dot2c_f32_bf16 v148, s84, v154
  v_dot2c_f32_bf16 v148, s84, v147
  v_dot2c_f32_bf16 v148, s84, v155
  s_nop 2
  ds_write_b32 v209, v148 offset:1024
  v_mov_b32 v164, 0
  v_dot2c_f32_bf16 v164, s84, v160
  v_dot2c_f32_bf16 v164, s84, v168
  v_dot2c_f32_bf16 v164, s84, v161
  v_dot2c_f32_bf16 v164, s84, v169
  v_dot2c_f32_bf16 v164, s84, v162
  v_dot2c_f32_bf16 v164, s84, v170
  v_dot2c_f32_bf16 v164, s84, v163
  v_dot2c_f32_bf16 v164, s84, v171
  s_nop 2
  ds_write_b32 v209, v164 offset:2048
  buffer_load_dword v224, v211, s[36:39], 0 offen sc1
  s_waitcnt lgkmcnt(0)
  s_barrier
  s_cmp_eq_u32 s48, 3
  s_cbranch_scc1 L_aug_e
  v_add_u32_e64 v208, s64, v6
  ds_read2st64_b32 v[220:221], v208 offset0:0 offset1:1
  ds_read2st64_b32 v[222:223], v208 offset0:2 offset1:3
  s_cmp_eq_u32 s48, 1
  s_cselect_b64 vcc, -1, 0
  v_cndmask_b32 v210, v194, v197, vcc
  s_cmp_eq_u32 s48, 2
  s_cselect_b64 vcc, -1, 0
  v_cndmask_b32 v210, v210, v200, vcc
  v_bfe_u32 v208, v210, 7, 3
  v_cmp_eq_u32 vcc, 6, v208
  v_mov_b32 v209, 0x40000000
  s_nop 0
  v_cndmask_b32 v208, v209, v210, vcc
  buffer_store_dword v216, v208, s[4:7], 0 offen offset:128 sc1
  s_waitcnt lgkmcnt(0)
  v_add_f32 v220, v220, v221
  v_add_f32 v222, v222, v223
  v_add_f32 v220, v220, v222
  v_cvt_pk_bf16_f32 v221, v220, v220
  v_and_b32 v221, 0xffff0000, v221
  v_sub_f32_e64 v221, v220, v221
  v_cvt_pk_bf16_f32 v221, v220, v221
  buffer_store_dword v221, v210, s[4:7], 0 offen sc1
L_aug_e:
  s_add_u32 m0, s74, 0
  s_nop 0
  buffer_load_dwordx4 v214, s[8:11], s75 offen offset:0  lds
  s_add_u32 m0, s74, 3968
  s_nop 0
  buffer_load_dwordx4 v214, s[8:11], s75 offen offset:128  lds
  s_add_u32 m0, s74, 7936
  s_nop 0
  buffer_load_dwordx4 v214, s[8:11], s75 offen offset:256  lds
  s_add_u32 m0, s74, 11904
  s_nop 0
  buffer_load_dwordx4 v214, s[8:11], s75 offen offset:384  lds
  s_add_u32 m0, s74, 15872
  s_nop 0
  buffer_load_dwordx4 v214, s[8:11], s75 offen offset:512  lds
  s_add_u32 m0, s74, 19840
  s_nop 0
  buffer_load_dwordx4 v214, s[8:11], s75 offen offset:640  lds
  s_add_u32 m0, s74, 23808
  s_nop 0
  buffer_load_dwordx4 v214, s[8:11], s75 offen offset:768  lds
  s_add_u32 s75, s75, 7168
  s_add_u32 m0, s74, 1024
  s_nop 0
  buffer_load_dwordx4 v215, s[8:11], s75 offen offset:0  lds
  s_add_u32 m0, s74, 4992
  s_nop 0
  buffer_load_dwordx4 v215, s[8:11], s75 offen offset:128  lds
  s_add_u32 m0, s74, 8960
  s_nop 0
  buffer_load_dwordx4 v215, s[8:11], s75 offen offset:256  lds
  s_add_u32 m0, s74, 12928
  s_nop 0
  buffer_load_dwordx4 v215, s[8:11], s75 offen offset:384  lds
  s_add_u32 m0, s74, 16896
  s_nop 0
  buffer_load_dwordx4 v215, s[8:11], s75 offen offset:512  lds
  s_waitcnt vmcnt(12)
  s_barrier
  s_cmp_lg_u32 s48, 3
  s_cbranch_scc1 L_ib
  v_cmp_ne_u32 vcc, 1, v224
  s_nop 0
  s_cmp_eq_u64 vcc, 0
  s_cbranch_scc1 L_go_ok
Lpoll_3:
  s_sleep 2
  buffer_load_dword v254, v211, s[36:39], 0 offen offset:0 sc1
  s_sub_u32 s54, s54, 1
  s_max_i32 s54, s54, 0
  s_cselect_b64 s[92:93], exec, 0
  s_waitcnt vmcnt(0)
  v_cmp_ne_u32 vcc, 1, v254
  s_nop 0
  s_and_b64 exec, s[92:93], vcc
  s_cbranch_scc1 Lpoll_3
  s_mov_b64 exec, -1
L_go_ok:
  v_lshlrev_b32 v208, 12, v0
  v_mov_b32_e64 v209, s95
  s_lshl_b32 s86, s2, 4
  s_mov_b64 exec, 15
  buffer_store_dword v209, v208, s[4:7], s86 offen sc1
  s_mov_b64 exec, -1
L_ib:
  s_add_u32 m0, s74, 20864
  s_nop 0
  buffer_load_dwordx4 v215, s[8:11], s75 offen offset:640  lds
  s_add_u32 m0, s74, 24832
  s_nop 0
  buffer_load_dwordx4 v215, s[8:11], s75 offen offset:768  lds
  s_add_u32 s75, s75, 7168
  s_add_u32 m0, s74, 2048
  s_nop 0
  buffer_load_dwordx4 v214, s[8:11], s75 offen offset:0  lds
  s_add_u32 m0, s74, 6016
  s_nop 0
  buffer_load_dwordx4 v214, s[8:11], s75 offen offset:128  lds
  s_add_u32 m0, s74, 9984
  s_nop 0
  buffer_load_dwordx4 v214, s[8:11], s75 offen offset:256  lds
  s_add_u32 m0, s74, 13952
  s_nop 0
  buffer_load_dwordx4 v214, s[8:11], s75 offen offset:384  lds
  s_add_u32 m0, s74, 17920
  s_nop 0
  buffer_load_dwordx4 v214, s[8:11], s75 offen offset:512  lds
  s_add_u32 m0, s74, 21888
  s_nop 0
  buffer_load_dwordx4 v214, s[8:11], s75 offen offset:640  lds
  s_add_u32 m0, s74, 25856
  s_nop 0
  buffer_load_dwordx4 v214, s[8:11], s75 offen offset:768  lds
  s_add_u32 s75, s75, 7168
  s_add_u32 m0, s74, 3072
  s_nop 0
  buffer_load_dwordx4 v215, s[8:11], s75 offen offset:0  lds
  s_add_u32 m0, s74, 7040
  s_nop 0
  buffer_load_dwordx4 v215, s[8:11], s75 offen offset:128  lds
  s_add_u32 m0, s74, 11008
  s_nop 0
  buffer_load_dwordx4 v215, s[8:11], s75 offen offset:256  lds
  s_add_u32 m0, s74, 14976
  s_nop 0
  buffer_load_dwordx4 v215, s[8:11], s75 offen offset:384  lds
  s_add_u32 m0, s74, 18944
  s_nop 0
  buffer_load_dwordx4 v215, s[8:11], s75 offen offset:512  lds
  s_add_u32 m0, s74, 22912
  s_nop 0
  buffer_load_dwordx4 v215, s[8:11], s75 offen offset:640  lds
  s_add_u32 m0, s74, 26880
  s_nop 0
  buffer_load_dwordx4 v215, s[8:11], s75 offen offset:768  lds
  s_add_u32 s75, s75, 7168
  s_mul_i32 s86, s58, 28672
  s_lshl_b32 s87, s59, 6
  s_add_u32 s86, s86, s87
  buffer_load_dwordx4 v[8:11], v4, s[8:11], s86 offen
  buffer_load_dwordx4 v[12:15], v4, s[8:11], s86 offen offset:32
  s_mul_i32 s67, s50, 89088
  s_add_u32 s67, s67, 1048576
  s_mul_i32 s68, s50, 207872
  s_add_u32 s68, s68, 3145728
  s_lshl_b32 s69, s52, 16
  s_lshl_b32 s86, s48, 14
  s_add_u32 s69, s69, s86
  s_add_u32 s69, s69, 2621440
  s_mul_i32 s70, s52, 229376
  s_mul_i32 s86, s48, 57344
  s_add_u32 s70, s70, s86
  s_add_u32 s70, s70, 6815744
  s_add_u32 s40, s4, 16777216
  s_addc_u32 s41, s5, 0
  s_mov_b32 s42, 33554432
  s_mov_b32 s43, 0x00020000
  s_mov_b32 s44, s40
  s_mov_b32 s45, s41
  s_mov_b32 s46, 33554432
  s_mov_b32 s47, 0x00020000
  v_lshrrev_b32 v208, 3, v204
  v_lshlrev_b32 v208, 10, v208
  v_and_b32_e64 v209, 7, v204
  v_lshl_add_u32 v208, v209, 7, v208
  v_add_u32_e64 v208, s74, v208
  v_bfe_u32 v209, v204, 1, 3
  v_xor_b32 v209, v209, v205
  v_xor_b32 v220, 0, v209
  v_lshl_add_u32 v220, v220, 4, v208
  v_xor_b32_e64 v221, 2, v209
  v_lshl_add_u32 v221, v221, 4, v208
  v_xor_b32_e64 v222, 4, v209
  v_lshl_add_u32 v222, v222, 4, v208
  v_xor_b32_e64 v223, 6, v209
  v_lshl_add_u32 v223, v223, 4, v208
  v_min_u32 v208, 20, v0
  v_mul_u32_u24 v209, 37, v208
  v_lshrrev_b32_e64 v209, 8, v209
  v_mad_u32_u24 v208, v209, 49, v208
  s_lshr_b32 s86, s50, 1
  s_mul_i32 s86, s86, 7
  v_add_lshl_u32 v210, v208, s86, 4
  s_waitcnt vmcnt(2)
  ds_read_b128 v[16:19], v220 offset:0
  ds_read_b128 v[20:23], v221 offset:0
  ds_read_b128 v[24:27], v222 offset:0
  ds_read_b128 v[28:31], v223 offset:0
  ds_read_b128 v[32:35], v220 offset:4096
  ds_read_b128 v[36:39], v221 offset:4096
  ds_read_b128 v[40:43], v222 offset:4096
  ds_read_b128 v[44:47], v223 offset:4096
  ds_read_b128 v[48:51], v220 offset:8192
  ds_read_b128 v[52:55], v221 offset:8192
  ds_read_b128 v[56:59], v222 offset:8192
  ds_read_b128 v[60:63], v223 offset:8192
  ds_read_b128 v[64:67], v220 offset:12288
  ds_read_b128 v[68:71], v221 offset:12288
  ds_read_b128 v[72:75], v222 offset:12288
  ds_read_b128 v[76:79], v223 offset:12288
  ds_read_b128 v[80:83], v220 offset:16384
  ds_read_b128 v[84:87], v221 offset:16384
  ds_read_b128 v[88:91], v222 offset:16384
  ds_read_b128 v[92:95], v223 offset:16384
  ds_read_b128 v[96:99], v220 offset:20480
  ds_read_b128 v[100:103], v221 offset:20480
  ds_read_b128 v[104:107], v222 offset:20480
  ds_read_b128 v[108:111], v223 offset:20480
  ds_read_b128 v[112:115], v220 offset:24576
  ds_read_b128 v[116:119], v221 offset:24576
  ds_read_b128 v[120:123], v222 offset:24576
  ds_read_b128 v[124:127], v223 offset:24576
  v_mov_b32 v240, v210
  s_mul_i32 s97, s58, 28672
  s_lshl_b32 s87, s59, 11
  s_add_u32 s97, s97, s87
  s_lshl_b32 s98, s58, 12
  s_cmp_ge_u32 s59, 7
  s_cselect_b32 s86, 7, 0
  s_cselect_b32 s87, 512, 0
  s_add_u32 s98, s98, s87
  s_sub_u32 s86, s59, s86
  s_lshr_b32 s87, s86, 1
  s_lshl_b32 s87, s87, 10
  s_add_u32 s98, s98, s87
  s_and_b32 s86, s86, 1
  s_lshl_b32 s86, s86, 3
  s_add_u32 s98, s98, s86
  s_lshl_b32 s99, s58, 9
  s_lshl_b32 s87, s59, 5
  s_add_u32 s99, s99, s87
  s_and_b32 s86, s64, 0x400
  v_add_u32_e64 v206, s86, v1
  v_xor_b32 v207, 0x400, v206
  v_and_b32_e64 v210, 27, v0
  v_cmp_eq_u32 vcc, 26, v210
  s_nop 1
  v_cndmask_b32 v210, 0, 1.0, vcc
  v_mov_b32_e64 v211, v210
  s_add_u32 s86, s66, 90112
  v_and_b32_e64 v208, 31, v0
  v_lshl_add_u32 v208, v208, 2, s86
  v_lshrrev_b32_e64 v209, 5, v0
  v_lshl_add_u32 v209, v209, 4, s86
  s_add_u32 s86, s68, 0xfffe6000
  v_add_u32 v204, s86, v1
  s_add_u32 s86, s67, 0x0
  v_add_u32_e64 v205, s86, v1
  s_waitcnt lgkmcnt(0)
  s_barrier
Lpoll_5:
  buffer_load_dword v254, v240, s[4:7], s72 offen offset:0 sc1
  s_sub_u32 s54, s54, 1
  s_max_i32 s54, s54, 0
  s_cselect_b64 s[92:93], exec, 0
  s_waitcnt vmcnt(0)
  v_cmp_eq_u32 vcc, 0, v254
  s_nop 0
  s_and_b64 exec, s[92:93], vcc
  s_cbranch_scc1 Lpoll_5
  s_mov_b64 exec, -1
  s_add_u32 m0, s65, 0
  s_nop 0
  buffer_load_dwordx4 v205, s[4:7], m0 offen offset:0 sc1 lds
  buffer_load_dwordx4 v205, s[4:7], m0 offen offset:1024 sc1 lds
  s_add_u32 m0, s65, 8192
  s_nop 0
  buffer_load_dwordx4 v205, s[4:7], m0 offen offset:0 sc1 lds
  buffer_load_dwordx4 v205, s[4:7], m0 offen offset:1024 sc1 lds
  v_mov_b32 v216, 0
  v_mov_b32 v217, 0
  v_mov_b32 v218, 0
  v_mov_b32 v219, 0
  s_add_u32 m0, s65, 16384
  s_nop 0
  buffer_load_dwordx4 v205, s[4:7], m0 offen offset:0 sc1 lds
  v_dot2c_f32_bf16 v216, s84, v16
  v_dot2c_f32_bf16 v218, v16, v16
  v_dot2c_f32_bf16 v217, s84, v17
  v_dot2c_f32_bf16 v219, v17, v17
  v_dot2c_f32_bf16 v216, s84, v18
  v_dot2c_f32_bf16 v218, v18, v18
  v_dot2c_f32_bf16 v217, s84, v19
  v_dot2c_f32_bf16 v219, v19, v19
  v_dot2c_f32_bf16 v216, s84, v20
  v_dot2c_f32_bf16 v218, v20, v20
  v_dot2c_f32_bf16 v217, s84, v21
  v_dot2c_f32_bf16 v219, v21, v21
  buffer_load_dwordx4 v205, s[4:7], m0 offen offset:1024 sc1 lds
  v_dot2c_f32_bf16 v216, s84, v22
  v_dot2c_f32_bf16 v218, v22, v22
  v_dot2c_f32_bf16 v217, s84, v23
  v_dot2c_f32_bf16 v219, v23, v23
  v_dot2c_f32_bf16 v216, s84, v24
  v_dot2c_f32_bf16 v218, v24, v24
  v_dot2c_f32_bf16 v217, s84, v25
  v_dot2c_f32_bf16 v219, v25, v25
  v_dot2c_f32_bf16 v216, s84, v26
  v_dot2c_f32_bf16 v218, v26, v26
  v_dot2c_f32_bf16 v217, s84, v27
  v_dot2c_f32_bf16 v219, v27, v27
  s_add_u32 m0, s65, 24576
  s_nop 0
  buffer_load_dwordx4 v205, s[4:7], m0 offen offset:0 sc1 lds
  v_dot2c_f32_bf16 v216, s84, v28
  v_dot2c_f32_bf16 v218, v28, v28
  v_dot2c_f32_bf16 v217, s84, v29
  v_dot2c_f32_bf16 v219, v29, v29
  v_dot2c_f32_bf16 v216, s84, v30
  v_dot2c_f32_bf16 v218, v30, v30
  v_dot2c_f32_bf16 v217, s84, v31
  v_dot2c_f32_bf16 v219, v31, v31
  v_dot2c_f32_bf16 v216, s84, v32
  v_dot2c_f32_bf16 v218, v32, v32
  v_dot2c_f32_bf16 v217, s84, v33
  v_dot2c_f32_bf16 v219, v33, v33
  buffer_load_dwordx4 v205, s[4:7], m0 offen offset:1024 sc1 lds
  v_dot2c_f32_bf16 v216, s84, v34
  v_dot2c_f32_bf16 v218, v34, v34
  v_dot2c_f32_bf16 v217, s84, v35
  v_dot2c_f32_bf16 v219, v35, v35
  v_dot2c_f32_bf16 v216, s84, v36
  v_dot2c_f32_bf16 v218, v36, v36
  v_dot2c_f32_bf16 v217, s84, v37
  v_dot2c_f32_bf16 v219, v37, v37
  v_dot2c_f32_bf16 v216, s84, v38
  v_dot2c_f32_bf16 v218, v38, v38
  v_dot2c_f32_bf16 v217, s84, v39
  v_dot2c_f32_bf16 v219, v39, v39
  s_add_u32 m0, s65, 32768
  s_nop 0
  buffer_load_dwordx4 v205, s[4:7], m0 offen offset:0 sc1 lds
  v_dot2c_f32_bf16 v216, s84, v40
  v_dot2c_f32_bf16 v218, v40, v40
  v_dot2c_f32_bf16 v217, s84, v41
  v_dot2c_f32_bf16 v219, v41, v41
  v_dot2c_f32_bf16 v216, s84, v42
  v_dot2c_f32_bf16 v218, v42, v42
  v_dot2c_f32_bf16 v217, s84, v43
  v_dot2c_f32_bf16 v219, v43, v43
  v_dot2c_f32_bf16 v216, s84, v44
  v_dot2c_f32_bf16 v218, v44, v44
  v_dot2c_f32_bf16 v217, s84, v45
  v_dot2c_f32_bf16 v219, v45, v45
  buffer_load_dwordx4 v205, s[4:7], m0 offen offset:1024 sc1 lds
  v_dot2c_f32_bf16 v216, s84, v46
  v_dot2c_f32_bf16 v218, v46, v46
  v_dot2c_f32_bf16 v217, s84, v47
  v_dot2c_f32_bf16 v219, v47, v47
  v_dot2c_f32_bf16 v216, s84, v48
  v_dot2c_f32_bf16 v218, v48, v48
  v_dot2c_f32_bf16 v217, s84, v49
  v_dot2c_f32_bf16 v219, v49, v49
  v_dot2c_f32_bf16 v216, s84, v50
  v_dot2c_f32_bf16 v218, v50, v50
  v_dot2c_f32_bf16 v217, s84, v51
  v_dot2c_f32_bf16 v219, v51, v51
  s_add_u32 m0, s65, 40960
  s_nop 0
  buffer_load_dwordx4 v205, s[4:7], m0 offen offset:0 sc1 lds
  v_dot2c_f32_bf16 v216, s84, v52
  v_dot2c_f32_bf16 v218, v52, v52
  v_dot2c_f32_bf16 v217, s84, v53
  v_dot2c_f32_bf16 v219, v53, v53
  v_dot2c_f32_bf16 v216, s84, v54
  v_dot2c_f32_bf16 v218, v54, v54
  v_dot2c_f32_bf16 v217, s84, v55
  v_dot2c_f32_bf16 v219, v55, v55
  v_dot2c_f32_bf16 v216, s84, v56
  v_dot2c_f32_bf16 v218, v56, v56
  v_dot2c_f32_bf16 v217, s84, v57
  v_dot2c_f32_bf16 v219, v57, v57
  buffer_load_dwordx4 v205, s[4:7], m0 offen offset:1024 sc1 lds
  v_dot2c_f32_bf16 v216, s84, v58
  v_dot2c_f32_bf16 v218, v58, v58
  v_dot2c_f32_bf16 v217, s84, v59
  v_dot2c_f32_bf16 v219, v59, v59
  v_dot2c_f32_bf16 v216, s84, v60
  v_dot2c_f32_bf16 v218, v60, v60
  v_dot2c_f32_bf16 v217, s84, v61
  v_dot2c_f32_bf16 v219, v61, v61
  v_dot2c_f32_bf16 v216, s84, v62
  v_dot2c_f32_bf16 v218, v62, v62
  v_dot2c_f32_bf16 v217, s84, v63
  v_dot2c_f32_bf16 v219, v63, v63
  s_add_u32 m0, s65, 49152
  s_nop 0
  buffer_load_dwordx4 v205, s[4:7], m0 offen offset:0 sc1 lds
  v_dot2c_f32_bf16 v216, s84, v64
  v_dot2c_f32_bf16 v218, v64, v64
  v_dot2c_f32_bf16 v217, s84, v65
  v_dot2c_f32_bf16 v219, v65, v65
  v_dot2c_f32_bf16 v216, s84, v66
  v_dot2c_f32_bf16 v218, v66, v66
  v_dot2c_f32_bf16 v217, s84, v67
  v_dot2c_f32_bf16 v219, v67, v67
  v_dot2c_f32_bf16 v216, s84, v68
  v_dot2c_f32_bf16 v218, v68, v68
  v_dot2c_f32_bf16 v217, s84, v69
  v_dot2c_f32_bf16 v219, v69, v69
  buffer_load_dwordx4 v205, s[4:7], m0 offen offset:1024 sc1 lds
  v_dot2c_f32_bf16 v216, s84, v70
  v_dot2c_f32_bf16 v218, v70, v70
  v_dot2c_f32_bf16 v217, s84, v71
  v_dot2c_f32_bf16 v219, v71, v71
  v_dot2c_f32_bf16 v216, s84, v72
  v_dot2c_f32_bf16 v218, v72, v72
  v_dot2c_f32_bf16 v217, s84, v73
  v_dot2c_f32_bf16 v219, v73, v73
  v_dot2c_f32_bf16 v216, s84, v74
  v_dot2c_f32_bf16 v218, v74, v74
  v_dot2c_f32_bf16 v217, s84, v75
  v_dot2c_f32_bf16 v219, v75, v75
  s_add_u32 m0, s65, 57344
  s_nop 0
  buffer_load_dwordx4 v205, s[4:7], m0 offen offset:0 sc1 lds
  v_dot2c_f32_bf16 v216, s84, v76
  v_dot2c_f32_bf16 v218, v76, v76
  v_dot2c_f32_bf16 v217, s84, v77
  v_dot2c_f32_bf16 v219, v77, v77
  v_dot2c_f32_bf16 v216, s84, v78
  v_dot2c_f32_bf16 v218, v78, v78
  v_dot2c_f32_bf16 v217, s84, v79
  v_dot2c_f32_bf16 v219, v79, v79
  v_dot2c_f32_bf16 v216, s84, v80
  v_dot2c_f32_bf16 v218, v80, v80
  v_dot2c_f32_bf16 v217, s84, v81
  v_dot2c_f32_bf16 v219, v81, v81
  buffer_load_dwordx4 v205, s[4:7], m0 offen offset:1024 sc1 lds
  v_dot2c_f32_bf16 v216, s84, v82
  v_dot2c_f32_bf16 v218, v82, v82
  v_dot2c_f32_bf16 v217, s84, v83
  v_dot2c_f32_bf16 v219, v83, v83
  v_dot2c_f32_bf16 v216, s84, v84
  v_dot2c_f32_bf16 v218, v84, v84
  v_dot2c_f32_bf16 v217, s84, v85
  v_dot2c_f32_bf16 v219, v85, v85
  v_dot2c_f32_bf16 v216, s84, v86
  v_dot2c_f32_bf16 v218, v86, v86
  v_dot2c_f32_bf16 v217, s84, v87
  v_dot2c_f32_bf16 v219, v87, v87
  s_add_u32 m0, s65, 65536
  s_nop 0
  buffer_load_dwordx4 v205, s[4:7], m0 offen offset:0 sc1 lds
  v_dot2c_f32_bf16 v216, s84, v88
  v_dot2c_f32_bf16 v218, v88, v88
  v_dot2c_f32_bf16 v217, s84, v89
  v_dot2c_f32_bf16 v219, v89, v89
  v_dot2c_f32_bf16 v216, s84, v90
  v_dot2c_f32_bf16 v218, v90, v90
  v_dot2c_f32_bf16 v217, s84, v91
  v_dot2c_f32_bf16 v219, v91, v91
  v_dot2c_f32_bf16 v216, s84, v92
  v_dot2c_f32_bf16 v218, v92, v92
  v_dot2c_f32_bf16 v217, s84, v93
  v_dot2c_f32_bf16 v219, v93, v93
  buffer_load_dwordx4 v205, s[4:7], m0 offen offset:1024 sc1 lds
  v_dot2c_f32_bf16 v216, s84, v94
  v_dot2c_f32_bf16 v218, v94, v94
  v_dot2c_f32_bf16 v217, s84, v95
  v_dot2c_f32_bf16 v219, v95, v95
  v_dot2c_f32_bf16 v216, s84, v96
  v_dot2c_f32_bf16 v218, v96, v96
  v_dot2c_f32_bf16 v217, s84, v97
  v_dot2c_f32_bf16 v219, v97, v97
  v_dot2c_f32_bf16 v216, s84, v98
  v_dot2c_f32_bf16 v218, v98, v98
  v_dot2c_f32_bf16 v217, s84, v99
  v_dot2c_f32_bf16 v219, v99, v99
  s_add_u32 m0, s65, 73728
  s_nop 0
  buffer_load_dwordx4 v205, s[4:7], m0 offen offset:0 sc1 lds
  v_dot2c_f32_bf16 v216, s84, v100
  v_dot2c_f32_bf16 v218, v100, v100
  v_dot2c_f32_bf16 v217, s84, v101
  v_dot2c_f32_bf16 v219, v101, v101
  v_dot2c_f32_bf16 v216, s84, v102
  v_dot2c_f32_bf16 v218, v102, v102
  v_dot2c_f32_bf16 v217, s84, v103
  v_dot2c_f32_bf16 v219, v103, v103
  v_dot2c_f32_bf16 v216, s84, v104
  v_dot2c_f32_bf16 v218, v104, v104
  v_dot2c_f32_bf16 v217, s84, v105
  v_dot2c_f32_bf16 v219, v105, v105
  buffer_load_dwordx4 v205, s[4:7], m0 offen offset:1024 sc1 lds
  v_dot2c_f32_bf16 v216, s84, v106
  v_dot2c_f32_bf16 v218, v106, v106
  v_dot2c_f32_bf16 v217, s84, v107
  v_dot2c_f32_bf16 v219, v107, v107
  v_dot2c_f32_bf16 v216, s84, v108
  v_dot2c_f32_bf16 v218, v108, v108
  v_dot2c_f32_bf16 v217, s84, v109
  v_dot2c_f32_bf16 v219, v109, v109
  v_dot2c_f32_bf16 v216, s84, v110
  v_dot2c_f32_bf16 v218, v110, v110
  v_dot2c_f32_bf16 v217, s84, v111
  v_dot2c_f32_bf16 v219, v111, v111
  s_add_u32 m0, s65, 81920
  s_nop 0
  buffer_load_dwordx4 v205, s[4:7], m0 offen offset:0 sc1 lds
  v_dot2c_f32_bf16 v216, s84, v112
  v_dot2c_f32_bf16 v218, v112, v112
  v_dot2c_f32_bf16 v217, s84, v113
  v_dot2c_f32_bf16 v219, v113, v113
  v_dot2c_f32_bf16 v216, s84, v114
  v_dot2c_f32_bf16 v218, v114, v114
  v_dot2c_f32_bf16 v217, s84, v115
  v_dot2c_f32_bf16 v219, v115, v115
  v_dot2c_f32_bf16 v216, s84, v116
  v_dot2c_f32_bf16 v218, v116, v116
  v_dot2c_f32_bf16 v217, s84, v117
  v_dot2c_f32_bf16 v219, v117, v117
  buffer_load_dwordx4 v205, s[4:7], m0 offen offset:1024 sc1 lds
  v_dot2c_f32_bf16 v216, s84, v118
  v_dot2c_f32_bf16 v218, v118, v118
  v_dot2c_f32_bf16 v217, s84, v119
  v_dot2c_f32_bf16 v219, v119, v119
  v_dot2c_f32_bf16 v216, s84, v120
  v_dot2c_f32_bf16 v218, v120, v120
  v_dot2c_f32_bf16 v217, s84, v121
  v_dot2c_f32_bf16 v219, v121, v121
  v_dot2c_f32_bf16 v216, s84, v122
  v_dot2c_f32_bf16 v218, v122, v122
  v_dot2c_f32_bf16 v217, s84, v123
  v_dot2c_f32_bf16 v219, v123, v123
  v_dot2c_f32_bf16 v216, s84, v124
  v_dot2c_f32_bf16 v218, v124, v124
  v_dot2c_f32_bf16 v217, s84, v125
  v_dot2c_f32_bf16 v219, v125, v125
  v_dot2c_f32_bf16 v216, s84, v126
  v_dot2c_f32_bf16 v218, v126, v126
  v_dot2c_f32_bf16 v217, s84, v127
  v_dot2c_f32_bf16 v219, v127, v127
  s_nop 1
  v_add_f32 v216, v216, v217
  v_add_f32 v217, v218, v219
  v_mov_b32 v218, v216
  v_mov_b32 v219, v217
  s_nop 0
  v_permlane32_swap_b32 v216, v218
  v_permlane32_swap_b32 v217, v219
  v_add_f32 v216, v216, v218
  v_add_f32_e64 v217, v217, v219
  v_mul_f32 v216, 0x3b124925, v216
  v_mul_f32 v217, 0x3b124925, v217
  v_fma_f32 v217, -v216, v216, v217
  v_max_f32_e64 v217, 0, v217
  v_add_f32 v217, 0x3727c5ac, v217
  v_rsq_f32_e64 v248, v217
  v_cvt_pk_bf16_f32 v200, -v216, -v216
  v_mul_f32_e64 v250, v217, v248
  v_mul_f32 v249, 0x3fb8aa3b, v248
  v_mov_b32 v201, v200
  v_mov_b32 v202, v200
  v_mov_b32_e64 v203, v200
  s_waitcnt vmcnt(16)
  s_barrier
  ds_read_b128 v[176:179], v1 offset:0
  ds_read_b128 v[180:183], v1 offset:1024
  ds_read_b128 v[184:187], v1 offset:3072
  ds_read_b128 v[188:191], v1 offset:4096
  s_waitcnt lgkmcnt(2)
  v_mfma_f32_32x32x16_bf16 v[128:143], v[16:19], v[176:179], 0
  ds_read_b128 v[192:195], v1 offset:6144
  v_mfma_f32_32x32x16_bf16 v[144:159], v[16:19], v[180:183], 0
  ds_read_b128 v[196:199], v1 offset:7168
  s_waitcnt lgkmcnt(2)
  v_mfma_f32_32x32x16_bf16 v[128:143], v[20:23], v[184:187], v[128:143]
  ds_read_b128 v[176:179], v1 offset:9216
  v_mfma_f32_32x32x16_bf16 v[144:159], v[20:23], v[188:191], v[144:159]
  ds_read_b128 v[180:183], v1 offset:10240
  s_waitcnt lgkmcnt(2)
  v_mfma_f32_32x32x16_bf16 v[128:143], v[24:27], v[192:195], v[128:143]
  ds_read_b128 v[184:187], v1 offset:12288
  v_mfma_f32_32x32x16_bf16 v[144:159], v[24:27], v[196:199], v[144:159]
  ds_read_b128 v[188:191], v1 offset:13312
  s_waitcnt lgkmcnt(2)
  v_mfma_f32_32x32x16_bf16 v[128:143], v[28:31], v[176:179], v[128:143]
  ds_read_b128 v[192:195], v1 offset:15360
  v_mfma_f32_32x32x16_bf16 v[144:159], v[28:31], v[180:183], v[144:159]
  ds_read_b128 v[196:199], v1 offset:16384
  s_waitcnt lgkmcnt(2)
  v_mfma_f32_32x32x16_bf16 v[128:143], v[32:35], v[184:187], v[128:143]
  ds_read_b128 v[176:179], v1 offset:18432
  v_mfma_f32_32x32x16_bf16 v[144:159], v[32:35], v[188:191], v[144:159]
  ds_read_b128 v[180:183], v1 offset:19456
  s_waitcnt lgkmcnt(2)
  v_mfma_f32_32x32x16_bf16 v[128:143], v[36:39], v[192:195], v[128:143]
  ds_read_b128 v[184:187], v1 offset:21504
  s_add_u32 s74, s72, s64
  buffer_load_dword v254, v1, s[4:7], s74 offen sc1
  v_mfma_f32_32x32x16_bf16 v[144:159], v[36:39], v[196:199], v[144:159]
  ds_read_b128 v[188:191], v1 offset:22528
  s_waitcnt lgkmcnt(2)
  v_mfma_f32_32x32x16_bf16 v[128:143], v[40:43], v[176:179], v[128:143]
  s_waitcnt vmcnt(11)
  s_barrier
  ds_read_b128 v[192:195], v1 offset:24576
  v_mfma_f32_32x32x16_bf16 v[144:159], v[40:43], v[180:183], v[144:159]
  ds_read_b128 v[196:199], v1 offset:25600
  s_waitcnt lgkmcnt(2)
  v_mfma_f32_32x32x16_bf16 v[128:143], v[44:47], v[184:187], v[128:143]
  ds_read_b128 v[176:179], v1 offset:27648
  v_mfma_f32_32x32x16_bf16 v[144:159], v[44:47], v[188:191], v[144:159]
  ds_read_b128 v[180:183], v1 offset:28672
  s_waitcnt lgkmcnt(2)
  v_mfma_f32_32x32x16_bf16 v[128:143], v[48:51], v[192:195], v[128:143]
  ds_read_b128 v[184:187], v1 offset:30720
  v_mfma_f32_32x32x16_bf16 v[144:159], v[48:51], v[196:199], v[144:159]
  ds_read_b128 v[188:191], v1 offset:31744
  s_waitcnt lgkmcnt(2)
  v_mfma_f32_32x32x16_bf16 v[128:143], v[52:55], v[176:179], v[128:143]
  ds_read_b128 v[192:195], v1 offset:33792
  v_mfma_f32_32x32x16_bf16 v[144:159], v[52:55], v[180:183], v[144:159]
  ds_read_b128 v[196:199], v1 offset:34816
  s_waitcnt lgkmcnt(2)
  v_mfma_f32_32x32x16_bf16 v[128:143], v[56:59], v[184:187], v[128:143]
  ds_read_b128 v[176:179], v1 offset:36864
  v_mfma_f32_32x32x16_bf16 v[144:159], v[56:59], v[188:191], v[144:159]
  ds_read_b128 v[180:183], v1 offset:37888
  s_waitcnt lgkmcnt(2)
  v_mfma_f32_32x32x16_bf16 v[128:143], v[60:63], v[192:195], v[128:143]
  ds_read_b128 v[184:187], v1 offset:39936
  v_mfma_f32_32x32x16_bf16 v[144:159], v[60:63], v[196:199], v[144:159]
  ds_read_b128 v[188:191], v1 offset:40960
  s_waitcnt lgkmcnt(2)
  v_mfma_f32_32x32x16_bf16 v[128:143], v[64:67], v[176:179], v[128:143]
  ds_read_b128 v[192:195], v1 offset:43008
  v_mfma_f32_32x32x16_bf16 v[144:159], v[64:67], v[180:183], v[144:159]
  ds_read_b128 v[196:199], v1 offset:44032
  s_waitcnt lgkmcnt(2)
  v_mfma_f32_32x32x16_bf16 v[128:143], v[68:71], v[184:187], v[128:143]
  ds_read_b128 v[176:179], v1 offset:46080
  v_mfma_f32_32x32x16_bf16 v[144:159], v[68:71], v[188:191], v[144:159]
  ds_read_b128 v[180:183], v1 offset:47104
  s_waitcnt lgkmcnt(2)
  v_mfma_f32_32x32x16_bf16 v[128:143], v[72:75], v[192:195], v[128:143]
  s_waitcnt vmcnt(1)
  s_waitcnt vmcnt(0)
  v_cmp_eq_u32 vcc, 0, v254
  s_nop 0
  s_cmp_eq_u64 vcc, 0
  s_cbranch_scc0 Lc_7
Lr_8:
  s_and_b32 s86, s2, 7
  v_and_b32 v252, 7, v0
  v_cmp_eq_u32 s[88:89], s86, v252
  v_cmp_ne_u32 vcc, s95, v254
  s_nop 0
  s_and_b64 vcc, vcc, s[88:89]
  s_cselect_b32 s96, 1, 0
  s_barrier
  ds_read_b128 v[184:187], v1 offset:49152
  v_mfma_f32_32x32x16_bf16 v[144:159], v[72:75], v[196:199], v[144:159]
  ds_read_b128 v[188:191], v1 offset:50176
  s_waitcnt lgkmcnt(2)
  v_mfma_f32_32x32x16_bf16 v[128:143], v[76:79], v[176:179], v[128:143]
  s_add_u32 m0, s65, 106496
  ds_read_b128 v[192:195], v1 offset:52224
  buffer_load_dwordx4 v204, s[4:7], m0 offen offset:0 sc1 lds
  v_mfma_f32_32x32x16_bf16 v[144:159], v[76:79], v[180:183], v[144:159]
  ds_read_b128 v[196:199], v1 offset:53248
  s_waitcnt lgkmcnt(2)
  v_mfma_f32_32x32x16_bf16 v[128:143], v[80:83], v[184:187], v[128:143]
  ds_read_b128 v[176:179], v1 offset:55296
  buffer_load_dwordx4 v204, s[4:7], m0 offen offset:1024 sc1 lds
  v_mfma_f32_32x32x16_bf16 v[144:159], v[80:83], v[188:191], v[144:159]
  ds_read_b128 v[180:183], v1 offset:56320
  s_waitcnt lgkmcnt(2)
  v_mfma_f32_32x32x16_bf16 v[128:143], v[84:87], v[192:195], v[128:143]
  s_add_u32 m0, s65, 114688
  ds_read_b128 v[184:187], v1 offset:58368
  buffer_load_dwordx4 v204, s[4:7], m0 offen offset:0 sc1 lds
  v_mfma_f32_32x32x16_bf16 v[144:159], v[84:87], v[196:199], v[144:159]
  ds_read_b128 v[188:191], v1 offset:59392
  s_waitcnt lgkmcnt(2)
  v_mfma_f32_32x32x16_bf16 v[128:143], v[88:91], v[176:179], v[128:143]
  ds_read_b128 v[192:195], v1 offset:61440
  buffer_load_dwordx4 v204, s[4:7], m0 offen offset:1024 sc1 lds
  v_mfma_f32_32x32x16_bf16 v[144:159], v[88:91], v[180:183], v[144:159]
  ds_read_b128 v[196:199], v1 offset:62464
  s_waitcnt lgkmcnt(2)
  v_mfma_f32_32x32x16_bf16 v[128:143], v[92:95], v[184:187], v[128:143]
  s_add_u32 m0, s65, 122880
  ds_read_b128 v[176:179], v1 offset:64512
  buffer_load_dwordx4 v204, s[4:7], m0 offen offset:0 sc1 lds
  v_mfma_f32_32x32x16_bf16 v[144:159], v[92:95], v[188:191], v[144:159]
  ds_read_b128 v[180:183], v2 offset:0
  s_waitcnt lgkmcnt(2)
  v_mfma_f32_32x32x16_bf16 v[128:143], v[96:99], v[192:195], v[128:143]
  ds_read_b128 v[184:187], v2 offset:2048
  buffer_load_dwordx4 v204, s[4:7], m0 offen offset:1024 sc1 lds
  v_mfma_f32_32x32x16_bf16 v[144:159], v[96:99], v[196:199], v[144:159]
  ds_read_b128 v[188:191], v2 offset:3072
  s_waitcnt lgkmcnt(2)
  v_mfma_f32_32x32x16_bf16 v[128:143], v[100:103], v[176:179], v[128:143]
  s_add_u32 m0, s65, 131072
  ds_read_b128 v[192:195], v2 offset:5120
  buffer_load_dwordx4 v204, s[4:7], m0 offen offset:0 sc1 lds
  v_mfma_f32_32x32x16_bf16 v[144:159], v[100:103], v[180:183], v[144:159]
  ds_read_b128 v[196:199], v2 offset:6144
  s_waitcnt lgkmcnt(2)
  v_mfma_f32_32x32x16_bf16 v[128:143], v[104:107], v[184:187], v[128:143]
  ds_read_b128 v[176:179], v2 offset:8192
  buffer_load_dwordx4 v204, s[4:7], m0 offen offset:1024 sc1 lds
  v_mfma_f32_32x32x16_bf16 v[144:159], v[104:107], v[188:191], v[144:159]
  ds_read_b128 v[180:183], v2 offset:9216
  s_waitcnt lgkmcnt(2)
  v_mfma_f32_32x32x16_bf16 v[128:143], v[108:111], v[192:195], v[128:143]
  s_add_u32 m0, s65, 139264
  ds_read_b128 v[184:187], v2 offset:11264
  buffer_load_dwordx4 v204, s[4:7], m0 offen offset:0 sc1 lds
  v_mfma_f32_32x32x16_bf16 v[144:159], v[108:111], v[196:199], v[144:159]
  ds_read_b128 v[188:191], v2 offset:12288
  ds_write2_b32 v208, v248, v249 offset0:0 offset1:32
  s_waitcnt lgkmcnt(3)
  v_mfma_f32_32x32x16_bf16 v[128:143], v[112:115], v[176:179], v[128:143]
  ds_read_b128 v[192:195], v2 offset:14336
  buffer_load_dwordx4 v204, s[4:7], m0 offen offset:1024 sc1 lds
  v_mfma_f32_32x32x16_bf16 v[144:159], v[112:115], v[180:183], v[144:159]
  ds_read_b128 v[196:199], v2 offset:15360
  ds_read_b128 v[160:163], v209 offset:0
  ds_read_b128 v[216:219], v209 offset:128
  s_waitcnt lgkmcnt(5)
  v_mfma_f32_32x32x16_bf16 v[128:143], v[116:119], v[184:187], v[128:143]
  s_add_u32 m0, s65, 147456
  ds_read_b128 v[176:179], v2 offset:17408
  buffer_load_dwordx4 v204, s[4:7], m0 offen offset:0 sc1 lds
  v_mfma_f32_32x32x16_bf16 v[144:159], v[116:119], v[188:191], v[144:159]
  ds_read_b128 v[180:183], v2 offset:18432
  ds_read_b128 v[164:167], v209 offset:32
  ds_read_b128 v[220:223], v209 offset:160
  s_waitcnt lgkmcnt(6)
  v_mfma_f32_32x32x16_bf16 v[128:143], v[120:123], v[192:195], v[128:143]
  v_add_u32 v252, 0x15000, v5
  ds_read2_b32 v[184:185], v252 offset0:0 offset1:32
  ds_read2_b32 v[186:187], v252 offset0:64 offset1:96
  buffer_load_dwordx4 v204, s[4:7], m0 offen offset:1024 sc1 lds
  v_mfma_f32_32x32x16_bf16 v[144:159], v[120:123], v[196:199], v[144:159]
  v_add_u32 v253, 0x15400, v5
  ds_read2_b32 v[188:189], v253 offset0:0 offset1:32
  ds_read2_b32 v[190:191], v253 offset0:64 offset1:96
  ds_read_b128 v[168:171], v209 offset:64
  ds_read_b128 v[224:227], v209 offset:192
  s_waitcnt lgkmcnt(8)
  v_mfma_f32_32x32x16_bf16 v[128:143], v[124:127], v[176:179], v[128:143]
  s_add_u32 m0, s65, 155648
  s_nop 0
  buffer_load_dwordx4 v204, s[4:7], m0 offen offset:0 sc1 lds
  v_mfma_f32_32x32x16_bf16 v[144:159], v[124:127], v[180:183], v[144:159]
  ds_read_b128 v[172:175], v209 offset:96
  ds_read_b128 v[228:231], v209 offset:224
  s_waitcnt lgkmcnt(4)
  v_mfma_f32_32x32x16_bf16 v[128:143], v[200:203], v[184:187], v[128:143]
  buffer_load_dwordx4 v204, s[4:7], m0 offen offset:1024 sc1 lds
  v_mfma_f32_32x32x16_bf16 v[144:159], v[200:203], v[188:191], v[144:159]
  ds_read_b128 v[176:179], v1 offset:2048
  ds_read_b128 v[180:183], v1 offset:5120
  ds_read_b128 v[184:187], v1 offset:8192
  ds_read_b128 v[188:191], v1 offset:11264
  s_lshl_b32 s87, s50, 12
  s_add_u32 s87, s87, s64
  s_waitcnt lgkmcnt(4)
  v_pk_mul_f32 v[128:129], v[128:129], v[216:217]
  v_pk_mul_f32 v[130:131], v[130:131], v[218:219]
  v_pk_mul_f32 v[132:133], v[132:133], v[220:221]
  v_pk_mul_f32 v[134:135], v[134:135], v[222:223]
  v_pk_mul_f32 v[136:137], v[136:137], v[224:225]
  v_pk_mul_f32 v[138:139], v[138:139], v[226:227]
  v_pk_mul_f32 v[140:141], v[140:141], v[228:229]
  v_pk_mul_f32 v[142:143], v[142:143], v[230:231]
  v_exp_f32_e64 v216, v128 clamp
  v_max_f32 v128, 0, v128
  v_exp_f32_e64 v217, v129 clamp
  v_max_f32_e64 v129, 0, v129
  v_exp_f32_e64 v218, v130 clamp
  v_max_f32_e64 v130, 0, v130
  v_exp_f32_e64 v219, v131 clamp
  v_max_f32_e64 v131, 0, v131
  v_exp_f32_e64 v220, v132 clamp
  v_max_f32_e64 v132, 0, v132
  v_exp_f32_e64 v221, v133 clamp
  v_max_f32_e64 v133, 0, v133
  v_exp_f32_e64 v222, v134 clamp
  v_max_f32_e64 v134, 0, v134
  v_exp_f32_e64 v223, v135 clamp
  v_max_f32_e64 v135, 0, v135
  v_exp_f32_e64 v224, v136 clamp
  v_max_f32_e64 v136, 0, v136
  v_exp_f32_e64 v225, v137 clamp
  v_max_f32_e64 v137, 0, v137
  v_exp_f32_e64 v226, v138 clamp
  v_max_f32_e64 v138, 0, v138
  v_exp_f32_e64 v227, v139 clamp
  v_max_f32_e64 v139, 0, v139
  v_exp_f32_e64 v228, v140 clamp
  v_max_f32_e64 v140, 0, v140
  v_exp_f32_e64 v229, v141 clamp
  v_max_f32_e64 v141, 0, v141
  v_exp_f32_e64 v230, v142 clamp
  v_max_f32_e64 v142, 0, v142
  v_exp_f32_e64 v231, v143 clamp
  v_max_f32_e64 v143, 0, v143
  v_pk_fma_f32 v[144:145], v[144:145], v[160:161], v[210:211]
  v_pk_fma_f32 v[216:217], v[128:129], s[60:61], v[216:217]
  v_pk_fma_f32 v[146:147], v[146:147], v[162:163], v[210:211]
  v_pk_fma_f32 v[218:219], v[130:131], s[60:61], v[218:219]
  v_pk_fma_f32 v[148:149], v[148:149], v[164:165], v[210:211]
  v_pk_fma_f32 v[220:221], v[132:133], s[60:61], v[220:221]
  v_pk_fma_f32 v[150:151], v[150:151], v[166:167], v[210:211]
  v_pk_fma_f32 v[222:223], v[134:135], s[60:61], v[222:223]
  v_pk_fma_f32 v[152:153], v[152:153], v[168:169], v[210:211]
  v_pk_fma_f32 v[224:225], v[136:137], s[60:61], v[224:225]
  v_pk_fma_f32 v[154:155], v[154:155], v[170:171], v[210:211]
  v_pk_fma_f32 v[226:227], v[138:139], s[60:61], v[226:227]
  v_pk_fma_f32 v[156:157], v[156:157], v[172:173], v[210:211]
  v_pk_fma_f32 v[228:229], v[140:141], s[60:61], v[228:229]
  v_pk_fma_f32 v[158:159], v[158:159], v[174:175], v[210:211]
  v_pk_fma_f32 v[230:231], v[142:143], s[60:61], v[230:231]
  v_pk_add_f32 v[216:217], v[216:217], s[62:63]
  v_cvt_pk_bf16_f32 v144, v144, v145
  v_pk_add_f32 v[218:219], v[218:219], s[62:63]
  v_cvt_pk_bf16_f32 v145, v146, v147
  v_pk_add_f32 v[220:221], v[220:221], s[62:63]
  v_cvt_pk_bf16_f32 v146, v148, v149
  v_pk_add_f32 v[222:223], v[222:223], s[62:63]
  v_cvt_pk_bf16_f32 v147, v150, v151
  v_pk_add_f32 v[224:225], v[224:225], s[62:63]
  v_cvt_pk_bf16_f32 v148, v152, v153
  v_pk_add_f32 v[226:227], v[226:227], s[62:63]
  v_cvt_pk_bf16_f32 v149, v154, v155
  v_pk_add_f32 v[228:229], v[228:229], s[62:63]
  v_cvt_pk_bf16_f32 v150, v156, v157
  v_pk_add_f32 v[230:231], v[230:231], s[62:63]
  v_cvt_pk_bf16_f32 v151, v158, v159
  v_cvt_pk_bf16_f32 v128, v216, v217
  v_cvt_pk_bf16_f32 v129, v218, v219
  v_cvt_pk_bf16_f32 v130, v220, v221
  v_cvt_pk_bf16_f32 v131, v222, v223
  s_nop 1
  v_mfma_f32_32x32x16_bf16 v[232:247], v[128:131], v[144:147], 0
  v_cvt_pk_bf16_f32 v132, v224, v225
  v_cvt_pk_bf16_f32 v133, v226, v227
  v_cvt_pk_bf16_f32 v134, v228, v229
  v_cvt_pk_bf16_f32 v135, v230, v231
  s_add_u32 s86, s66, 90112
  v_add_u32 v208, s86, v1
  v_mfma_f32_32x32x16_bf16 v[232:247], v[132:135], v[148:151], v[232:247]
  s_add_u32 s86, s64, 90112
  v_add_u32 v209, s86, v6
  s_lshl_b32 s86, s48, 2
  s_add_u32 s86, s86, 89088
  v_mov_b32 v252, s86
  v_mov_b32 v253, s96
  ds_write_b32 v252, v253
  v_mov_b32 v252, 89088
  s_waitcnt lgkmcnt(4)
  v_mfma_f32_32x32x16_bf16 v[160:175], v[176:179], v[16:19], 0
  ds_read_b128 v[192:195], v1 offset:14336
  s_nop 0
  ds_write_b128 v208, v[232:235] offset:0
  ds_write_b128 v208, v[236:239] offset:1024
  ds_write_b128 v208, v[240:243] offset:2048
  ds_write_b128 v208, v[244:247] offset:3072
  s_waitcnt lgkmcnt(8)
  v_mfma_f32_32x32x16_bf16 v[160:175], v[180:183], v[20:23], v[160:175]
  ds_read_b128 v[196:199], v1 offset:17408
  s_waitcnt lgkmcnt(1)
  s_barrier
  ds_read2st64_b32 v[216:217], v209 offset0:0 offset1:1
  ds_read2st64_b32 v[218:219], v209 offset0:2 offset1:3
  ds_read2st64_b32 v[220:221], v209 offset0:16 offset1:17
  ds_read2st64_b32 v[222:223], v209 offset0:18 offset1:19
  ds_read2st64_b32 v[224:225], v209 offset0:32 offset1:33
  ds_read2st64_b32 v[226:227], v209 offset0:34 offset1:35
  ds_read2st64_b32 v[228:229], v209 offset0:48 offset1:49
  ds_read2st64_b32 v[230:231], v209 offset0:50 offset1:51
  ds_read_b128 v[232:235], v252
  v_mfma_f32_32x32x16_bf16 v[160:175], v[184:187], v[24:27], v[160:175]
  ds_read_b128 v[176:179], v1 offset:20480
  s_waitcnt lgkmcnt(2)
  v_add_f32 v216, v216, v220
  v_add_f32 v224, v224, v228
  v_add_f32 v217, v217, v221
  v_add_f32 v225, v225, v229
  v_add_f32 v218, v218, v222
  v_add_f32 v226, v226, v230
  v_add_f32 v219, v219, v223
  v_add_f32 v227, v227, v231
  v_add_f32 v216, v216, v224
  v_add_f32 v217, v217, v225
  v_add_f32 v218, v218, v226
  v_add_f32 v219, v219, v227
  buffer_atomic_add_f32 v216, v6, s[40:43], s87 offen offset:0
  buffer_atomic_add_f32 v217, v6, s[40:43], s87 offen offset:256
  buffer_atomic_add_f32 v218, v6, s[40:43], s87 offen offset:512
  buffer_atomic_add_f32 v219, v6, s[40:43], s87 offen offset:768
  s_waitcnt lgkmcnt(1)
  v_or_b32 v232, v232, v233
  v_or3_b32 v232, v232, v234, v235
  s_nop 0
  v_readfirstlane_b32 s86, v232
  s_nop 0
  s_cmp_lg_u32 s86, 0
  s_cbranch_scc1 L_slow
  v_mfma_f32_32x32x16_bf16 v[160:175], v[188:191], v[28:31], v[160:175]
  ds_read_b128 v[180:183], v1 offset:23552
  s_cmp_ge_u32 s49, 28
  s_cselect_b32 s75, 0x40000000, s97
  s_add_u32 s75, s75, 3145728
  buffer_store_dwordx4 v[8:11], v1, s[44:47], s75 offen sc1
  s_lshl_b32 s73, s50, 8
  s_lshl_b32 s87, s71, 4
  v_mfma_f32_32x32x16_bf16 v[160:175], v[192:195], v[32:35], v[160:175]
  ds_read_b128 v[184:187], v1 offset:26624
  s_add_u32 s73, s73, s87
  s_add_u32 s73, s73, 65536
  s_cmp_lg_u32 s48, 3
  s_cselect_b32 s73, 0x40000000, s73
  s_lshl_b32 s86, s56, 15
  s_lshl_b32 s87, s50, 11
  s_add_u32 s86, s86, s87
  v_mfma_f32_32x32x16_bf16 v[160:175], v[196:199], v[36:39], v[160:175]
  ds_read_b128 v[188:191], v1 offset:29696
  buffer_store_dwordx4 v[12:15], v1, s[44:47], s75 offen offset:1024 sc1
  s_add_u32 s86, s86, 1048576
  s_lshl_b32 s94, s56, 9
  s_lshl_b32 s87, s50, 5
  s_add_u32 s94, s94, s87
  s_add_u32 s94, s94, 98304
  s_waitcnt lgkmcnt(3)
  v_mfma_f32_32x32x16_bf16 v[160:175], v[176:179], v[40:43], v[160:175]
  ds_read_b128 v[192:195], v1 offset:32768
  v_lshlrev_b32 v208, 12, v0
  v_mov_b32 v209, 1
  v_mov_b32 v251, v249
  v_mov_b32 v135, 0
  s_waitcnt lgkmcnt(3)
  v_mfma_f32_32x32x16_bf16 v[160:175], v[180:183], v[44:47], v[160:175]
  ds_read_b128 v[196:199], v1 offset:35840
  s_add_u32 s91, s69, 0
  buffer_load_dwordx4 v[16:19], v206, s[4:7], s91 offen offset:0 sc1
  s_waitcnt lgkmcnt(3)
  v_mfma_f32_32x32x16_bf16 v[160:175], v[184:187], v[48:51], v[160:175]
  ds_read_b128 v[176:179], v1 offset:38912
  s_waitcnt lgkmcnt(3)
  v_mfma_f32_32x32x16_bf16 v[160:175], v[188:191], v[52:55], v[160:175]
  ds_read_b128 v[180:183], v1 offset:41984
  buffer_load_dwordx4 v[20:23], v207, s[4:7], s91 offen offset:0 sc1
  s_waitcnt lgkmcnt(3)
  v_mfma_f32_32x32x16_bf16 v[160:175], v[192:195], v[56:59], v[160:175]
  ds_read_b128 v[184:187], v1 offset:45056
  s_waitcnt lgkmcnt(3)
  v_mfma_f32_32x32x16_bf16 v[160:175], v[196:199], v[60:63], v[160:175]
  ds_read_b128 v[188:191], v1 offset:48128
  buffer_load_dwordx4 v[24:27], v206, s[4:7], s91 offen offset:2048 sc1
  s_waitcnt lgkmcnt(3)
  v_mfma_f32_32x32x16_bf16 v[160:175], v[176:179], v[64:67], v[160:175]
  ds_read_b128 v[192:195], v1 offset:51200
  s_waitcnt lgkmcnt(3)
  v_mfma_f32_32x32x16_bf16 v[160:175], v[180:183], v[68:71], v[160:175]
  ds_read_b128 v[196:199], v1 offset:54272
  buffer_load_dwordx4 v[28:31], v207, s[4:7], s91 offen offset:2048 sc1
  s_waitcnt lgkmcnt(3)
  v_mfma_f32_32x32x16_bf16 v[160:175], v[184:187], v[72:75], v[160:175]
  ds_read_b128 v[176:179], v1 offset:57344
  s_waitcnt lgkmcnt(3)
  v_mfma_f32_32x32x16_bf16 v[160:175], v[188:191], v[76:79], v[160:175]
  ds_read_b128 v[180:183], v1 offset:60416
  s_add_u32 s91, s69, 4096
  buffer_load_dwordx4 v[32:35], v206, s[4:7], s91 offen offset:0 sc1
  s_waitcnt lgkmcnt(3)
  v_mfma_f32_32x32x16_bf16 v[160:175], v[192:195], v[80:83], v[160:175]
  ds_read_b128 v[184:187], v1 offset:63488
  s_waitcnt lgkmcnt(3)
  v_mfma_f32_32x32x16_bf16 v[160:175], v[196:199], v[84:87], v[160:175]
  ds_read_b128 v[188:191], v2 offset:1024
  buffer_load_dwordx4 v[36:39], v207, s[4:7], s91 offen offset:0 sc1
  s_waitcnt lgkmcnt(3)
  v_mfma_f32_32x32x16_bf16 v[160:175], v[176:179], v[88:91], v[160:175]
  ds_read_b128 v[192:195], v2 offset:4096
  s_waitcnt lgkmcnt(3)
  v_mfma_f32_32x32x16_bf16 v[160:175], v[180:183], v[92:95], v[160:175]
  ds_read_b128 v[196:199], v2 offset:7168
  buffer_load_dwordx4 v[40:43], v206, s[4:7], s91 offen offset:2048 sc1
  s_waitcnt lgkmcnt(3)
  v_mfma_f32_32x32x16_bf16 v[160:175], v[184:187], v[96:99], v[160:175]
  ds_read_b128 v[176:179], v2 offset:10240
  s_waitcnt lgkmcnt(3)
  v_mfma_f32_32x32x16_bf16 v[160:175], v[188:191], v[100:103], v[160:175]
  ds_read_b128 v[180:183], v2 offset:13312
  buffer_load_dwordx4 v[44:47], v207, s[4:7], s91 offen offset:2048 sc1
  s_waitcnt lgkmcnt(3)
  v_mfma_f32_32x32x16_bf16 v[160:175], v[192:195], v[104:107], v[160:175]
  ds_read_b128 v[184:187], v2 offset:16384
  s_waitcnt vmcnt(10)
  s_barrier
  s_mov_b64 exec, 15
  buffer_store_dword v209, v208, s[40:43], s73 offen sc1
  s_mov_b64 exec, -1
  s_waitcnt lgkmcnt(3)
  v_mfma_f32_32x32x16_bf16 v[160:175], v[196:199], v[108:111], v[160:175]
  ds_read_b128 v[188:191], v2 offset:19456
  s_add_u32 s91, s69, 8192
  buffer_load_dwordx4 v[48:51], v206, s[4:7], s91 offen offset:0 sc1
  s_waitcnt lgkmcnt(3)
  v_mfma_f32_32x32x16_bf16 v[160:175], v[176:179], v[112:115], v[160:175]
  v_add_u32 v252, 0x15800, v5
  ds_read2_b32 v[192:193], v252 offset0:0 offset1:32
  ds_read2_b32 v[194:195], v252 offset0:64 offset1:96
  s_waitcnt lgkmcnt(4)
  v_mfma_f32_32x32x16_bf16 v[160:175], v[180:183], v[116:119], v[160:175]
  buffer_load_dwordx4 v[52:55], v207, s[4:7], s91 offen offset:0 sc1
  s_waitcnt lgkmcnt(3)
  v_mfma_f32_32x32x16_bf16 v[160:175], v[184:187], v[120:123], v[160:175]
  s_waitcnt lgkmcnt(2)
  v_mfma_f32_32x32x16_bf16 v[160:175], v[188:191], v[124:127], v[160:175]
  buffer_load_dwordx4 v[56:59], v206, s[4:7], s91 offen offset:2048 sc1
  s_waitcnt lgkmcnt(0)
  v_mfma_f32_32x32x16_bf16 v[160:175], v[192:195], v[200:203], v[160:175]
  s_nop 4
  s_nop 6
  v_pk_mul_f32 v[160:161], v[160:161], v[250:251] op_sel:[0,1] op_sel_hi:[1,1]
  v_pk_mul_f32 v[162:163], v[162:163], v[250:251] op_sel:[0,1] op_sel_hi:[1,1]
  v_pk_mul_f32 v[164:165], v[164:165], v[250:251] op_sel:[0,1] op_sel_hi:[1,1]
  v_pk_mul_f32 v[166:167], v[166:167], v[250:251] op_sel:[0,1] op_sel_hi:[1,1]
  v_pk_mul_f32 v[168:169], v[168:169], v[250:251] op_sel:[0,1] op_sel_hi:[1,1]
  v_pk_mul_f32 v[170:171], v[170:171], v[250:251] op_sel:[0,1] op_sel_hi:[1,1]
  v_pk_mul_f32 v[172:173], v[172:173], v[250:251] op_sel:[0,1] op_sel_hi:[1,1]
  v_exp_f32_e64 v216, v160 clamp
  v_max_f32_e64 v160, 0, v160
  v_exp_f32_e64 v217, v161 clamp
  v_max_f32_e64 v161, 0, v161
  v_exp_f32_e64 v218, v162 clamp
  v_max_f32_e64 v162, 0, v162
  v_exp_f32_e64 v219, v163 clamp
  v_max_f32_e64 v163, 0, v163
  v_exp_f32_e64 v220, v164 clamp
  v_max_f32_e64 v164, 0, v164
  v_exp_f32_e64 v221, v165 clamp
  v_max_f32_e64 v165, 0, v165
  v_exp_f32_e64 v222, v166 clamp
  v_max_f32_e64 v166, 0, v166
  v_exp_f32_e64 v223, v167 clamp
  v_max_f32_e64 v167, 0, v167
  v_exp_f32_e64 v224, v168 clamp
  v_max_f32_e64 v168, 0, v168
  v_exp_f32_e64 v225, v169 clamp
  v_max_f32_e64 v169, 0, v169
  v_exp_f32_e64 v226, v170 clamp
  v_max_f32_e64 v170, 0, v170
  v_exp_f32_e64 v227, v171 clamp
  v_max_f32_e64 v171, 0, v171
  v_exp_f32_e64 v228, v172 clamp
  v_max_f32_e64 v172, 0, v172
  v_exp_f32_e64 v229, v173 clamp
  v_max_f32_e64 v173, 0, v173
  v_pk_fma_f32 v[216:217], v[160:161], s[60:61], v[216:217]
  v_pk_fma_f32 v[218:219], v[162:163], s[60:61], v[218:219]
  v_pk_fma_f32 v[220:221], v[164:165], s[60:61], v[220:221]
  v_pk_fma_f32 v[222:223], v[166:167], s[60:61], v[222:223]
  v_pk_fma_f32 v[224:225], v[168:169], s[60:61], v[224:225]
  v_pk_fma_f32 v[226:227], v[170:171], s[60:61], v[226:227]
  v_pk_fma_f32 v[228:229], v[172:173], s[60:61], v[228:229]
  v_pk_add_f32 v[216:217], v[216:217], s[62:63]
  v_pk_add_f32 v[218:219], v[218:219], s[62:63]
  v_pk_add_f32 v[220:221], v[220:221], s[62:63]
  v_pk_add_f32 v[222:223], v[222:223], s[62:63]
  v_pk_add_f32 v[224:225], v[224:225], s[62:63]
  v_pk_add_f32 v[226:227], v[226:227], s[62:63]
  v_pk_add_f32 v[228:229], v[228:229], s[62:63]
  v_cvt_pk_bf16_f32 v128, v216, v217
  v_cvt_pk_bf16_f32 v129, v218, v219
  v_cvt_pk_bf16_f32 v130, v220, v221
  v_cvt_pk_bf16_f32 v131, v222, v223
  v_cvt_pk_bf16_f32 v132, v224, v225
  v_cvt_pk_bf16_f32 v133, v226, v227
  v_cvt_pk_bf16_f32 v134, v228, v229
  buffer_store_dwordx4 v[128:131], v1, s[44:47], s86 offen sc1
  buffer_store_dwordx4 v[132:135], v1, s[44:47], s86 offen offset:1024 sc1
  buffer_load_dwordx4 v[60:63], v207, s[4:7], s91 offen offset:2048 sc1
  s_add_u32 s91, s69, 12288
  buffer_load_dwordx4 v[64:67], v206, s[4:7], s91 offen offset:0 sc1
  buffer_load_dwordx4 v[68:71], v207, s[4:7], s91 offen offset:0 sc1
  buffer_load_dwordx4 v[72:75], v206, s[4:7], s91 offen offset:2048 sc1
  s_barrier
  s_waitcnt vmcnt(4)
  v_mov_b32 v254, 1
  s_mov_b64 exec, 1
  buffer_store_dword v254, off, s[40:43], s94 offset:0
  s_mov_b64 exec, -1
  buffer_load_dwordx4 v[76:79], v207, s[4:7], s91 offen offset:2048 sc1
  s_add_u32 s75, s70, 0
  buffer_load_dwordx4 a[0:3], v206, s[4:7], s75 offen offset:0 sc1
  buffer_load_dwordx4 a[4:7], v207, s[4:7], s75 offen offset:0 sc1
  buffer_load_dwordx4 a[8:11], v206, s[4:7], s75 offen offset:2048 sc1
  buffer_load_dwordx4 a[12:15], v207, s[4:7], s75 offen offset:2048 sc1
  s_add_u32 s75, s70, 4096
  buffer_load_dwordx4 a[16:19], v206, s[4:7], s75 offen offset:0 sc1
  buffer_load_dwordx4 a[20:23], v207, s[4:7], s75 offen offset:0 sc1
  buffer_load_dwordx4 a[24:27], v206, s[4:7], s75 offen offset:2048 sc1
  buffer_load_dwordx4 a[28:31], v207, s[4:7], s75 offen offset:2048 sc1
  s_add_u32 s86, s68, 0xe000
  v_add_u32 v4, s86, v1
  v_and_b32 v240, 3, v0
  v_lshlrev_b32_e64 v240, 5, v240
  v_bfe_u32 v241, v0, 2, 1
  v_lshl_add_u32 v240, v241, 9, v240
  s_lshl_b32 s88, s57, 9
  s_lshl_b32 s86, s48, 7
  s_add_u32 s88, s88, s86
  s_add_u32 s88, s88, 98304
  s_lshl_b32 s90, s58, 15
  s_lshl_b32 s86, s48, 13
  s_add_u32 s90, s90, s86
  s_add_u32 s90, s90, 1048576
  s_xor_b32 s91, s90, 0x8000
  s_add_u32 s74, s72, s64
  s_add_u32 s74, s74, 65536
  s_lshl_b32 s89, s48, 14
  s_cmp_ge_u32 s49, 28
  s_cbranch_scc1 Lc_11
  v_lshlrev_b32_e64 v208, 16, v8
  v_and_b32 v209, 0xffff0000, v8
  v_lshlrev_b32_e64 v210, 16, v9
  v_and_b32 v211, 0xffff0000, v9
  v_lshlrev_b32_e64 v212, 16, v10
  v_and_b32 v213, 0xffff0000, v10
  v_lshlrev_b32_e64 v214, 16, v11
  v_and_b32 v215, 0xffff0000, v11
  v_lshlrev_b32_e64 v216, 16, v12
  v_and_b32 v217, 0xffff0000, v12
  v_lshlrev_b32_e64 v218, 16, v13
  v_and_b32 v219, 0xffff0000, v13
  v_lshlrev_b32_e64 v220, 16, v14
  v_and_b32 v221, 0xffff0000, v14
  v_lshlrev_b32_e64 v222, 16, v15
  v_and_b32 v223, 0xffff0000, v15
  s_xor_b32 s80, s48, 0
  s_mul_i32 s80, s80, 12288
  s_add_u32 s80, s80, 57344
  s_xor_b32 s81, s48, 1
  s_mul_i32 s81, s81, 12288
  s_add_u32 s81, s81, 57344
  s_xor_b32 s82, s48, 2
  s_mul_i32 s82, s82, 12288
  s_add_u32 s82, s82, 61440
  s_xor_b32 s83, s48, 3
  s_mul_i32 s83, s83, 12288
  s_add_u32 s83, s83, 65536
Lpoll_12:
  buffer_load_dword v254, v240, s[40:43], s88 offen offset:0 sc1
  s_sub_u32 s54, s54, 1
  s_max_i32 s54, s54, 0
  s_cselect_b64 s[92:93], exec, 0
  s_waitcnt vmcnt(0)
  v_cmp_ne_u32 vcc, 1, v254
  s_nop 0
  s_and_b64 exec, s[92:93], vcc
  s_cbranch_scc1 Lpoll_12
  s_mov_b64 exec, -1
  buffer_load_dwordx4 v[88:91], v1, s[44:47], s91 offen offset:0 sc1
  buffer_load_dwordx4 v[92:95], v1, s[44:47], s91 offen offset:1024 sc1
  buffer_load_dwordx4 v[104:107], v1, s[44:47], s91 offen offset:2048 sc1
  buffer_load_dwordx4 v[108:111], v1, s[44:47], s91 offen offset:3072 sc1
  s_add_u32 s91, s91, 4096
  buffer_load_dword v253, v1, s[40:43], s74 offen sc1
  buffer_load_dwordx4 v[120:123], v1, s[44:47], s91 offen offset:0 sc1
  buffer_load_dwordx4 v[124:127], v1, s[44:47], s91 offen offset:1024 sc1
  buffer_load_dwordx4 v[136:139], v1, s[44:47], s91 offen offset:2048 sc1
  buffer_load_dwordx4 v[140:143], v1, s[44:47], s91 offen offset:3072 sc1
  buffer_load_dwordx4 v[80:83], v1, s[44:47], s90 offen offset:0 sc1
  buffer_load_dwordx4 v[84:87], v1, s[44:47], s90 offen offset:1024 sc1
  buffer_load_dwordx4 v[96:99], v1, s[44:47], s90 offen offset:2048 sc1
  buffer_load_dwordx4 v[100:103], v1, s[44:47], s90 offen offset:3072 sc1
  s_add_u32 s90, s90, 4096
  s_waitcnt vmcnt(8)
  v_cmp_ne_u32 vcc, 1, v253
  s_nop 0
  s_cmp_eq_u64 vcc, 0
  s_cbranch_scc0 Lc_14
Lr_15:
  buffer_load_dwordx4 v[144:147], v1, s[40:43], s89 offen offset:0 sc1
  buffer_load_dwordx4 v[148:151], v1, s[40:43], s89 offen offset:1024 sc1
  buffer_load_dwordx4 v[152:155], v1, s[40:43], s89 offen offset:2048 sc1
  buffer_load_dwordx4 v[156:159], v1, s[40:43], s89 offen offset:3072 sc1
  s_add_u32 s89, s89, 4096
  buffer_load_dwordx4 v[160:163], v1, s[40:43], s89 offen offset:0 sc1
  buffer_load_dwordx4 v[164:167], v1, s[40:43], s89 offen offset:1024 sc1
  buffer_load_dwordx4 v[168:171], v1, s[40:43], s89 offen offset:2048 sc1
  buffer_load_dwordx4 v[172:175], v1, s[40:43], s89 offen offset:3072 sc1
  s_add_u32 s89, s89, 4096
  buffer_load_dwordx4 v[176:179], v1, s[40:43], s89 offen offset:0 sc1
  buffer_load_dwordx4 v[180:183], v1, s[40:43], s89 offen offset:1024 sc1
  buffer_load_dwordx4 v[184:187], v1, s[40:43], s89 offen offset:2048 sc1
  buffer_load_dwordx4 v[188:191], v1, s[40:43], s89 offen offset:3072 sc1
  s_add_u32 s89, s89, 4096
  buffer_load_dwordx4 v[192:195], v1, s[40:43], s89 offen offset:0 sc1
  buffer_load_dwordx4 v[196:199], v1, s[40:43], s89 offen offset:1024 sc1
  buffer_load_dwordx4 v[200:203], v1, s[40:43], s89 offen offset:2048 sc1
  buffer_load_dwordx4 v[204:207], v1, s[40:43], s89 offen offset:3072 sc1
  s_add_u32 s89, s89, 4096
  s_and_b32 s86, s64, 0x400
  s_add_u32 s76, s70, s86
  s_xor_b32 s86, s86, 0x400
  s_add_u32 s77, s70, s86
  s_waitcnt vmcnt(12)
  v_cvt_pk_bf16_f32 v144, v144, v145
  v_cvt_pk_bf16_f32 v145, v146, v147
  v_cvt_pk_bf16_f32 v146, v148, v149
  v_cvt_pk_bf16_f32 v147, v150, v151
  v_cvt_pk_bf16_f32 v148, v152, v153
  v_cvt_pk_bf16_f32 v149, v154, v155
  v_cvt_pk_bf16_f32 v150, v156, v157
  v_cvt_pk_bf16_f32 v151, v158, v159
  v_mfma_f32_32x32x16_bf16 v[240:255], v[144:147], v[88:91], 0
  s_nop 0
  v_mfma_f32_32x32x16_bf16 v[240:255], v[148:151], v[92:95], v[240:255]
  s_waitcnt vmcnt(8)
  v_cvt_pk_bf16_f32 v152, v160, v161
  v_cvt_pk_bf16_f32 v153, v162, v163
  v_cvt_pk_bf16_f32 v154, v164, v165
  v_cvt_pk_bf16_f32 v155, v166, v167
  v_cvt_pk_bf16_f32 v156, v168, v169
  v_cvt_pk_bf16_f32 v157, v170, v171
  v_cvt_pk_bf16_f32 v158, v172, v173
  v_cvt_pk_bf16_f32 v159, v174, v175
  v_mfma_f32_32x32x16_bf16 v[160:175], v[152:155], v[104:107], 0
  s_nop 1
  v_add_f32 v254, s62, v254
  v_rcp_f32 v254, v254
  s_nop 0
  v_mul_f32 v240, v240, v254
  v_mul_f32_e64 v241, v241, v254
  v_cvt_pk_bf16_f32 v88, v240, v241
  v_mul_f32_e64 v242, v242, v254
  v_mfma_f32_32x32x16_bf16 v[160:175], v[156:159], v[108:111], v[160:175]
  v_mul_f32_e64 v243, v243, v254
  v_cvt_pk_bf16_f32 v89, v242, v243
  v_mul_f32 v244, v244, v254
  v_mul_f32 v245, v245, v254
  v_cvt_pk_bf16_f32 v90, v244, v245
  v_mul_f32 v246, v246, v254
  v_mul_f32 v247, v247, v254
  v_cvt_pk_bf16_f32 v91, v246, v247
  v_mul_f32 v248, v248, v254
  v_mul_f32 v249, v249, v254
  v_cvt_pk_bf16_f32 v92, v248, v249
  v_mul_f32 v250, v250, v254
  v_mul_f32 v251, v251, v254
  v_cvt_pk_bf16_f32 v93, v250, v251
  v_mul_f32 v252, v252, v254
  v_mul_f32 v253, v253, v254
  v_cvt_pk_bf16_f32 v94, v252, v253
  s_waitcnt vmcnt(4)
  v_mfma_f32_32x32x16_bf16 a[224:239], v[16:19], v[88:91], 0
  buffer_load_dwordx4 v[112:115], v1, s[44:47], s90 offen offset:0 sc1
  v_cvt_pk_bf16_f32 v176, v176, v177
  v_cvt_pk_bf16_f32 v177, v178, v179
  v_cvt_pk_bf16_f32 v178, v180, v181
  v_cvt_pk_bf16_f32 v179, v182, v183
  v_cvt_pk_bf16_f32 v180, v184, v185
  v_cvt_pk_bf16_f32 v181, v186, v187
  v_mfma_f32_32x32x16_bf16 a[224:239], v[24:27], v[92:95], a[224:239]
  v_cvt_pk_bf16_f32 v182, v188, v189
  v_cvt_pk_bf16_f32 v183, v190, v191
  v_add_f32 v174, s62, v174
  v_rcp_f32 v174, v174
  s_nop 0
  v_mul_f32 v160, v160, v174
  v_mul_f32 v161, v161, v174
  v_mfma_f32_32x32x16_bf16 v[240:255], v[176:179], v[120:123], 0
  buffer_load_dwordx4 v[116:119], v1, s[44:47], s90 offen offset:1024 sc1
  v_cvt_pk_bf16_f32 v104, v160, v161
  v_mul_f32 v162, v162, v174
  v_mul_f32 v163, v163, v174
  v_cvt_pk_bf16_f32 v105, v162, v163
  v_mul_f32 v164, v164, v174
  v_mul_f32 v165, v165, v174
  v_mfma_f32_32x32x16_bf16 v[240:255], v[180:183], v[124:127], v[240:255]
  v_cvt_pk_bf16_f32 v106, v164, v165
  v_mul_f32 v166, v166, v174
  v_mul_f32 v167, v167, v174
  v_cvt_pk_bf16_f32 v107, v166, v167
  v_mul_f32 v168, v168, v174
  v_mul_f32 v169, v169, v174
  v_cvt_pk_bf16_f32 v108, v168, v169
  v_mfma_f32_32x32x16_bf16 a[240:255], v[20:23], v[88:91], 0
  buffer_load_dwordx4 v[128:131], v1, s[44:47], s90 offen offset:2048 sc1
  v_mul_f32 v170, v170, v174
  v_mul_f32 v171, v171, v174
  v_cvt_pk_bf16_f32 v109, v170, v171
  v_mul_f32 v172, v172, v174
  v_mul_f32 v173, v173, v174
  v_cvt_pk_bf16_f32 v110, v172, v173
  v_mfma_f32_32x32x16_bf16 a[240:255], v[28:31], v[92:95], a[240:255]
  s_waitcnt vmcnt(3)
  v_mfma_f32_32x32x16_bf16 a[224:239], v[32:35], v[104:107], a[224:239]
  buffer_load_dwordx4 v[132:135], v1, s[44:47], s90 offen offset:3072 sc1
  v_cvt_pk_bf16_f32 v192, v192, v193
  v_cvt_pk_bf16_f32 v193, v194, v195
  v_cvt_pk_bf16_f32 v194, v196, v197
  v_cvt_pk_bf16_f32 v195, v198, v199
  v_cvt_pk_bf16_f32 v196, v200, v201
  v_cvt_pk_bf16_f32 v197, v202, v203
  v_mfma_f32_32x32x16_bf16 a[224:239], v[40:43], v[108:111], a[224:239]
  v_cvt_pk_bf16_f32 v198, v204, v205
  v_cvt_pk_bf16_f32 v199, v206, v207
  v_add_f32 v254, s62, v254
  v_rcp_f32 v254, v254
  s_nop 0
  v_mul_f32 v240, v240, v254
  v_mul_f32 v241, v241, v254
  v_mfma_f32_32x32x16_bf16 v[160:175], v[192:195], v[136:139], 0
  s_add_u32 m0, s65, 0
  s_nop 0
  buffer_load_dwordx4 v4, s[4:7], m0 offen offset:0 sc1 lds
  v_cvt_pk_bf16_f32 v120, v240, v241
  v_mul_f32 v242, v242, v254
  v_mul_f32 v243, v243, v254
  v_cvt_pk_bf16_f32 v121, v242, v243
  v_mfma_f32_32x32x16_bf16 v[160:175], v[196:199], v[140:143], v[160:175]
  v_mul_f32 v244, v244, v254
  v_mul_f32 v245, v245, v254
  v_cvt_pk_bf16_f32 v122, v244, v245
  v_mul_f32 v246, v246, v254
  v_mul_f32 v247, v247, v254
  v_cvt_pk_bf16_f32 v123, v246, v247
  v_mul_f32_e64 v248, v248, v254
  v_mfma_f32_32x32x16_bf16 a[240:255], v[36:39], v[104:107], a[240:255]
  buffer_load_dwordx4 v4, s[4:7], m0 offen offset:1024 sc1 lds
  v_mul_f32_e64 v249, v249, v254
  v_cvt_pk_bf16_f32 v124, v248, v249
  v_mul_f32 v250, v250, v254
  v_mul_f32 v251, v251, v254
  v_cvt_pk_bf16_f32 v125, v250, v251
  v_mul_f32_e64 v252, v252, v254
  v_mfma_f32_32x32x16_bf16 a[240:255], v[44:47], v[108:111], a[240:255]
  v_mul_f32_e64 v253, v253, v254
  v_cvt_pk_bf16_f32 v126, v252, v253
  v_mfma_f32_32x32x16_bf16 a[224:239], v[48:51], v[120:123], a[224:239]
  s_add_u32 m0, s65, 8192
  s_nop 0
  buffer_load_dwordx4 v4, s[4:7], m0 offen offset:0 sc1 lds
  v_add_f32 v174, s62, v174
  v_rcp_f32 v174, v174
  s_nop 0
  v_mul_f32_e64 v160, v160, v174
  v_mfma_f32_32x32x16_bf16 a[224:239], v[56:59], v[124:127], a[224:239]
  v_mul_f32_e64 v161, v161, v174
  v_cvt_pk_bf16_f32 v136, v160, v161
  v_mul_f32 v162, v162, v174
  v_mul_f32 v163, v163, v174
  v_cvt_pk_bf16_f32 v137, v162, v163
  v_mul_f32 v164, v164, v174
  v_mul_f32 v165, v165, v174
  v_mfma_f32_32x32x16_bf16 v[240:255], v[144:147], v[80:83], 0
  buffer_load_dwordx4 v4, s[4:7], m0 offen offset:1024 sc1 lds
  v_cvt_pk_bf16_f32 v138, v164, v165
  v_mul_f32 v166, v166, v174
  v_mul_f32 v167, v167, v174
  v_cvt_pk_bf16_f32 v139, v166, v167
  v_mul_f32 v168, v168, v174
  v_mul_f32 v169, v169, v174
  v_mfma_f32_32x32x16_bf16 v[240:255], v[148:151], v[84:87], v[240:255]
  v_cvt_pk_bf16_f32 v140, v168, v169
  v_mul_f32 v170, v170, v174
  v_mul_f32 v171, v171, v174
  v_cvt_pk_bf16_f32 v141, v170, v171
  v_mul_f32 v172, v172, v174
  v_mul_f32 v173, v173, v174
  v_cvt_pk_bf16_f32 v142, v172, v173
  v_mfma_f32_32x32x16_bf16 a[240:255], v[52:55], v[120:123], a[240:255]
  s_add_u32 m0, s65, 16384
  s_nop 0
  buffer_load_dwordx4 v4, s[4:7], m0 offen offset:0 sc1 lds
  v_add_u32 v184, s80, v1
  v_add_u32 v185, s81, v1
  v_add_u32 v186, s82, v1
  v_add_u32_e64 v187, s83, v1
  v_mfma_f32_32x32x16_bf16 a[240:255], v[60:63], v[124:127], a[240:255]
  v_mfma_f32_32x32x16_bf16 a[224:239], v[64:67], v[136:139], a[224:239]
  buffer_load_dwordx4 v4, s[4:7], m0 offen offset:1024 sc1 lds
  v_add_f32 v254, s62, v254
  v_rcp_f32 v254, v254
  s_nop 0
  v_mul_f32 v240, v240, v254
  v_mul_f32_e64 v241, v241, v254
  v_cvt_pk_bf16_f32 v80, v240, v241
  v_mfma_f32_32x32x16_bf16 a[224:239], v[72:75], v[140:143], a[224:239]
  v_mul_f32 v242, v242, v254
  v_mul_f32 v243, v243, v254
  v_cvt_pk_bf16_f32 v81, v242, v243
  v_mul_f32 v244, v244, v254
  v_mul_f32 v245, v245, v254
  v_cvt_pk_bf16_f32 v82, v244, v245
  v_mul_f32_e64 v246, v246, v254
  v_mfma_f32_32x32x16_bf16 v[160:175], v[152:155], v[96:99], 0
  s_add_u32 m0, s65, 24576
  s_nop 0
  buffer_load_dwordx4 v4, s[4:7], m0 offen offset:0 sc1 lds
  v_mul_f32 v247, v247, v254
  v_cvt_pk_bf16_f32 v83, v246, v247
  v_mul_f32 v248, v248, v254
  v_mul_f32 v249, v249, v254
  v_mfma_f32_32x32x16_bf16 v[160:175], v[156:159], v[100:103], v[160:175]
  v_cvt_pk_bf16_f32 v84, v248, v249
  v_mul_f32 v250, v250, v254
  v_mul_f32 v251, v251, v254
  v_cvt_pk_bf16_f32 v85, v250, v251
  v_mul_f32 v252, v252, v254
  v_mul_f32 v253, v253, v254
  v_cvt_pk_bf16_f32 v86, v252, v253
  v_mfma_f32_32x32x16_bf16 a[240:255], v[68:71], v[136:139], a[240:255]
  buffer_load_dwordx4 v4, s[4:7], m0 offen offset:1024 sc1 lds
  v_mfma_f32_32x32x16_bf16 a[240:255], v[76:79], v[140:143], a[240:255]
  v_mfma_f32_32x32x16_bf16 v[224:239], v[20:23], v[80:83], 0
  s_add_u32 s78, s76, 8192
  buffer_load_dwordx4 a[32:35], v1, s[4:7], s78 offen sc1
  v_add_f32 v174, s62, v174
  v_rcp_f32 v174, v174
  s_nop 0
  v_mul_f32 v160, v160, v174
  v_mul_f32_e64 v161, v161, v174
  v_mfma_f32_32x32x16_bf16 v[224:239], v[28:31], v[84:87], v[224:239]
  ds_write_b128 v186, a[224:227] offset:0
  v_cvt_pk_bf16_f32 v96, v160, v161
  v_mul_f32 v162, v162, v174
  v_mul_f32 v163, v163, v174
  v_cvt_pk_bf16_f32 v97, v162, v163
  v_mul_f32_e64 v164, v164, v174
  v_mul_f32 v165, v165, v174
  s_waitcnt vmcnt(11)
  v_mfma_f32_32x32x16_bf16 v[240:255], v[176:179], v[112:115], 0
  s_add_u32 s78, s77, 8192
  buffer_load_dwordx4 a[36:39], v1, s[4:7], s78 offen sc1
  v_cvt_pk_bf16_f32 v98, v164, v165
  v_mul_f32 v166, v166, v174
  v_mul_f32 v167, v167, v174
  v_cvt_pk_bf16_f32 v99, v166, v167
  v_mul_f32_e64 v168, v168, v174
  v_mfma_f32_32x32x16_bf16 v[240:255], v[180:183], v[116:119], v[240:255]
  ds_write_b128 v186, a[228:231] offset:1024
  v_mul_f32_e64 v169, v169, v174
  v_cvt_pk_bf16_f32 v100, v168, v169
  v_mul_f32 v170, v170, v174
  v_mul_f32 v171, v171, v174
  v_cvt_pk_bf16_f32 v101, v170, v171
  v_mul_f32 v172, v172, v174
  v_mul_f32 v173, v173, v174
  v_cvt_pk_bf16_f32 v102, v172, v173
  v_mfma_f32_32x32x16_bf16 v[224:239], v[36:39], v[96:99], v[224:239]
  s_add_u32 s78, s76, 10240
  buffer_load_dwordx4 a[40:43], v1, s[4:7], s78 offen sc1
  v_add_f32 v254, s62, v254
  v_rcp_f32 v254, v254
  s_nop 0
  v_mul_f32 v240, v240, v254
  v_mul_f32_e64 v241, v241, v254
  v_mfma_f32_32x32x16_bf16 v[224:239], v[44:47], v[100:103], v[224:239]
  ds_write_b128 v186, a[232:235] offset:2048
  v_cvt_pk_bf16_f32 v112, v240, v241
  v_mul_f32 v242, v242, v254
  v_mul_f32 v243, v243, v254
  v_cvt_pk_bf16_f32 v113, v242, v243
  v_mul_f32_e64 v244, v244, v254
  v_mul_f32 v245, v245, v254
  s_waitcnt vmcnt(11)
  v_mfma_f32_32x32x16_bf16 v[160:175], v[192:195], v[128:131], 0
  s_add_u32 s78, s77, 10240
  buffer_load_dwordx4 a[44:47], v1, s[4:7], s78 offen sc1
  v_cvt_pk_bf16_f32 v114, v244, v245
  v_mul_f32 v246, v246, v254
  v_mul_f32 v247, v247, v254
  v_cvt_pk_bf16_f32 v115, v246, v247
  v_mul_f32_e64 v248, v248, v254
  v_mfma_f32_32x32x16_bf16 v[160:175], v[196:199], v[132:135], v[160:175]
  ds_write_b128 v186, a[236:239] offset:3072
  v_mul_f32_e64 v249, v249, v254
  v_cvt_pk_bf16_f32 v116, v248, v249
  v_mul_f32 v250, v250, v254
  v_mul_f32 v251, v251, v254
  v_cvt_pk_bf16_f32 v117, v250, v251
  v_mul_f32 v252, v252, v254
  v_mul_f32 v253, v253, v254
  v_cvt_pk_bf16_f32 v118, v252, v253
  v_mfma_f32_32x32x16_bf16 v[224:239], v[52:55], v[112:115], v[224:239]
  s_add_u32 s78, s76, 12288
  buffer_load_dwordx4 a[48:51], v1, s[4:7], s78 offen sc1
  v_add_f32 v174, s62, v174
  v_rcp_f32 v174, v174
  s_nop 0
  v_mul_f32 v160, v160, v174
  v_mul_f32_e64 v161, v161, v174
  v_mfma_f32_32x32x16_bf16 v[224:239], v[60:63], v[116:119], v[224:239]
  ds_write_b128 v187, a[240:243] offset:0
  v_cvt_pk_bf16_f32 v128, v160, v161
  v_mul_f32 v162, v162, v174
  v_mul_f32 v163, v163, v174
  v_cvt_pk_bf16_f32 v129, v162, v163
  v_mul_f32 v164, v164, v174
  v_mul_f32 v165, v165, v174
  v_mfma_f32_32x32x16_bf16 v[208:223], v[16:19], v[80:83], v[208:223]
  s_add_u32 s78, s77, 12288
  buffer_load_dwordx4 a[52:55], v1, s[4:7], s78 offen sc1
  v_cvt_pk_bf16_f32 v130, v164, v165
  v_mul_f32 v166, v166, v174
  v_mul_f32 v167, v167, v174
  v_cvt_pk_bf16_f32 v131, v166, v167
  v_mul_f32_e64 v168, v168, v174
  v_mfma_f32_32x32x16_bf16 v[208:223], v[24:27], v[84:87], v[208:223]
  ds_write_b128 v187, a[244:247] offset:1024
  v_mul_f32_e64 v169, v169, v174
  v_cvt_pk_bf16_f32 v132, v168, v169
  v_mul_f32 v170, v170, v174
  v_mul_f32 v171, v171, v174
  v_cvt_pk_bf16_f32 v133, v170, v171
  v_mul_f32 v172, v172, v174
  v_mul_f32 v173, v173, v174
  v_cvt_pk_bf16_f32 v134, v172, v173
  v_mfma_f32_32x32x16_bf16 v[224:239], v[68:71], v[128:131], v[224:239]
  s_add_u32 s78, s76, 14336
  buffer_load_dwordx4 a[56:59], v1, s[4:7], s78 offen sc1
  v_mfma_f32_32x32x16_bf16 v[224:239], v[76:79], v[132:135], v[224:239]
  ds_write_b128 v187, a[248:251] offset:2048
  v_mfma_f32_32x32x16_bf16 v[208:223], v[32:35], v[96:99], v[208:223]
  s_add_u32 s78, s77, 14336
  buffer_load_dwordx4 a[60:63], v1, s[4:7], s78 offen sc1
  v_mfma_f32_32x32x16_bf16 v[208:223], v[40:43], v[100:103], v[208:223]
  ds_write_b128 v187, a[252:255] offset:3072
  v_mfma_f32_32x32x16_bf16 v[208:223], v[48:51], v[112:115], v[208:223]
  s_add_u32 s78, s76, 16384
  buffer_load_dwordx4 a[64:67], v1, s[4:7], s78 offen sc1
  v_mfma_f32_32x32x16_bf16 v[208:223], v[56:59], v[116:119], v[208:223]
  ds_write_b128 v185, v[224:227] offset:0
  v_mfma_f32_32x32x16_bf16 v[208:223], v[64:67], v[128:131], v[208:223]
  s_add_u32 s78, s77, 16384
  buffer_load_dwordx4 a[68:71], v1, s[4:7], s78 offen sc1
  ds_write_b128 v185, v[228:231] offset:1024
  v_mfma_f32_32x32x16_bf16 v[208:223], v[72:75], v[132:135], v[208:223]
  ds_write_b128 v185, v[232:235] offset:2048
  ds_write_b128 v185, v[236:239] offset:3072
  s_add_u32 m0, s65, 32768
  s_nop 0
  buffer_load_dwordx4 v4, s[4:7], m0 offen offset:0 sc1 lds
  buffer_load_dwordx4 v4, s[4:7], m0 offen offset:1024 sc1 lds
  s_add_u32 m0, s65, 40960
  s_nop 0
  buffer_load_dwordx4 v4, s[4:7], m0 offen offset:0 sc1 lds
  buffer_load_dwordx4 v4, s[4:7], m0 offen offset:1024 sc1 lds
  s_add_u32 m0, s65, 49152
  s_nop 0
  buffer_load_dwordx4 v4, s[4:7], m0 offen offset:0 sc1 lds
  buffer_load_dwordx4 v4, s[4:7], m0 offen offset:1024 sc1 lds
  s_add_u32 s78, s76, 18432
  buffer_load_dwordx4 a[72:75], v1, s[4:7], s78 offen sc1
  s_add_u32 s78, s77, 18432
  buffer_load_dwordx4 a[76:79], v1, s[4:7], s78 offen sc1
  s_waitcnt lgkmcnt(0)
  s_barrier
  ds_read_b128 v[80:83], v184 offset:0
  ds_read_b128 v[84:87], v184 offset:1024
  ds_read_b128 v[88:91], v184 offset:2048
  ds_read_b128 v[92:95], v184 offset:3072
  ds_read_b128 v[96:99], v184 offset:4096
  ds_read_b128 v[100:103], v184 offset:5120
  ds_read_b128 v[104:107], v184 offset:6144
  ds_read_b128 v[108:111], v184 offset:7168
  ds_read_b128 v[112:115], v184 offset:8192
  ds_read_b128 v[116:119], v184 offset:9216
  ds_read_b128 v[120:123], v184 offset:10240
  ds_read_b128 v[124:127], v184 offset:11264
  s_add_u32 s86, s97, 3145728
  s_add_u32 s87, s98, 262144
  s_add_u32 s96, s99, 131072
  v_mov_b32 v160, 0
  v_mov_b32 v161, 0
  s_waitcnt lgkmcnt(8)
  v_pk_add_f32 v[208:209], v[208:209], v[80:81]
  v_pk_add_f32 v[210:211], v[210:211], v[82:83]
  v_pk_add_f32 v[212:213], v[212:213], v[84:85]
  v_pk_add_f32 v[214:215], v[214:215], v[86:87]
  v_pk_add_f32 v[216:217], v[216:217], v[88:89]
  v_pk_add_f32 v[218:219], v[218:219], v[90:91]
  v_pk_add_f32 v[220:221], v[220:221], v[92:93]
  v_pk_add_f32 v[222:223], v[222:223], v[94:95]
  s_waitcnt lgkmcnt(4)
  v_pk_add_f32 v[208:209], v[208:209], v[96:97]
  v_pk_add_f32 v[210:211], v[210:211], v[98:99]
  v_pk_add_f32 v[212:213], v[212:213], v[100:101]
  v_pk_add_f32 v[214:215], v[214:215], v[102:103]
  v_pk_add_f32 v[216:217], v[216:217], v[104:105]
  v_pk_add_f32 v[218:219], v[218:219], v[106:107]
  v_pk_add_f32 v[220:221], v[220:221], v[108:109]
  v_pk_add_f32 v[222:223], v[222:223], v[110:111]
  s_waitcnt lgkmcnt(0)
  v_pk_add_f32 v[208:209], v[208:209], v[112:113]
  v_pk_add_f32 v[210:211], v[210:211], v[114:115]
  v_pk_add_f32 v[212:213], v[212:213], v[116:117]
  v_pk_add_f32 v[214:215], v[214:215], v[118:119]
  v_pk_add_f32 v[216:217], v[216:217], v[120:121]
  v_pk_add_f32 v[218:219], v[218:219], v[122:123]
  v_pk_add_f32 v[220:221], v[220:221], v[124:125]
  v_pk_add_f32 v[222:223], v[222:223], v[126:127]
  v_cvt_pk_bf16_f32 v8, v208, v209
  v_cvt_pk_bf16_f32 v9, v210, v211
  v_cvt_pk_bf16_f32 v10, v212, v213
  v_cvt_pk_bf16_f32 v11, v214, v215
  v_cvt_pk_bf16_f32 v12, v216, v217
  v_cvt_pk_bf16_f32 v13, v218, v219
  v_cvt_pk_bf16_f32 v14, v220, v221
  v_cvt_pk_bf16_f32 v15, v222, v223
  buffer_store_dwordx4 v[8:11], v1, s[44:47], s86 offen
  buffer_store_dwordx4 v[12:15], v1, s[44:47], s86 offen offset:1024
  v_dot2c_f32_bf16 v160, s84, v8
  v_dot2c_f32_bf16 v161, v8, v8
  v_dot2c_f32_bf16 v160, s84, v9
  v_dot2c_f32_bf16 v161, v9, v9
  v_dot2c_f32_bf16 v160, s84, v10
  v_dot2c_f32_bf16 v161, v10, v10
  v_dot2c_f32_bf16 v160, s84, v11
  v_dot2c_f32_bf16 v161, v11, v11
  v_dot2c_f32_bf16 v160, s84, v12
  v_dot2c_f32_bf16 v161, v12, v12
  v_dot2c_f32_bf16 v160, s84, v13
  v_dot2c_f32_bf16 v161, v13, v13
  v_dot2c_f32_bf16 v160, s84, v14
  v_dot2c_f32_bf16 v161, v14, v14
  v_dot2c_f32_bf16 v160, s84, v15
  v_dot2c_f32_bf16 v161, v15, v15
  s_nop 1
  v_mov_b32 v162, v160
  v_mov_b32 v163, v161
  s_nop 0
  v_permlane32_swap_b32 v160, v162
  v_permlane32_swap_b32 v161, v163
  v_pk_add_f32 v[160:161], v[160:161], v[162:163]
  s_mov_b32 exec_hi, 0
  buffer_store_dwordx2 v[160:161], v1, s[44:47], s87 offen
  s_mov_b64 exec, -1
  v_and_b32 v240, 15, v0
  v_min_u32 v240, 13, v240
  v_lshlrev_b32 v240, 5, v240
  s_lshl_b32 s88, s56, 9
  s_add_u32 s88, s88, 131072
  s_lshl_b32 s89, s56, 12
  s_add_u32 s89, s89, 262144
  s_mul_i32 s90, s56, 28672
  s_add_u32 s90, s90, 3145728
  s_add_u32 s86, s68, 0xe000
  v_add_u32 v229, s86, v1
  s_add_u32 s86, s68, 0xac00
  v_add_u32 v228, s86, v1
  v_add_u32 v243, s67, v1
  s_mul_i32 s73, s56, 114688
  s_mul_i32 s86, s50, 7168
  s_add_u32 s73, s73, s86
  s_add_u32 s73, s73, 7340032
  s_add_u32 s74, s73, 4096
  s_lshl_b32 s94, s56, 9
  s_lshl_b32 s86, s50, 2
  s_add_u32 s94, s94, s86
  s_add_u32 s94, s94, 196608
  s_waitcnt vmcnt(0)
  v_mov_b32_e64 v254, 1
  s_mov_b64 exec, 1
  buffer_store_dword v254, off, s[40:43], s96 offset:0
  s_mov_b64 exec, -1
L_p2skip0:
  s_waitcnt lgkmcnt(0)
  s_barrier
  ds_read_b128 v[192:195], v2 offset:40960
  ds_read_b128 v[196:199], v2 offset:41984
  ds_read_b128 v[200:203], v2 offset:43008
  ds_read_b128 v[204:207], v2 offset:44032
  ds_read_b128 v[208:211], v2 offset:45056
  ds_read_b128 v[212:215], v2 offset:46080
Lpoll_18:
  buffer_load_dword v254, v240, s[40:43], s88 offen offset:0 sc1
  s_sub_u32 s54, s54, 1
  s_max_i32 s54, s54, 0
  s_cselect_b64 s[92:93], exec, 0
  s_waitcnt vmcnt(0)
  v_cmp_ne_u32 vcc, 1, v254
  s_nop 0
  s_and_b64 exec, s[92:93], vcc
  s_cbranch_scc1 Lpoll_18
  s_mov_b64 exec, -1
  buffer_load_dwordx4 v[16:19], v1, s[44:47], s90 offen offset:0 sc1
  buffer_load_dwordx4 v[20:23], v1, s[44:47], s90 offen offset:1024 sc1
  buffer_load_dwordx4 v[24:27], v1, s[44:47], s90 offen offset:2048 sc1
  buffer_load_dwordx4 v[28:31], v1, s[44:47], s90 offen offset:3072 sc1
  s_add_u32 s90, s90, 4096
  buffer_load_dwordx4 v[32:35], v1, s[44:47], s90 offen offset:0 sc1
  buffer_load_dwordx4 v[36:39], v1, s[44:47], s90 offen offset:1024 sc1
  buffer_load_dwordx4 v[40:43], v1, s[44:47], s90 offen offset:2048 sc1
  buffer_load_dwordx4 v[44:47], v1, s[44:47], s90 offen offset:3072 sc1
  s_waitcnt vmcnt(7) lgkmcnt(4)
  v_mfma_f32_32x32x16_bf16 v[128:143], v[192:195], v[16:19], 0
  ds_read_b128 v[216:219], v2 offset:47104
  s_add_u32 s90, s90, 4096
  buffer_load_dwordx4 v[48:51], v1, s[44:47], s90 offen offset:0 sc1
  v_mfma_f32_32x32x16_bf16 v[144:159], v[196:199], v[16:19], 0
  ds_read_b128 v[220:223], v2 offset:48128
  s_waitcnt vmcnt(7) lgkmcnt(4)
  v_mfma_f32_32x32x16_bf16 v[160:175], v[200:203], v[16:19], 0
  ds_read_b128 v[192:195], v2 offset:49152
  buffer_load_dwordx4 v[176:179], v1, s[44:47], s89 offen offset:0 sc1
  v_mfma_f32_32x32x16_bf16 v[128:143], v[204:207], v[20:23], v[128:143]
  ds_read_b128 v[196:199], v2 offset:50176
  buffer_load_dwordx4 v[52:55], v1, s[44:47], s90 offen offset:1024 sc1
  s_waitcnt lgkmcnt(4)
  v_mfma_f32_32x32x16_bf16 v[144:159], v[208:211], v[20:23], v[144:159]
  ds_read_b128 v[200:203], v2 offset:51200
  v_mfma_f32_32x32x16_bf16 v[160:175], v[212:215], v[20:23], v[160:175]
  ds_read_b128 v[204:207], v2 offset:52224
  s_waitcnt vmcnt(8) lgkmcnt(4)
  v_mfma_f32_32x32x16_bf16 v[128:143], v[216:219], v[24:27], v[128:143]
  ds_read_b128 v[208:211], v2 offset:53248
  buffer_load_dwordx4 v[56:59], v1, s[44:47], s90 offen offset:2048 sc1
  v_mfma_f32_32x32x16_bf16 v[144:159], v[220:223], v[24:27], v[144:159]
  ds_read_b128 v[212:215], v2 offset:54272
  s_waitcnt vmcnt(8) lgkmcnt(4)
  v_mfma_f32_32x32x16_bf16 v[160:175], v[192:195], v[24:27], v[160:175]
  ds_read_b128 v[216:219], v2 offset:55296
  buffer_load_dwordx4 v[180:183], v1, s[44:47], s89 offen offset:1024 sc1
  v_mfma_f32_32x32x16_bf16 v[128:143], v[196:199], v[28:31], v[128:143]
  ds_read_b128 v[220:223], v2 offset:56320
  buffer_load_dwordx4 v[60:63], v1, s[44:47], s90 offen offset:3072 sc1
  s_waitcnt lgkmcnt(4)
  v_mfma_f32_32x32x16_bf16 v[144:159], v[200:203], v[28:31], v[144:159]
  ds_read_b128 v[192:195], v2 offset:57344
  v_mfma_f32_32x32x16_bf16 v[160:175], v[204:207], v[28:31], v[160:175]
  ds_read_b128 v[196:199], v2 offset:58368
  s_waitcnt vmcnt(9) lgkmcnt(4)
  v_mfma_f32_32x32x16_bf16 v[128:143], v[208:211], v[32:35], v[128:143]
  ds_read_b128 v[200:203], v2 offset:59392
  s_add_u32 s90, s90, 4096
  buffer_load_dwordx4 v[64:67], v1, s[44:47], s90 offen offset:0 sc1
  v_mfma_f32_32x32x16_bf16 v[144:159], v[212:215], v[32:35], v[144:159]
  ds_read_b128 v[204:207], v2 offset:60416
  s_waitcnt vmcnt(9) lgkmcnt(4)
  v_mfma_f32_32x32x16_bf16 v[160:175], v[216:219], v[32:35], v[160:175]
  ds_read_b128 v[208:211], v2 offset:61440
  buffer_load_dwordx4 v[184:187], v1, s[44:47], s89 offen offset:2048 sc1
  v_mfma_f32_32x32x16_bf16 v[128:143], v[220:223], v[36:39], v[128:143]
  ds_read_b128 v[212:215], v2 offset:62464
  buffer_load_dwordx4 v[68:71], v1, s[44:47], s90 offen offset:1024 sc1
  s_waitcnt lgkmcnt(4)
  v_mfma_f32_32x32x16_bf16 v[144:159], v[192:195], v[36:39], v[144:159]
  ds_read_b128 v[216:219], v2 offset:63488
  v_mfma_f32_32x32x16_bf16 v[160:175], v[196:199], v[36:39], v[160:175]
  ds_read_b128 v[220:223], v2 offset:64512
  s_waitcnt vmcnt(10) lgkmcnt(4)
  v_mfma_f32_32x32x16_bf16 v[128:143], v[200:203], v[40:43], v[128:143]
  ds_read_b128 v[192:195], v3 offset:0
  buffer_load_dwordx4 v[72:75], v1, s[44:47], s90 offen offset:2048 sc1
  v_mfma_f32_32x32x16_bf16 v[144:159], v[204:207], v[40:43], v[144:159]
  ds_read_b128 v[196:199], v3 offset:1024
  s_waitcnt vmcnt(10) lgkmcnt(4)
  v_mfma_f32_32x32x16_bf16 v[160:175], v[208:211], v[40:43], v[160:175]
  ds_read_b128 v[200:203], v3 offset:2048
  buffer_load_dwordx4 v[188:191], v1, s[44:47], s89 offen offset:3072 sc1
  v_mfma_f32_32x32x16_bf16 v[128:143], v[212:215], v[44:47], v[128:143]
  ds_read_b128 v[204:207], v3 offset:3072
  buffer_load_dwordx4 v[76:79], v1, s[44:47], s90 offen offset:3072 sc1
  s_waitcnt lgkmcnt(4)
  v_mfma_f32_32x32x16_bf16 v[144:159], v[216:219], v[44:47], v[144:159]
  ds_read_b128 v[208:211], v3 offset:4096
  v_mfma_f32_32x32x16_bf16 v[160:175], v[220:223], v[44:47], v[160:175]
  ds_read_b128 v[212:215], v3 offset:5120
  s_waitcnt vmcnt(11) lgkmcnt(4)
  v_mfma_f32_32x32x16_bf16 v[128:143], v[192:195], v[48:51], v[128:143]
  ds_read_b128 v[216:219], v3 offset:6144
  s_add_u32 s90, s90, 4096
  buffer_load_dwordx4 v[80:83], v1, s[44:47], s90 offen offset:0 sc1
  v_mfma_f32_32x32x16_bf16 v[144:159], v[196:199], v[48:51], v[144:159]
  ds_read_b128 v[220:223], v3 offset:7168
  s_waitcnt vmcnt(10) lgkmcnt(4)
  v_mfma_f32_32x32x16_bf16 v[160:175], v[200:203], v[48:51], v[160:175]
  s_add_u32 m0, s64, 57344
  ds_read_b128 v[192:195], v3 offset:8192
  buffer_load_dwordx4 v229, s[4:7], m0 offen offset:0 sc1 lds
  v_mfma_f32_32x32x16_bf16 v[128:143], v[204:207], v[52:55], v[128:143]
  ds_read_b128 v[196:199], v3 offset:9216
  buffer_load_dwordx4 v[84:87], v1, s[44:47], s90 offen offset:1024 sc1
  s_waitcnt lgkmcnt(4)
  v_mfma_f32_32x32x16_bf16 v[144:159], v[208:211], v[52:55], v[144:159]
  ds_read_b128 v[200:203], v3 offset:10240
  v_mfma_f32_32x32x16_bf16 v[160:175], v[212:215], v[52:55], v[160:175]
  ds_read_b128 v[204:207], v3 offset:11264
  s_waitcnt vmcnt(11) lgkmcnt(4)
  v_mfma_f32_32x32x16_bf16 v[128:143], v[216:219], v[56:59], v[128:143]
  ds_read_b128 v[208:211], v3 offset:12288
  buffer_load_dwordx4 v[88:91], v1, s[44:47], s90 offen offset:2048 sc1
  v_mfma_f32_32x32x16_bf16 v[144:159], v[220:223], v[56:59], v[144:159]
  ds_read_b128 v[212:215], v3 offset:13312
  s_waitcnt vmcnt(10) lgkmcnt(4)
  v_mfma_f32_32x32x16_bf16 v[160:175], v[192:195], v[56:59], v[160:175]
  s_add_u32 m0, s64, 61440
  ds_read_b128 v[216:219], v3 offset:14336
  buffer_load_dwordx4 v229, s[4:7], m0 offen offset:0 sc1 lds
  v_mfma_f32_32x32x16_bf16 v[128:143], v[196:199], v[60:63], v[128:143]
  ds_read_b128 v[220:223], v3 offset:15360
  buffer_load_dwordx4 v[92:95], v1, s[44:47], s90 offen offset:3072 sc1
  s_waitcnt lgkmcnt(4)
  v_mfma_f32_32x32x16_bf16 v[144:159], v[200:203], v[60:63], v[144:159]
  ds_read_b128 v[192:195], v3 offset:16384
  v_mfma_f32_32x32x16_bf16 v[160:175], v[204:207], v[60:63], v[160:175]
  ds_read_b128 v[196:199], v3 offset:17408
  s_waitcnt vmcnt(11) lgkmcnt(4)
  v_mfma_f32_32x32x16_bf16 v[128:143], v[208:211], v[64:67], v[128:143]
  ds_read_b128 v[200:203], v3 offset:18432
  s_add_u32 s90, s90, 4096
  buffer_load_dwordx4 v[96:99], v1, s[44:47], s90 offen offset:0 sc1
  v_mfma_f32_32x32x16_bf16 v[144:159], v[212:215], v[64:67], v[144:159]
  ds_read_b128 v[204:207], v3 offset:19456
  s_waitcnt vmcnt(10) lgkmcnt(4)
  v_mfma_f32_32x32x16_bf16 v[160:175], v[216:219], v[64:67], v[160:175]
  s_add_u32 m0, s64, 65536
  ds_read_b128 v[208:211], v3 offset:20480
  buffer_load_dwordx4 v229, s[4:7], m0 offen offset:0 sc1 lds
  v_mfma_f32_32x32x16_bf16 v[128:143], v[220:223], v[68:71], v[128:143]
  ds_read_b128 v[212:215], v3 offset:21504
  buffer_load_dwordx4 v[100:103], v1, s[44:47], s90 offen offset:1024 sc1
  s_waitcnt lgkmcnt(4)
  v_mfma_f32_32x32x16_bf16 v[144:159], v[192:195], v[68:71], v[144:159]
  ds_read_b128 v[216:219], v3 offset:22528
  v_mfma_f32_32x32x16_bf16 v[160:175], v[196:199], v[68:71], v[160:175]
  ds_read_b128 v[220:223], v3 offset:23552
  s_waitcnt vmcnt(11) lgkmcnt(4)
  v_mfma_f32_32x32x16_bf16 v[128:143], v[200:203], v[72:75], v[128:143]
  ds_read_b128 v[192:195], v3 offset:24576
  buffer_load_dwordx4 v[104:107], v1, s[44:47], s90 offen offset:2048 sc1
  v_mfma_f32_32x32x16_bf16 v[144:159], v[204:207], v[72:75], v[144:159]
  ds_read_b128 v[196:199], v3 offset:25600
  s_waitcnt vmcnt(10) lgkmcnt(4)
  v_mfma_f32_32x32x16_bf16 v[160:175], v[208:211], v[72:75], v[160:175]
  s_add_u32 m0, s64, 69632
  ds_read_b128 v[200:203], v3 offset:26624
  buffer_load_dwordx4 v229, s[4:7], m0 offen offset:0 sc1 lds
  v_mfma_f32_32x32x16_bf16 v[128:143], v[212:215], v[76:79], v[128:143]
  ds_read_b128 v[204:207], v3 offset:27648
  buffer_load_dwordx4 v[108:111], v1, s[44:47], s90 offen offset:3072 sc1
  s_and_b32 s86, s64, 0x400
  v_add_u32 v240, s86, v1
  v_xor_b32 v241, 0x400, v240
  v_add_f32 v176, v176, v178
  s_waitcnt lgkmcnt(4)
  v_mfma_f32_32x32x16_bf16 v[144:159], v[216:219], v[76:79], v[144:159]
  ds_read_b128 v[208:211], v3 offset:28672
  v_add_f32 v177, v177, v179
  v_add_f32 v176, v176, v180
  v_add_f32 v177, v177, v181
  v_add_f32 v176, v176, v182
  v_add_f32 v177, v177, v183
  v_add_f32 v176, v176, v184
  v_mfma_f32_32x32x16_bf16 v[160:175], v[220:223], v[76:79], v[160:175]
  ds_read_b128 v[212:215], v3 offset:29696
  v_add_f32 v177, v177, v185
  v_add_f32 v176, v176, v186
  v_add_f32 v177, v177, v187
  v_add_f32 v176, v176, v188
  v_add_f32 v177, v177, v189
  s_waitcnt vmcnt(11) lgkmcnt(4)
  v_mfma_f32_32x32x16_bf16 v[128:143], v[192:195], v[80:83], v[128:143]
  ds_read_b128 v[216:219], v3 offset:30720
  s_add_u32 s90, s90, 4096
  buffer_load_dwordx4 v[112:115], v1, s[44:47], s90 offen offset:0 sc1
  v_mov_b32_e64 v178, v176
  v_mov_b32 v179, v177
  s_nop 0
  v_permlane32_swap_b32 v176, v178
  v_permlane32_swap_b32 v177, v179
  v_mfma_f32_32x32x16_bf16 v[144:159], v[196:199], v[80:83], v[144:159]
  ds_read_b128 v[220:223], v3 offset:31744
  v_add_f32 v176, v176, v178
  v_add_f32 v177, v177, v179
  v_mul_f32 v176, 0x3b124925, v176
  v_mul_f32 v177, 0x3b124925, v177
  v_fma_f32 v177, -v176, v176, v177
  s_waitcnt vmcnt(10) lgkmcnt(4)
  v_mfma_f32_32x32x16_bf16 v[160:175], v[200:203], v[80:83], v[160:175]
  s_add_u32 m0, s64, 73728
  ds_read_b128 v[192:195], v1 offset:0
  buffer_load_dwordx4 v229, s[4:7], m0 offen offset:0 sc1 lds
  v_max_f32 v177, 0, v177
  v_add_f32 v177, 0x3727c5ac, v177
  v_rsq_f32_e64 v248, v177
  v_mfma_f32_32x32x16_bf16 v[128:143], v[204:207], v[84:87], v[128:143]
  ds_read_b128 v[196:199], v1 offset:1024
  buffer_load_dwordx4 v[116:119], v1, s[44:47], s90 offen offset:1024 sc1
  v_cvt_pk_bf16_f32 v224, -v176, -v176
  v_mul_f32_e64 v250, v177, v248
  v_mul_f32 v249, 0x3fb8aa3b, v248
  v_mov_b32 v225, v224
  s_waitcnt lgkmcnt(4)
  v_mfma_f32_32x32x16_bf16 v[144:159], v[208:211], v[84:87], v[144:159]
  ds_read_b128 v[200:203], v1 offset:2048
  v_mov_b32 v226, v224
  v_mov_b32 v227, v224
  v_and_b32 v244, 3, v0
  v_lshlrev_b32 v244, 2, v244
  v_bfe_u32 v245, v0, 2, 1
  v_lshl_add_u32 v244, v245, 9, v244
  v_mfma_f32_32x32x16_bf16 v[160:175], v[212:215], v[84:87], v[160:175]
  ds_read_b128 v[204:207], v1 offset:3072
  s_lshl_b32 s86, s57, 9
  s_lshl_b32 s87, s48, 4
  s_add_u32 s86, s86, s87
  s_add_u32 s85, s86, 196608
  v_add_u32_e64 v244, s85, v244
  s_waitcnt vmcnt(11) lgkmcnt(4)
  v_mfma_f32_32x32x16_bf16 v[128:143], v[216:219], v[88:91], v[128:143]
  ds_read_b128 v[208:211], v1 offset:4096
  buffer_load_dwordx4 v[120:123], v1, s[44:47], s90 offen offset:2048 sc1
  s_mul_i32 s87, s48, 28672
  s_add_u32 s87, s87, 7340032
  s_mul_i32 s86, s58, 114688
  s_add_u32 s86, s86, s87
  v_add_u32 v245, s86, v1
  v_mfma_f32_32x32x16_bf16 v[144:159], v[220:223], v[88:91], v[144:159]
  ds_read_b128 v[212:215], v1 offset:5120
  s_xor_b32 s86, s58, 1
  s_mul_i32 s86, s86, 114688
  s_add_u32 s86, s86, s87
  v_add_u32_e64 v246, s86, v1
  s_waitcnt vmcnt(10) lgkmcnt(4)
  s_barrier
  v_mfma_f32_32x32x16_bf16 v[160:175], v[192:195], v[88:91], v[160:175]
  s_add_u32 m0, s64, 77824
  ds_read_b128 v[216:219], v1 offset:6144
  buffer_load_dwordx4 v229, s[4:7], m0 offen offset:0 sc1 lds
  v_mfma_f32_32x32x16_bf16 v[128:143], v[196:199], v[92:95], v[128:143]
  ds_read_b128 v[220:223], v1 offset:7168
  buffer_load_dwordx4 v[124:127], v1, s[44:47], s90 offen offset:3072 sc1
  s_waitcnt lgkmcnt(4)
  v_mfma_f32_32x32x16_bf16 v[144:159], v[200:203], v[92:95], v[144:159]
  ds_read_b128 v[192:195], v1 offset:8192
  v_mfma_f32_32x32x16_bf16 v[160:175], v[204:207], v[92:95], v[160:175]
  ds_read_b128 v[196:199], v1 offset:9216
  s_waitcnt vmcnt(11) lgkmcnt(4)
  v_mfma_f32_32x32x16_bf16 v[128:143], v[208:211], v[96:99], v[128:143]
  s_add_u32 m0, s64, 81920
  ds_read_b128 v[200:203], v1 offset:10240
  buffer_load_dwordx4 v229, s[4:7], m0 offen offset:0 sc1 lds
  v_mfma_f32_32x32x16_bf16 v[144:159], v[212:215], v[96:99], v[144:159]
  ds_read_b128 v[204:207], v1 offset:11264
  s_waitcnt vmcnt(10) lgkmcnt(4)
  v_mfma_f32_32x32x16_bf16 v[160:175], v[216:219], v[96:99], v[160:175]
  s_add_u32 m0, s64, 86016
  ds_read_b128 v[208:211], v1 offset:12288
  buffer_load_dwordx4 v229, s[4:7], m0 offen offset:0 sc1 lds
  v_mfma_f32_32x32x16_bf16 v[128:143], v[220:223], v[100:103], v[128:143]
  ds_read_b128 v[212:215], v1 offset:13312
  s_waitcnt lgkmcnt(4)
  v_mfma_f32_32x32x16_bf16 v[144:159], v[192:195], v[100:103], v[144:159]
  s_add_u32 m0, s64, 90112
  ds_read_b128 v[216:219], v1 offset:14336
  buffer_load_dwordx4 v229, s[4:7], m0 offen offset:0 sc1 lds
  v_mfma_f32_32x32x16_bf16 v[160:175], v[196:199], v[100:103], v[160:175]
  ds_read_b128 v[220:223], v1 offset:15360
  s_waitcnt vmcnt(11) lgkmcnt(4)
  v_mfma_f32_32x32x16_bf16 v[128:143], v[200:203], v[104:107], v[128:143]
  s_add_u32 m0, s65, 106496
  ds_read_b128 v[192:195], v1 offset:16384
  buffer_load_dwordx4 v228, s[4:7], m0 offen offset:0 sc1 lds
  v_mfma_f32_32x32x16_bf16 v[144:159], v[204:207], v[104:107], v[144:159]
  ds_read_b128 v[196:199], v1 offset:17408
  s_waitcnt vmcnt(10) lgkmcnt(4)
  v_mfma_f32_32x32x16_bf16 v[160:175], v[208:211], v[104:107], v[160:175]
  ds_read_b128 v[200:203], v1 offset:18432
  buffer_load_dwordx4 v228, s[4:7], m0 offen offset:1024 sc1 lds
  v_mfma_f32_32x32x16_bf16 v[128:143], v[212:215], v[108:111], v[128:143]
  ds_read_b128 v[204:207], v1 offset:19456
  s_waitcnt lgkmcnt(4)
  v_mfma_f32_32x32x16_bf16 v[144:159], v[216:219], v[108:111], v[144:159]
  s_add_u32 m0, s65, 114688
  ds_read_b128 v[208:211], v1 offset:20480
  buffer_load_dwordx4 v228, s[4:7], m0 offen offset:0 sc1 lds
  v_mfma_f32_32x32x16_bf16 v[160:175], v[220:223], v[108:111], v[160:175]
  ds_read_b128 v[212:215], v1 offset:21504
  s_waitcnt vmcnt(11) lgkmcnt(4)
  v_mfma_f32_32x32x16_bf16 v[128:143], v[192:195], v[112:115], v[128:143]
  ds_read_b128 v[216:219], v1 offset:22528
  buffer_load_dwordx4 v228, s[4:7], m0 offen offset:1024 sc1 lds
  v_mfma_f32_32x32x16_bf16 v[144:159], v[196:199], v[112:115], v[144:159]
  ds_read_b128 v[220:223], v1 offset:23552
  s_waitcnt vmcnt(10) lgkmcnt(4)
  v_mfma_f32_32x32x16_bf16 v[160:175], v[200:203], v[112:115], v[160:175]
  s_add_u32 m0, s65, 122880
  ds_read_b128 v[192:195], v1 offset:24576
  buffer_load_dwordx4 v228, s[4:7], m0 offen offset:0 sc1 lds
  v_mfma_f32_32x32x16_bf16 v[128:143], v[204:207], v[116:119], v[128:143]
  ds_read_b128 v[196:199], v1 offset:25600
  s_waitcnt lgkmcnt(4)
  v_mfma_f32_32x32x16_bf16 v[144:159], v[208:211], v[116:119], v[144:159]
  ds_read_b128 v[200:203], v1 offset:26624
  buffer_load_dwordx4 v228, s[4:7], m0 offen offset:1024 sc1 lds
  v_mfma_f32_32x32x16_bf16 v[160:175], v[212:215], v[116:119], v[160:175]
  ds_read_b128 v[204:207], v1 offset:27648
  s_waitcnt vmcnt(11) lgkmcnt(4)
  v_mfma_f32_32x32x16_bf16 v[128:143], v[216:219], v[120:123], v[128:143]
  s_add_u32 m0, s65, 131072
  v_add_u32 v251, 0x7000, v5
  ds_read2_b32 v[208:209], v251 offset0:0 offset1:32
  ds_read2_b32 v[210:211], v251 offset0:64 offset1:96
  buffer_load_dwordx4 v228, s[4:7], m0 offen offset:0 sc1 lds
  v_mfma_f32_32x32x16_bf16 v[144:159], v[220:223], v[120:123], v[144:159]
  v_add_u32 v252, 0x7400, v5
  ds_read2_b32 v[212:213], v252 offset0:0 offset1:32
  ds_read2_b32 v[214:215], v252 offset0:64 offset1:96
  s_waitcnt vmcnt(10) lgkmcnt(6)
  v_mfma_f32_32x32x16_bf16 v[160:175], v[192:195], v[120:123], v[160:175]
  v_add_u32 v253, 0x7800, v5
  ds_read2_b32 v[216:217], v253 offset0:0 offset1:32
  ds_read2_b32 v[218:219], v253 offset0:64 offset1:96
  buffer_load_dwordx4 v228, s[4:7], m0 offen offset:1024 sc1 lds
  v_mfma_f32_32x32x16_bf16 v[128:143], v[196:199], v[124:127], v[128:143]
  ds_read_b128 v[220:223], v1 offset:31744
  s_waitcnt lgkmcnt(7)
  v_mfma_f32_32x32x16_bf16 v[144:159], v[200:203], v[124:127], v[144:159]
  s_add_u32 m0, s65, 139264
  ds_read_b128 v[192:195], v1 offset:32768
  buffer_load_dwordx4 v228, s[4:7], m0 offen offset:0 sc1 lds
  v_mfma_f32_32x32x16_bf16 v[160:175], v[204:207], v[124:127], v[160:175]
  ds_read_b128 v[196:199], v1 offset:33792
  s_waitcnt lgkmcnt(5)
  v_mfma_f32_32x32x16_bf16 v[128:143], v[208:211], v[224:227], v[128:143]
  ds_read_b128 v[200:203], v1 offset:34816
  buffer_load_dwordx4 v228, s[4:7], m0 offen offset:1024 sc1 lds
  v_mfma_f32_32x32x16_bf16 v[144:159], v[212:215], v[224:227], v[144:159]
  ds_read_b128 v[204:207], v1 offset:35840
  s_waitcnt lgkmcnt(4)
  v_mfma_f32_32x32x16_bf16 v[160:175], v[216:219], v[224:227], v[160:175]
  s_add_u32 m0, s65, 147456
  ds_read_b128 v[208:211], v1 offset:36864
  buffer_load_dwordx4 v228, s[4:7], m0 offen offset:0 sc1 lds
  v_mul_f32 v128, v128, v249
  v_mul_f32 v129, v129, v249
  v_mul_f32 v130, v130, v249
  v_mul_f32_e64 v131, v131, v249
  v_mfma_f32_32x32x16_bf16 v[176:191], v[220:223], v[16:19], 0
  ds_read_b128 v[212:215], v1 offset:37888
  v_mul_f32 v132, v132, v249
  v_mul_f32 v133, v133, v249
  v_mul_f32_e64 v134, v134, v249
  v_mul_f32 v135, v135, v249
  s_waitcnt lgkmcnt(4)
  v_mfma_f32_32x32x16_bf16 v[176:191], v[192:195], v[20:23], v[176:191]
  ds_read_b128 v[216:219], v1 offset:38912
  buffer_load_dwordx4 v228, s[4:7], m0 offen offset:1024 sc1 lds
  v_exp_f32_e64 v128, -v128
  v_exp_f32_e64 v129, -v129
  v_mfma_f32_32x32x16_bf16 v[176:191], v[196:199], v[24:27], v[176:191]
  ds_read_b128 v[220:223], v1 offset:39936
  v_exp_f32_e64 v130, -v130
  v_fma_f32 v128, v128, v250, v250
  v_exp_f32_e64 v131, -v131
  s_waitcnt lgkmcnt(4)
  v_mfma_f32_32x32x16_bf16 v[176:191], v[200:203], v[28:31], v[176:191]
  s_add_u32 m0, s65, 155648
  ds_read_b128 v[192:195], v1 offset:40960
  buffer_load_dwordx4 v228, s[4:7], m0 offen offset:0 sc1 lds
  v_fma_f32 v129, v129, v250, v250
  v_exp_f32_e64 v132, -v132
  v_fma_f32 v130, v130, v250, v250
  v_mfma_f32_32x32x16_bf16 v[176:191], v[204:207], v[32:35], v[176:191]
  ds_read_b128 v[196:199], v1 offset:41984
  v_exp_f32_e64 v133, -v133
  v_fma_f32 v131, v131, v250, v250
  v_exp_f32_e64 v134, -v134
  s_waitcnt lgkmcnt(4)
  v_mfma_f32_32x32x16_bf16 v[176:191], v[208:211], v[36:39], v[176:191]
  ds_read_b128 v[200:203], v1 offset:43008
  buffer_load_dwordx4 v228, s[4:7], m0 offen offset:1024 sc1 lds
  v_fma_f32 v132, v132, v250, v250
  v_exp_f32_e64 v135, -v135
  v_fma_f32 v133, v133, v250, v250
  v_fma_f32 v134, v134, v250, v250
  v_mfma_f32_32x32x16_bf16 v[176:191], v[212:215], v[40:43], v[176:191]
  ds_read_b128 v[204:207], v1 offset:44032
  v_fma_f32 v135, v135, v250, v250
  v_rcp_f32_e64 v128, v128
  v_rcp_f32 v129, v129
  s_waitcnt lgkmcnt(4)
  v_mfma_f32_32x32x16_bf16 v[176:191], v[216:219], v[44:47], v[176:191]
  v_and_b32 v232, 3, v0
  v_lshlrev_b32 v232, 7, v232
  ds_read_b128 v[208:211], v1 offset:45056
  global_load_dword v233, v232, s[100:101]
  v_rcp_f32 v130, v130
  v_mul_f32 v128, v128, v136
  v_mfma_f32_32x32x16_bf16 v[176:191], v[220:223], v[48:51], v[176:191]
  ds_read_b128 v[212:215], v1 offset:46080
  v_rcp_f32 v131, v131
  v_mul_f32 v129, v129, v137
  v_rcp_f32 v132, v132
  s_waitcnt lgkmcnt(4)
  v_mfma_f32_32x32x16_bf16 v[176:191], v[192:195], v[52:55], v[176:191]
  s_add_u32 s91, s70, 20480
  ds_read_b128 v[216:219], v1 offset:47104
  buffer_load_dwordx4 a[80:83], v240, s[4:7], s91 offen offset:0 sc1
  v_mul_f32 v130, v130, v138
  v_rcp_f32 v133, v133
  v_mul_f32_e64 v131, v131, v139
  v_mfma_f32_32x32x16_bf16 v[176:191], v[196:199], v[56:59], v[176:191]
  ds_read_b128 v[220:223], v1 offset:48128
  v_rcp_f32 v134, v134
  v_mul_f32 v132, v132, v140
  v_rcp_f32 v135, v135
  s_waitcnt lgkmcnt(4)
  v_mfma_f32_32x32x16_bf16 v[176:191], v[200:203], v[60:63], v[176:191]
  ds_read_b128 v[192:195], v1 offset:49152
  buffer_load_dwordx4 a[84:87], v241, s[4:7], s91 offen offset:0 sc1
  v_mul_f32 v133, v133, v141
  v_mul_f32 v134, v134, v142
  v_mul_f32_e64 v135, v135, v143
  v_cvt_pk_bf16_f32 v136, v128, v129
  v_cvt_pk_bf16_f32 v137, v130, v131
  v_mfma_f32_32x32x16_bf16 v[176:191], v[204:207], v[64:67], v[176:191]
  ds_read_b128 v[196:199], v1 offset:50176
  v_cvt_pk_bf16_f32 v138, v132, v133
  v_cvt_pk_bf16_f32 v139, v134, v135
  s_waitcnt lgkmcnt(4)
  v_mfma_f32_32x32x16_bf16 v[176:191], v[208:211], v[68:71], v[176:191]
  ds_read_b128 v[200:203], v1 offset:51200
  buffer_load_dwordx4 a[88:91], v240, s[4:7], s91 offen offset:2048 sc1
  buffer_store_dwordx4 v[136:139], v1, s[44:47], s73 offen offset:0 sc1
  v_mul_f32 v144, v144, v249
  v_mul_f32 v145, v145, v249
  v_mul_f32 v146, v146, v249
  v_mul_f32_e64 v147, v147, v249
  v_mfma_f32_32x32x16_bf16 v[176:191], v[212:215], v[72:75], v[176:191]
  ds_read_b128 v[204:207], v1 offset:52224
  v_mul_f32 v148, v148, v249
  v_mul_f32 v149, v149, v249
  v_mul_f32_e64 v150, v150, v249
  v_mul_f32 v151, v151, v249
  s_waitcnt lgkmcnt(4)
  v_mfma_f32_32x32x16_bf16 v[176:191], v[216:219], v[76:79], v[176:191]
  ds_read_b128 v[208:211], v1 offset:53248
  buffer_load_dwordx4 a[92:95], v241, s[4:7], s91 offen offset:2048 sc1
  v_exp_f32_e64 v144, -v144
  v_exp_f32_e64 v145, -v145
  v_mfma_f32_32x32x16_bf16 v[176:191], v[220:223], v[80:83], v[176:191]
  ds_read_b128 v[212:215], v1 offset:54272
  v_exp_f32_e64 v146, -v146
  v_fma_f32 v144, v144, v250, v250
  v_exp_f32_e64 v147, -v147
  s_waitcnt lgkmcnt(4)
  v_mfma_f32_32x32x16_bf16 v[176:191], v[192:195], v[84:87], v[176:191]
  s_add_u32 s91, s70, 24576
  ds_read_b128 v[216:219], v1 offset:55296
  buffer_load_dwordx4 a[96:99], v240, s[4:7], s91 offen offset:0 sc1
  v_fma_f32 v145, v145, v250, v250
  v_exp_f32_e64 v148, -v148
  v_fma_f32 v146, v146, v250, v250
  v_mfma_f32_32x32x16_bf16 v[176:191], v[196:199], v[88:91], v[176:191]
  ds_read_b128 v[220:223], v1 offset:56320
  v_exp_f32_e64 v149, -v149
  v_fma_f32 v147, v147, v250, v250
  v_exp_f32_e64 v150, -v150
  s_waitcnt lgkmcnt(4)
  s_waitcnt vmcnt(21)
  s_barrier
  v_mfma_f32_32x32x16_bf16 v[176:191], v[200:203], v[92:95], v[176:191]
  ds_read_b128 v[192:195], v1 offset:57344
  buffer_load_dwordx4 a[100:103], v241, s[4:7], s91 offen offset:0 sc1
  v_fma_f32 v148, v148, v250, v250
  v_exp_f32_e64 v151, -v151
  v_fma_f32 v149, v149, v250, v250
  v_fma_f32 v150, v150, v250, v250
  v_mfma_f32_32x32x16_bf16 v[176:191], v[204:207], v[96:99], v[176:191]
  ds_read_b128 v[196:199], v1 offset:58368
  v_fma_f32 v151, v151, v250, v250
  v_rcp_f32_e64 v144, v144
  v_rcp_f32 v145, v145
  s_waitcnt lgkmcnt(4)
  v_mfma_f32_32x32x16_bf16 v[176:191], v[208:211], v[100:103], v[176:191]
  ds_read_b128 v[200:203], v1 offset:59392
  buffer_load_dwordx4 a[104:107], v240, s[4:7], s91 offen offset:2048 sc1
  v_rcp_f32 v146, v146
  v_mul_f32 v144, v144, v152
  v_rcp_f32_e64 v147, v147
  v_mfma_f32_32x32x16_bf16 v[176:191], v[212:215], v[104:107], v[176:191]
  v_add_u32 v252, 0xec00, v5
  ds_read2_b32 v[204:205], v252 offset0:0 offset1:32
  ds_read2_b32 v[206:207], v252 offset0:64 offset1:96
  v_mul_f32_e64 v145, v145, v153
  v_rcp_f32 v148, v148
  s_waitcnt lgkmcnt(5)
  v_mfma_f32_32x32x16_bf16 v[176:191], v[216:219], v[108:111], v[176:191]
  ds_read_b128 v[208:211], v1 offset:61440
  buffer_load_dwordx4 a[108:111], v241, s[4:7], s91 offen offset:2048 sc1
  v_mul_f32 v146, v146, v154
  v_rcp_f32 v149, v149
  v_mul_f32_e64 v147, v147, v155
  v_mfma_f32_32x32x16_bf16 v[176:191], v[220:223], v[112:115], v[176:191]
  ds_read_b128 v[212:215], v1 offset:62464
  v_rcp_f32 v150, v150
  v_mul_f32 v148, v148, v156
  v_rcp_f32 v151, v151
  s_waitcnt lgkmcnt(5)
  v_mfma_f32_32x32x16_bf16 v[176:191], v[192:195], v[116:119], v[176:191]
  s_add_u32 s91, s70, 28672
  ds_read_b128 v[216:219], v1 offset:63488
  buffer_load_dwordx4 a[112:115], v240, s[4:7], s91 offen offset:0 sc1
  v_mul_f32 v149, v149, v157
  v_mul_f32 v150, v150, v158
  v_mul_f32_e64 v151, v151, v159
  v_cvt_pk_bf16_f32 v152, v144, v145
  v_mfma_f32_32x32x16_bf16 v[176:191], v[196:199], v[120:123], v[176:191]
  ds_read_b128 v[220:223], v1 offset:64512
  v_cvt_pk_bf16_f32 v153, v146, v147
  v_cvt_pk_bf16_f32 v154, v148, v149
  v_cvt_pk_bf16_f32 v155, v150, v151
  s_waitcnt lgkmcnt(4)
  v_mfma_f32_32x32x16_bf16 v[176:191], v[200:203], v[124:127], v[176:191]
  ds_read_b128 v[192:195], v2 offset:0
  buffer_load_dwordx4 a[116:119], v241, s[4:7], s91 offen offset:0 sc1
  buffer_store_dwordx4 v[152:155], v1, s[44:47], s73 offen offset:1024 sc1
  v_mul_f32 v160, v160, v249
  v_mul_f32 v161, v161, v249
  v_mul_f32 v162, v162, v249
  v_mul_f32_e64 v163, v163, v249
  v_mfma_f32_32x32x16_bf16 v[176:191], v[204:207], v[224:227], v[176:191]
  ds_read_b128 v[196:199], v2 offset:1024
  v_mul_f32 v164, v164, v249
  v_mul_f32 v165, v165, v249
  v_mul_f32_e64 v166, v166, v249
  v_mul_f32 v167, v167, v249
  s_waitcnt lgkmcnt(4)
  v_mfma_f32_32x32x16_bf16 v[128:143], v[208:211], v[16:19], 0
  ds_read_b128 v[200:203], v2 offset:2048
  buffer_load_dwordx4 a[120:123], v240, s[4:7], s91 offen offset:2048 sc1
  v_exp_f32_e64 v160, -v160
  v_exp_f32_e64 v161, -v161
  v_mfma_f32_32x32x16_bf16 v[128:143], v[212:215], v[20:23], v[128:143]
  ds_read_b128 v[204:207], v2 offset:3072
  v_exp_f32_e64 v162, -v162
  v_fma_f32 v160, v160, v250, v250
  v_exp_f32_e64 v163, -v163
  s_waitcnt lgkmcnt(4)
  v_mfma_f32_32x32x16_bf16 v[128:143], v[216:219], v[24:27], v[128:143]
  ds_read_b128 v[208:211], v2 offset:4096
  buffer_load_dwordx4 a[124:127], v241, s[4:7], s91 offen offset:2048 sc1
  v_fma_f32 v161, v161, v250, v250
  v_exp_f32_e64 v164, -v164
  v_fma_f32 v162, v162, v250, v250
  v_mfma_f32_32x32x16_bf16 v[128:143], v[220:223], v[28:31], v[128:143]
  ds_read_b128 v[212:215], v2 offset:5120
  v_exp_f32_e64 v165, -v165
  v_fma_f32 v163, v163, v250, v250
  v_exp_f32_e64 v166, -v166
  s_waitcnt lgkmcnt(4)
  v_mfma_f32_32x32x16_bf16 v[128:143], v[192:195], v[32:35], v[128:143]
  s_add_u32 s91, s70, 32768
  ds_read_b128 v[216:219], v2 offset:6144
  buffer_load_dwordx4 a[128:131], v240, s[4:7], s91 offen offset:0 sc1
  v_fma_f32 v164, v164, v250, v250
  v_exp_f32_e64 v167, -v167
  v_fma_f32 v165, v165, v250, v250
  v_mfma_f32_32x32x16_bf16 v[128:143], v[196:199], v[36:39], v[128:143]
  ds_read_b128 v[220:223], v2 offset:7168
  v_fma_f32 v166, v166, v250, v250
  v_fma_f32 v167, v167, v250, v250
  v_rcp_f32 v160, v160
  s_waitcnt lgkmcnt(4)
  v_mfma_f32_32x32x16_bf16 v[128:143], v[200:203], v[40:43], v[128:143]
  ds_read_b128 v[192:195], v2 offset:8192
  buffer_load_dwordx4 a[132:135], v241, s[4:7], s91 offen offset:0 sc1
  v_rcp_f32 v161, v161
  v_rcp_f32 v162, v162
  v_mul_f32_e64 v160, v160, v168
  v_mfma_f32_32x32x16_bf16 v[128:143], v[204:207], v[44:47], v[128:143]
  ds_read_b128 v[196:199], v2 offset:9216
  v_rcp_f32 v163, v163
  v_mul_f32 v161, v161, v169
  v_rcp_f32 v164, v164
  s_waitcnt lgkmcnt(4)
  v_mfma_f32_32x32x16_bf16 v[128:143], v[208:211], v[48:51], v[128:143]
  ds_read_b128 v[200:203], v2 offset:10240
  buffer_load_dwordx4 a[136:139], v240, s[4:7], s91 offen offset:2048 sc1
  v_mul_f32 v162, v162, v170
  v_rcp_f32 v165, v165
  v_mul_f32_e64 v163, v163, v171
  v_mfma_f32_32x32x16_bf16 v[128:143], v[212:215], v[52:55], v[128:143]
  ds_read_b128 v[204:207], v2 offset:11264
  v_rcp_f32 v166, v166
  v_mul_f32 v164, v164, v172
  v_rcp_f32 v167, v167
  s_waitcnt lgkmcnt(4)
  v_mfma_f32_32x32x16_bf16 v[128:143], v[216:219], v[56:59], v[128:143]
  ds_read_b128 v[208:211], v2 offset:12288
  buffer_load_dwordx4 a[140:143], v241, s[4:7], s91 offen offset:2048 sc1
  v_mul_f32 v165, v165, v173
  v_mul_f32 v166, v166, v174
  v_mul_f32_e64 v167, v167, v175
  v_cvt_pk_bf16_f32 v168, v160, v161
  v_cvt_pk_bf16_f32 v169, v162, v163
  v_mfma_f32_32x32x16_bf16 v[128:143], v[220:223], v[60:63], v[128:143]
  ds_read_b128 v[212:215], v2 offset:13312
  v_cvt_pk_bf16_f32 v170, v164, v165
  v_cvt_pk_bf16_f32 v171, v166, v167
  s_waitcnt lgkmcnt(4)
  v_mfma_f32_32x32x16_bf16 v[128:143], v[192:195], v[64:67], v[128:143]
  s_add_u32 s91, s70, 36864
  ds_read_b128 v[216:219], v2 offset:14336
  buffer_load_dwordx4 a[144:147], v240, s[4:7], s91 offen offset:0 sc1
  buffer_store_dwordx4 v[168:171], v1, s[44:47], s73 offen offset:2048 sc1
  v_mul_f32 v176, v176, v249
  v_mul_f32 v177, v177, v249
  v_mul_f32 v178, v178, v249
  v_mfma_f32_32x32x16_bf16 v[128:143], v[196:199], v[68:71], v[128:143]
  ds_read_b128 v[220:223], v2 offset:15360
  v_mul_f32 v179, v179, v249
  v_mul_f32 v180, v180, v249
  v_mul_f32 v181, v181, v249
  v_mul_f32 v182, v182, v249
  v_mul_f32 v183, v183, v249
  s_waitcnt lgkmcnt(4)
  v_mfma_f32_32x32x16_bf16 v[128:143], v[200:203], v[72:75], v[128:143]
  ds_read_b128 v[192:195], v2 offset:16384
  buffer_load_dwordx4 a[148:151], v241, s[4:7], s91 offen offset:0 sc1
  v_exp_f32_e64 v176, -v176
  v_exp_f32_e64 v177, -v177
  v_mfma_f32_32x32x16_bf16 v[128:143], v[204:207], v[76:79], v[128:143]
  ds_read_b128 v[196:199], v2 offset:17408
  v_exp_f32_e64 v178, -v178
  v_fma_f32 v176, v176, v250, v250
  v_exp_f32_e64 v179, -v179
  s_waitcnt lgkmcnt(4)
  v_mfma_f32_32x32x16_bf16 v[128:143], v[208:211], v[80:83], v[128:143]
  ds_read_b128 v[200:203], v2 offset:18432
  buffer_load_dwordx4 a[152:155], v240, s[4:7], s91 offen offset:2048 sc1
  v_fma_f32 v177, v177, v250, v250
  v_exp_f32_e64 v180, -v180
  v_fma_f32 v178, v178, v250, v250
  v_mfma_f32_32x32x16_bf16 v[128:143], v[212:215], v[84:87], v[128:143]
  ds_read_b128 v[204:207], v2 offset:19456
  v_exp_f32_e64 v181, -v181
  v_fma_f32 v179, v179, v250, v250
  v_exp_f32_e64 v182, -v182
  s_waitcnt lgkmcnt(4)
  v_mfma_f32_32x32x16_bf16 v[128:143], v[216:219], v[88:91], v[128:143]
  ds_read_b128 v[208:211], v2 offset:20480
  buffer_load_dwordx4 a[156:159], v241, s[4:7], s91 offen offset:2048 sc1
  v_fma_f32 v180, v180, v250, v250
  v_exp_f32_e64 v183, -v183
  v_fma_f32 v181, v181, v250, v250
  v_fma_f32 v182, v182, v250, v250
  v_mfma_f32_32x32x16_bf16 v[128:143], v[220:223], v[92:95], v[128:143]
  ds_read_b128 v[212:215], v2 offset:21504
  s_waitcnt vmcnt(11)
  v_mov_b32_e64 v254, 1
  s_mov_b64 exec, 1
  buffer_store_dword v254, off, s[40:43], s94 offset:0
  s_mov_b64 exec, -1
  s_waitcnt lgkmcnt(4)
  v_mfma_f32_32x32x16_bf16 v[128:143], v[192:195], v[96:99], v[128:143]
  s_add_u32 s91, s70, 40960
  ds_read_b128 v[216:219], v2 offset:22528
  buffer_load_dwordx4 a[160:163], v240, s[4:7], s91 offen offset:0 sc1
  v_fma_f32 v183, v183, v250, v250
  v_rcp_f32_e64 v176, v176
  v_mfma_f32_32x32x16_bf16 v[128:143], v[196:199], v[100:103], v[128:143]
  ds_read_b128 v[220:223], v2 offset:23552
  v_rcp_f32 v177, v177
  v_rcp_f32 v178, v178
  v_mul_f32 v176, v176, v184
  s_waitcnt lgkmcnt(4)
  v_mfma_f32_32x32x16_bf16 v[128:143], v[200:203], v[104:107], v[128:143]
  v_add_u32 v251, 0x16000, v5
  ds_read2_b32 v[192:193], v251 offset0:0 offset1:32
  ds_read2_b32 v[194:195], v251 offset0:64 offset1:96
  buffer_load_dwordx4 a[164:167], v241, s[4:7], s91 offen offset:0 sc1
  v_rcp_f32_e64 v179, v179
  v_mul_f32 v177, v177, v185
  s_barrier
  v_mfma_f32_32x32x16_bf16 v[128:143], v[204:207], v[108:111], v[128:143]
  ds_read_b128 v[196:199], v2 offset:40960
  v_rcp_f32 v180, v180
  v_mul_f32 v178, v178, v186
  v_rcp_f32 v181, v181
  s_waitcnt lgkmcnt(5)
  v_mfma_f32_32x32x16_bf16 v[128:143], v[208:211], v[112:115], v[128:143]
  v_and_b32 v232, 3, v0
  v_lshlrev_b32 v232, 7, v232
  ds_read_b128 v[200:203], v2 offset:41984
  global_load_dword v233, v232, s[100:101]
  v_mul_f32 v179, v179, v187
  v_rcp_f32 v182, v182
  v_mfma_f32_32x32x16_bf16 v[128:143], v[212:215], v[116:119], v[128:143]
  ds_read_b128 v[204:207], v2 offset:43008
  v_mul_f32 v180, v180, v188
  v_rcp_f32 v183, v183
  v_mul_f32_e64 v181, v181, v189
  v_mul_f32 v182, v182, v190
  s_waitcnt lgkmcnt(5)
  v_mfma_f32_32x32x16_bf16 v[128:143], v[216:219], v[120:123], v[128:143]
  ds_read_b128 v[208:211], v2 offset:44032
  buffer_load_dwordx4 a[168:171], v240, s[4:7], s91 offen offset:2048 sc1
  v_mul_f32_e64 v183, v183, v191
  v_cvt_pk_bf16_f32 v184, v176, v177
  v_cvt_pk_bf16_f32 v185, v178, v179
  v_cvt_pk_bf16_f32 v186, v180, v181
  v_cvt_pk_bf16_f32 v187, v182, v183
  v_mfma_f32_32x32x16_bf16 v[128:143], v[220:223], v[124:127], v[128:143]
  ds_read_b128 v[212:215], v2 offset:45056
  buffer_store_dwordx4 v[184:187], v1, s[44:47], s73 offen offset:3072 sc1
  s_waitcnt lgkmcnt(4)
  v_mfma_f32_32x32x16_bf16 v[128:143], v[192:195], v[224:227], v[128:143]
  ds_read_b128 v[216:219], v2 offset:46080
  buffer_load_dwordx4 a[172:175], v241, s[4:7], s91 offen offset:2048 sc1
  v_mfma_f32_32x32x16_bf16 v[144:159], v[196:199], v[16:19], 0
  ds_read_b128 v[220:223], v2 offset:47104
  s_waitcnt lgkmcnt(4)
  v_mfma_f32_32x32x16_bf16 v[144:159], v[200:203], v[20:23], v[144:159]
  s_add_u32 s91, s70, 45056
  ds_read_b128 v[192:195], v2 offset:48128
  buffer_load_dwordx4 a[176:179], v240, s[4:7], s91 offen offset:0 sc1
  v_mul_f32 v128, v128, v249
  v_mul_f32 v129, v129, v249
  v_mul_f32 v130, v130, v249
  v_mul_f32 v131, v131, v249
  v_mfma_f32_32x32x16_bf16 v[144:159], v[204:207], v[24:27], v[144:159]
  ds_read_b128 v[196:199], v2 offset:49152
  v_mul_f32 v132, v132, v249
  v_mul_f32 v133, v133, v249
  v_mul_f32_e64 v134, v134, v249
  v_mul_f32 v135, v135, v249
  s_waitcnt lgkmcnt(4)
  v_mfma_f32_32x32x16_bf16 v[144:159], v[208:211], v[28:31], v[144:159]
  ds_read_b128 v[200:203], v2 offset:50176
  buffer_load_dwordx4 a[180:183], v241, s[4:7], s91 offen offset:0 sc1
  v_exp_f32_e64 v128, -v128
  v_exp_f32_e64 v129, -v129
  v_mfma_f32_32x32x16_bf16 v[144:159], v[212:215], v[32:35], v[144:159]
  ds_read_b128 v[204:207], v2 offset:51200
  v_exp_f32_e64 v130, -v130
  v_fma_f32 v128, v128, v250, v250
  v_exp_f32_e64 v131, -v131
  s_waitcnt lgkmcnt(4)
  v_mfma_f32_32x32x16_bf16 v[144:159], v[216:219], v[36:39], v[144:159]
  ds_read_b128 v[208:211], v2 offset:52224
  buffer_load_dwordx4 a[184:187], v240, s[4:7], s91 offen offset:2048 sc1
  v_fma_f32 v129, v129, v250, v250
  v_exp_f32_e64 v132, -v132
  v_fma_f32 v130, v130, v250, v250
  v_mfma_f32_32x32x16_bf16 v[144:159], v[220:223], v[40:43], v[144:159]
  ds_read_b128 v[212:215], v2 offset:53248
  v_exp_f32_e64 v133, -v133
  v_fma_f32 v131, v131, v250, v250
  v_exp_f32_e64 v134, -v134
  s_waitcnt lgkmcnt(4)
  v_mfma_f32_32x32x16_bf16 v[144:159], v[192:195], v[44:47], v[144:159]
  ds_read_b128 v[216:219], v2 offset:54272
  buffer_load_dwordx4 a[188:191], v241, s[4:7], s91 offen offset:2048 sc1
  v_fma_f32 v132, v132, v250, v250
  v_exp_f32_e64 v135, -v135
  v_fma_f32 v133, v133, v250, v250
  v_fma_f32 v134, v134, v250, v250
  v_mfma_f32_32x32x16_bf16 v[144:159], v[196:199], v[48:51], v[144:159]
  ds_read_b128 v[220:223], v2 offset:55296
  v_fma_f32 v135, v135, v250, v250
  v_rcp_f32_e64 v128, v128
  v_rcp_f32 v129, v129
  s_waitcnt lgkmcnt(4)
  v_mfma_f32_32x32x16_bf16 v[144:159], v[200:203], v[52:55], v[144:159]
  s_add_u32 s91, s70, 49152
  ds_read_b128 v[192:195], v2 offset:56320
  buffer_load_dwordx4 a[192:195], v240, s[4:7], s91 offen offset:0 sc1
  v_rcp_f32 v130, v130
  v_mul_f32 v128, v128, v136
  v_mfma_f32_32x32x16_bf16 v[144:159], v[204:207], v[56:59], v[144:159]
  ds_read_b128 v[196:199], v2 offset:57344
  v_rcp_f32 v131, v131
  v_mul_f32 v129, v129, v137
  v_rcp_f32 v132, v132
  s_waitcnt lgkmcnt(4)
  v_mfma_f32_32x32x16_bf16 v[144:159], v[208:211], v[60:63], v[144:159]
  ds_read_b128 v[200:203], v2 offset:58368
  buffer_load_dwordx4 a[196:199], v241, s[4:7], s91 offen offset:0 sc1
  v_mul_f32 v130, v130, v138
  v_rcp_f32 v133, v133
  v_mul_f32_e64 v131, v131, v139
  v_mfma_f32_32x32x16_bf16 v[144:159], v[212:215], v[64:67], v[144:159]
  ds_read_b128 v[204:207], v2 offset:59392
  buffer_load_dword v247, v244, s[40:43], 0 offen offset:0 sc1
  v_rcp_f32_e64 v134, v134
  v_mul_f32 v132, v132, v140
  s_waitcnt lgkmcnt(4)
  v_mfma_f32_32x32x16_bf16 v[144:159], v[216:219], v[68:71], v[144:159]
  ds_read_b128 v[208:211], v2 offset:60416
  buffer_load_dwordx4 a[200:203], v240, s[4:7], s91 offen offset:2048 sc1
  v_rcp_f32 v135, v135
  v_mul_f32 v133, v133, v141
  v_mul_f32 v134, v134, v142
  v_mul_f32 v135, v135, v143
  v_mfma_f32_32x32x16_bf16 v[144:159], v[220:223], v[72:75], v[144:159]
  ds_read_b128 v[212:215], v2 offset:61440
  v_cvt_pk_bf16_f32 v136, v128, v129
  v_cvt_pk_bf16_f32 v137, v130, v131
  v_cvt_pk_bf16_f32 v138, v132, v133
  v_cvt_pk_bf16_f32 v139, v134, v135
  s_waitcnt lgkmcnt(4)
  v_mfma_f32_32x32x16_bf16 v[144:159], v[192:195], v[76:79], v[144:159]
  ds_read_b128 v[216:219], v2 offset:62464
  buffer_load_dwordx4 a[204:207], v241, s[4:7], s91 offen offset:2048 sc1
  buffer_store_dwordx4 v[136:139], v1, s[44:47], s74 offen offset:0 sc1
  v_mfma_f32_32x32x16_bf16 v[144:159], v[196:199], v[80:83], v[144:159]
  ds_read_b128 v[220:223], v2 offset:63488
  s_waitcnt lgkmcnt(4)
  v_mfma_f32_32x32x16_bf16 v[144:159], v[200:203], v[84:87], v[144:159]
  s_add_u32 s91, s70, 53248
  ds_read_b128 v[192:195], v2 offset:64512
  buffer_load_dwordx4 a[208:211], v240, s[4:7], s91 offen offset:0 sc1
  v_mfma_f32_32x32x16_bf16 v[144:159], v[204:207], v[88:91], v[144:159]
  ds_read_b128 v[196:199], v3 offset:0
  s_waitcnt vmcnt(12)
  v_mov_b32_e64 v254, 1
  s_mov_b64 exec, 1
  buffer_store_dword v254, off, s[40:43], s94 offset:64
  s_mov_b64 exec, -1
  s_waitcnt lgkmcnt(4)
  v_mfma_f32_32x32x16_bf16 v[144:159], v[208:211], v[92:95], v[144:159]
  ds_read_b128 v[200:203], v3 offset:1024
  buffer_load_dwordx4 a[212:215], v241, s[4:7], s91 offen offset:0 sc1
  v_mfma_f32_32x32x16_bf16 v[144:159], v[212:215], v[96:99], v[144:159]
  ds_read_b128 v[204:207], v3 offset:2048
  s_waitcnt lgkmcnt(4)
  v_mfma_f32_32x32x16_bf16 v[144:159], v[216:219], v[100:103], v[144:159]
  ds_read_b128 v[208:211], v3 offset:3072
  buffer_load_dwordx4 a[216:219], v240, s[4:7], s91 offen offset:2048 sc1
  v_mfma_f32_32x32x16_bf16 v[144:159], v[220:223], v[104:107], v[144:159]
  v_add_u32 v253, 0x21000, v5
  ds_read2_b32 v[212:213], v253 offset0:0 offset1:32
  ds_read2_b32 v[214:215], v253 offset0:64 offset1:96
  s_waitcnt lgkmcnt(5)
  v_mfma_f32_32x32x16_bf16 v[144:159], v[192:195], v[108:111], v[144:159]
  ds_read_b128 v[216:219], v3 offset:5120
  buffer_load_dwordx4 a[220:223], v241, s[4:7], s91 offen offset:2048 sc1
  v_mfma_f32_32x32x16_bf16 v[144:159], v[196:199], v[112:115], v[144:159]
  ds_read_b128 v[220:223], v3 offset:6144
  s_waitcnt lgkmcnt(5)
  v_mfma_f32_32x32x16_bf16 v[144:159], v[200:203], v[116:119], v[144:159]
  ds_read_b128 v[192:195], v3 offset:7168
  v_mfma_f32_32x32x16_bf16 v[144:159], v[204:207], v[120:123], v[144:159]
  ds_read_b128 v[196:199], v3 offset:8192
  s_waitcnt lgkmcnt(4)
  v_mfma_f32_32x32x16_bf16 v[144:159], v[208:211], v[124:127], v[144:159]
  ds_read_b128 v[200:203], v3 offset:9216
  v_mfma_f32_32x32x16_bf16 v[144:159], v[212:215], v[224:227], v[144:159]
  ds_read_b128 v[204:207], v3 offset:10240
  s_waitcnt lgkmcnt(4)
  v_mfma_f32_32x32x16_bf16 v[160:175], v[216:219], v[16:19], 0
  ds_read_b128 v[208:211], v3 offset:11264
  s_waitcnt vmcnt(8)
  v_mfma_f32_32x32x16_bf16 v[160:175], v[220:223], v[20:23], v[160:175]
  ds_read_b128 v[212:215], v3 offset:12288
  s_mov_b32 s90, 0
  buffer_load_dwordx4 v[16:19], v245, s[44:47], s90 offen sc1
  v_mul_f32 v144, v144, v249
  v_mul_f32_e64 v145, v145, v249
  v_mul_f32 v146, v146, v249
  s_waitcnt lgkmcnt(4)
  v_mfma_f32_32x32x16_bf16 v[160:175], v[192:195], v[24:27], v[160:175]
  ds_read_b128 v[216:219], v3 offset:13312
  v_mul_f32 v147, v147, v249
  v_mul_f32 v148, v148, v249
  v_mul_f32 v149, v149, v249
  v_mul_f32 v150, v150, v249
  v_mul_f32_e64 v151, v151, v249
  v_mfma_f32_32x32x16_bf16 v[160:175], v[196:199], v[28:31], v[160:175]
  ds_read_b128 v[220:223], v3 offset:14336
  buffer_load_dwordx4 v[20:23], v246, s[44:47], s90 offen sc1
  v_exp_f32_e64 v144, -v144
  v_exp_f32_e64 v145, -v145
  s_waitcnt lgkmcnt(4)
  v_mfma_f32_32x32x16_bf16 v[160:175], v[200:203], v[32:35], v[160:175]
  ds_read_b128 v[192:195], v3 offset:15360
  v_exp_f32_e64 v146, -v146
  v_fma_f32 v144, v144, v250, v250
  v_exp_f32_e64 v147, -v147
  v_fma_f32 v145, v145, v250, v250
  v_mfma_f32_32x32x16_bf16 v[160:175], v[204:207], v[36:39], v[160:175]
  ds_read_b128 v[196:199], v3 offset:16384
  s_mov_b32 s90, 7168
  buffer_load_dwordx4 v[24:27], v245, s[44:47], s90 offen sc1
  v_exp_f32_e64 v148, -v148
  v_fma_f32 v146, v146, v250, v250
  s_waitcnt lgkmcnt(4)
  v_mfma_f32_32x32x16_bf16 v[160:175], v[208:211], v[40:43], v[160:175]
  ds_read_b128 v[200:203], v3 offset:17408
  v_exp_f32_e64 v149, -v149
  v_fma_f32 v147, v147, v250, v250
  v_exp_f32_e64 v150, -v150
  v_fma_f32 v148, v148, v250, v250
  v_mfma_f32_32x32x16_bf16 v[160:175], v[212:215], v[44:47], v[160:175]
  ds_read_b128 v[204:207], v3 offset:18432
  buffer_load_dwordx4 v[28:31], v246, s[44:47], s90 offen sc1
  s_waitcnt vmcnt(9)
  v_mov_b32_e64 v254, 1
  s_mov_b64 exec, 1
  buffer_store_dword v254, off, s[40:43], s94 offset:256
  s_mov_b64 exec, -1
  s_waitcnt lgkmcnt(4)
  v_mfma_f32_32x32x16_bf16 v[160:175], v[216:219], v[48:51], v[160:175]
  ds_read_b128 v[208:211], v3 offset:19456
  v_exp_f32_e64 v151, -v151
  v_fma_f32 v149, v149, v250, v250
  v_fma_f32 v150, v150, v250, v250
  v_fma_f32 v151, v151, v250, v250
  v_mfma_f32_32x32x16_bf16 v[160:175], v[220:223], v[52:55], v[160:175]
  ds_read_b128 v[212:215], v3 offset:20480
  s_mov_b32 s90, 14336
  buffer_load_dwordx4 v[32:35], v245, s[44:47], s90 offen sc1
  v_rcp_f32 v144, v144
  s_waitcnt lgkmcnt(4)
  v_mfma_f32_32x32x16_bf16 v[160:175], v[192:195], v[56:59], v[160:175]
  ds_read_b128 v[216:219], v3 offset:21504
  v_rcp_f32 v145, v145
  v_rcp_f32 v146, v146
  v_mul_f32_e64 v144, v144, v152
  v_mfma_f32_32x32x16_bf16 v[160:175], v[196:199], v[60:63], v[160:175]
  ds_read_b128 v[220:223], v3 offset:22528
  buffer_load_dwordx4 v[36:39], v246, s[44:47], s90 offen sc1
  v_rcp_f32_e64 v147, v147
  v_mul_f32 v145, v145, v153
  s_waitcnt lgkmcnt(4)
  v_mfma_f32_32x32x16_bf16 v[160:175], v[200:203], v[64:67], v[160:175]
  ds_read_b128 v[192:195], v3 offset:23552
  v_rcp_f32 v148, v148
  v_mul_f32 v146, v146, v154
  v_rcp_f32 v149, v149
  v_mul_f32 v147, v147, v155
  v_mfma_f32_32x32x16_bf16 v[160:175], v[204:207], v[68:71], v[160:175]
  ds_read_b128 v[196:199], v3 offset:24576
  s_mov_b32 s90, 21504
  buffer_load_dwordx4 v[40:43], v245, s[44:47], s90 offen sc1
  v_rcp_f32_e64 v150, v150
  v_mul_f32 v148, v148, v156
  s_waitcnt lgkmcnt(4)
  v_mfma_f32_32x32x16_bf16 v[160:175], v[208:211], v[72:75], v[160:175]
  ds_read_b128 v[200:203], v3 offset:25600
  v_rcp_f32 v151, v151
  v_mul_f32 v149, v149, v157
  v_mul_f32 v150, v150, v158
  v_mul_f32 v151, v151, v159
  v_cvt_pk_bf16_f32 v152, v144, v145
  v_mfma_f32_32x32x16_bf16 v[160:175], v[212:215], v[76:79], v[160:175]
  ds_read_b128 v[204:207], v3 offset:26624
  buffer_load_dwordx4 v[44:47], v246, s[44:47], s90 offen sc1
  v_cvt_pk_bf16_f32 v153, v146, v147
  v_cvt_pk_bf16_f32 v154, v148, v149
  v_cvt_pk_bf16_f32 v155, v150, v151
  s_waitcnt lgkmcnt(4)
  v_mfma_f32_32x32x16_bf16 v[160:175], v[216:219], v[80:83], v[160:175]
  ds_read_b128 v[208:211], v3 offset:27648
  buffer_store_dwordx4 v[152:155], v1, s[44:47], s74 offen offset:1024 sc1
  v_mfma_f32_32x32x16_bf16 v[160:175], v[220:223], v[84:87], v[160:175]
  ds_read_b128 v[212:215], v3 offset:28672
  s_mov_b32 s90, 1024
  buffer_load_dwordx4 v[48:51], v245, s[44:47], s90 offen sc1
  s_waitcnt lgkmcnt(4)
  v_mfma_f32_32x32x16_bf16 v[160:175], v[192:195], v[88:91], v[160:175]
  ds_read_b128 v[216:219], v3 offset:29696
  v_mfma_f32_32x32x16_bf16 v[160:175], v[196:199], v[92:95], v[160:175]
  ds_read_b128 v[220:223], v3 offset:30720
  buffer_load_dwordx4 v[52:55], v246, s[44:47], s90 offen sc1
  s_waitcnt lgkmcnt(4)
  v_mfma_f32_32x32x16_bf16 v[160:175], v[200:203], v[96:99], v[160:175]
  ds_read_b128 v[192:195], v3 offset:31744
  v_mfma_f32_32x32x16_bf16 v[160:175], v[204:207], v[100:103], v[160:175]
  ds_read_b128 v[196:199], v2 offset:25600
  s_mov_b32 s90, 8192
  buffer_load_dwordx4 v[56:59], v245, s[44:47], s90 offen sc1
  s_waitcnt lgkmcnt(4)
  v_mfma_f32_32x32x16_bf16 v[160:175], v[208:211], v[104:107], v[160:175]
  v_add_u32 v252, 0x16800, v5
  ds_read2_b32 v[200:201], v252 offset0:0 offset1:32
  ds_read2_b32 v[202:203], v252 offset0:64 offset1:96
  v_mfma_f32_32x32x16_bf16 v[160:175], v[212:215], v[108:111], v[160:175]
  buffer_load_dwordx4 v[60:63], v246, s[44:47], s90 offen sc1
  s_waitcnt lgkmcnt(4)
  v_mfma_f32_32x32x16_bf16 v[160:175], v[216:219], v[112:115], v[160:175]
  s_buffer_load_dwordx4 s[76:79], s[40:43], s85 offset:64
  s_buffer_load_dwordx4 s[80:83], s[40:43], s85 offset:576
  v_mfma_f32_32x32x16_bf16 v[160:175], v[220:223], v[116:119], v[160:175]
  s_mov_b32 s90, 15360
  buffer_load_dwordx4 v[64:67], v245, s[44:47], s90 offen sc1
  s_waitcnt lgkmcnt(2)
  v_mfma_f32_32x32x16_bf16 v[160:175], v[192:195], v[120:123], v[160:175]
  v_mfma_f32_32x32x16_bf16 v[160:175], v[196:199], v[124:127], v[160:175]
  buffer_load_dwordx4 v[68:71], v246, s[44:47], s90 offen sc1
  s_waitcnt lgkmcnt(0)
  v_mfma_f32_32x32x16_bf16 v[160:175], v[200:203], v[224:227], v[160:175]
  s_cmp_ge_u32 s49, 28
  s_cbranch_scc1 Lc_20
  v_cmp_ne_u32 vcc, 1, v247
  s_waitcnt lgkmcnt(0)
  s_and_b64 s[76:77], s[76:77], s[78:79]
  s_and_b64 s[80:81], s[80:81], s[82:83]
  s_and_b64 s[76:77], s[76:77], s[80:81]
  s_and_b32 s76, s76, s77
  s_cmp_eq_u64 vcc, 0
  s_cselect_b32 s77, 1, 0
  s_and_b32 s76, s76, s77
  s_cbranch_scc0 Lc_21
Lr_22:
  s_waitcnt vmcnt(15)
  v_mfma_f32_32x32x16_bf16 v[208:223], a[0:3], v[16:19], 0
  s_mov_b32 s90, 22528
  buffer_load_dwordx4 v[72:75], v245, s[44:47], s90 offen sc1
  v_mfma_f32_32x32x16_bf16 v[224:239], a[4:7], v[16:19], 0
  v_mul_f32 v160, v160, v249
  v_mul_f32 v161, v161, v249
  v_mul_f32 v162, v162, v249
  v_mul_f32 v163, v163, v249
  v_mul_f32 v164, v164, v249
  v_mul_f32 v165, v165, v249
  v_mul_f32 v166, v166, v249
  s_waitcnt vmcnt(15)
  v_mfma_f32_32x32x16_bf16 a[224:239], a[0:3], v[20:23], 0
  buffer_load_dwordx4 v[76:79], v246, s[44:47], s90 offen sc1
  v_mul_f32_e64 v167, v167, v249
  v_exp_f32_e64 v160, -v160
  v_exp_f32_e64 v161, -v161
  v_mfma_f32_32x32x16_bf16 a[240:255], a[4:7], v[20:23], 0
  v_exp_f32_e64 v162, -v162
  v_fma_f32 v160, v160, v250, v250
  v_exp_f32_e64 v163, -v163
  v_fma_f32 v161, v161, v250, v250
  s_barrier
  s_waitcnt vmcnt(15)
  v_mfma_f32_32x32x16_bf16 v[208:223], a[8:11], v[24:27], v[208:223]
  s_mov_b32 s90, 2048
  buffer_load_dwordx4 v[80:83], v245, s[44:47], s90 offen sc1
  v_exp_f32_e64 v164, -v164
  v_fma_f32 v162, v162, v250, v250
  v_exp_f32_e64 v165, -v165
  v_mfma_f32_32x32x16_bf16 v[224:239], a[12:15], v[24:27], v[224:239]
  v_fma_f32 v163, v163, v250, v250
  v_exp_f32_e64 v166, -v166
  v_fma_f32 v164, v164, v250, v250
  v_exp_f32_e64 v167, -v167
  v_fma_f32 v165, v165, v250, v250
  s_waitcnt vmcnt(15)
  v_mfma_f32_32x32x16_bf16 a[224:239], a[8:11], v[28:31], a[224:239]
  buffer_load_dwordx4 v[84:87], v246, s[44:47], s90 offen sc1
  v_fma_f32 v166, v166, v250, v250
  v_fma_f32 v167, v167, v250, v250
  v_rcp_f32 v160, v160
  v_rcp_f32_e64 v161, v161
  v_mfma_f32_32x32x16_bf16 a[240:255], a[12:15], v[28:31], a[240:255]
  v_rcp_f32 v162, v162
  v_mul_f32 v160, v160, v168
  v_rcp_f32_e64 v163, v163
  v_mul_f32 v161, v161, v169
  s_waitcnt vmcnt(14)
  v_mfma_f32_32x32x16_bf16 v[208:223], a[16:19], v[32:35], v[208:223]
  s_mov_b32 s90, 9216
  buffer_load_dwordx4 v[88:91], v245, s[44:47], s90 offen sc1
  v_rcp_f32 v164, v164
  v_mul_f32 v162, v162, v170
  v_rcp_f32_e64 v165, v165
  v_mfma_f32_32x32x16_bf16 v[224:239], a[20:23], v[32:35], v[224:239]
  v_mul_f32 v163, v163, v171
  v_rcp_f32 v166, v166
  v_mul_f32 v164, v164, v172
  v_rcp_f32 v167, v167
  v_mul_f32 v165, v165, v173
  s_waitcnt vmcnt(14)
  v_mfma_f32_32x32x16_bf16 a[224:239], a[16:19], v[36:39], a[224:239]
  buffer_load_dwordx4 v[92:95], v246, s[44:47], s90 offen sc1
  v_mul_f32 v166, v166, v174
  v_mul_f32 v167, v167, v175
  v_cvt_pk_bf16_f32 v168, v160, v161
  v_cvt_pk_bf16_f32 v169, v162, v163
  v_cvt_pk_bf16_f32 v170, v164, v165
  v_cvt_pk_bf16_f32 v171, v166, v167
  v_mfma_f32_32x32x16_bf16 a[240:255], a[20:23], v[36:39], a[240:255]
  buffer_store_dwordx4 v[168:171], v1, s[44:47], s74 offen offset:2048 sc1
  s_waitcnt vmcnt(15)
  v_mfma_f32_32x32x16_bf16 v[208:223], a[24:27], v[40:43], v[208:223]
  s_mov_b32 s90, 16384
  buffer_load_dwordx4 v[96:99], v245, s[44:47], s90 offen sc1
  v_mfma_f32_32x32x16_bf16 v[224:239], a[28:31], v[40:43], v[224:239]
  s_waitcnt vmcnt(14)
  v_mov_b32 v254, 1
  s_mov_b64 exec, 1
  buffer_store_dword v254, off, s[40:43], s94 offset:128
  s_mov_b64 exec, -1
  v_mfma_f32_32x32x16_bf16 a[224:239], a[24:27], v[44:47], a[224:239]
  buffer_load_dwordx4 v[100:103], v246, s[44:47], s90 offen sc1
  v_mfma_f32_32x32x16_bf16 a[240:255], a[28:31], v[44:47], a[240:255]
  s_waitcnt vmcnt(15)
  v_mfma_f32_32x32x16_bf16 v[208:223], a[32:35], v[48:51], v[208:223]
  s_mov_b32 s90, 23552
  buffer_load_dwordx4 v[104:107], v245, s[44:47], s90 offen sc1
  v_mfma_f32_32x32x16_bf16 v[224:239], a[36:39], v[48:51], v[224:239]
  s_waitcnt vmcnt(15)
  v_mfma_f32_32x32x16_bf16 a[224:239], a[32:35], v[52:55], a[224:239]
  buffer_load_dwordx4 v[108:111], v246, s[44:47], s90 offen sc1
  v_mfma_f32_32x32x16_bf16 a[240:255], a[36:39], v[52:55], a[240:255]
  s_waitcnt vmcnt(15)
  v_mfma_f32_32x32x16_bf16 v[208:223], a[40:43], v[56:59], v[208:223]
  s_mov_b32 s90, 3072
  buffer_load_dwordx4 v[112:115], v245, s[44:47], s90 offen sc1
  v_mfma_f32_32x32x16_bf16 v[224:239], a[44:47], v[56:59], v[224:239]
  s_waitcnt vmcnt(15)
  v_mfma_f32_32x32x16_bf16 a[224:239], a[40:43], v[60:63], a[224:239]
  buffer_load_dwordx4 v[116:119], v246, s[44:47], s90 offen sc1
  v_mfma_f32_32x32x16_bf16 a[240:255], a[44:47], v[60:63], a[240:255]
  s_waitcnt vmcnt(15)
  v_mfma_f32_32x32x16_bf16 v[208:223], a[48:51], v[64:67], v[208:223]
  s_mov_b32 s90, 10240
  buffer_load_dwordx4 v[120:123], v245, s[44:47], s90 offen sc1
  v_mfma_f32_32x32x16_bf16 v[224:239], a[52:55], v[64:67], v[224:239]
  s_waitcnt vmcnt(15)
  v_mfma_f32_32x32x16_bf16 a[224:239], a[48:51], v[68:71], a[224:239]
  buffer_load_dwordx4 v[124:127], v246, s[44:47], s90 offen sc1
  v_mfma_f32_32x32x16_bf16 a[240:255], a[52:55], v[68:71], a[240:255]
  s_waitcnt vmcnt(15)
  v_mfma_f32_32x32x16_bf16 v[208:223], a[56:59], v[72:75], v[208:223]
  s_buffer_load_dwordx4 s[76:79], s[40:43], s85 offset:256
  s_buffer_load_dwordx4 s[80:83], s[40:43], s85 offset:768
  s_mov_b32 s90, 17408
  buffer_load_dwordx4 v[16:19], v245, s[44:47], s90 offen sc1
  v_mfma_f32_32x32x16_bf16 v[224:239], a[60:63], v[72:75], v[224:239]
  s_waitcnt vmcnt(15)
  v_mfma_f32_32x32x16_bf16 a[224:239], a[56:59], v[76:79], a[224:239]
  buffer_load_dwordx4 v[20:23], v246, s[44:47], s90 offen sc1
  v_mfma_f32_32x32x16_bf16 a[240:255], a[60:63], v[76:79], a[240:255]
  s_waitcnt vmcnt(15)
  v_mfma_f32_32x32x16_bf16 v[208:223], a[64:67], v[80:83], v[208:223]
  s_mov_b32 s90, 24576
  buffer_load_dwordx4 v[24:27], v245, s[44:47], s90 offen sc1
  v_mfma_f32_32x32x16_bf16 v[224:239], a[68:71], v[80:83], v[224:239]
  s_waitcnt vmcnt(12)
  v_mov_b32_e64 v254, 1
  s_mov_b64 exec, 1
  buffer_store_dword v254, off, s[40:43], s94 offset:192
  s_mov_b64 exec, -1
  s_xor_b32 s86, s48, 1
  s_mul_i32 s86, s86, 12288
  v_mfma_f32_32x32x16_bf16 a[224:239], a[64:67], v[84:87], a[224:239]
  buffer_load_dwordx4 v[28:31], v246, s[44:47], s90 offen sc1
  s_add_u32 s86, s86, 106496
  v_add_u32 v129, s86, v1
  s_xor_b32 s86, s48, 2
  s_mul_i32 s86, s86, 12288
  s_add_u32 s86, s86, 110592
  v_add_u32_e64 v130, s86, v1
  v_mfma_f32_32x32x16_bf16 a[240:255], a[68:71], v[84:87], a[240:255]
  s_xor_b32 s86, s48, 3
  s_mul_i32 s86, s86, 12288
  s_add_u32 s86, s86, 114688
  v_add_u32 v131, s86, v1
  s_mul_i32 s86, s48, 12288
  s_add_u32 s86, s86, 106496
  v_add_u32_e64 v128, s86, v1
  v_mfma_f32_32x32x16_bf16 v[208:223], a[72:75], v[88:91], v[208:223]
  s_waitcnt lgkmcnt(0)
  s_and_b64 s[76:77], s[76:77], s[78:79]
  s_and_b64 s[80:81], s[80:81], s[82:83]
  s_and_b64 s[76:77], s[76:77], s[80:81]
  s_and_b32 s76, s76, s77
  s_cbranch_scc0 Lc_25
Lr_26:
  s_mov_b32 s90, 4096
  buffer_load_dwordx4 v[32:35], v245, s[44:47], s90 offen sc1
  v_mfma_f32_32x32x16_bf16 v[224:239], a[76:79], v[88:91], v[224:239]
  v_lshlrev_b32_e64 v192, 16, v8
  v_and_b32 v193, 0xffff0000, v8
  v_lshlrev_b32_e64 v194, 16, v9
  v_and_b32 v195, 0xffff0000, v9
  v_lshlrev_b32_e64 v196, 16, v10
  v_and_b32 v197, 0xffff0000, v10
  v_lshlrev_b32_e64 v198, 16, v11
  v_mfma_f32_32x32x16_bf16 a[224:239], a[72:75], v[92:95], a[224:239]
  buffer_load_dwordx4 v[36:39], v246, s[44:47], s90 offen sc1
  v_and_b32 v199, 0xffff0000, v11
  v_lshlrev_b32_e64 v200, 16, v12
  v_and_b32 v201, 0xffff0000, v12
  v_lshlrev_b32_e64 v202, 16, v13
  v_and_b32 v203, 0xffff0000, v13
  v_lshlrev_b32_e64 v204, 16, v14
  v_mfma_f32_32x32x16_bf16 a[240:255], a[76:79], v[92:95], a[240:255]
  v_and_b32 v205, 0xffff0000, v14
  v_lshlrev_b32_e64 v206, 16, v15
  v_and_b32 v207, 0xffff0000, v15
  s_waitcnt vmcnt(15)
  v_mfma_f32_32x32x16_bf16 v[208:223], a[80:83], v[96:99], v[208:223]
  s_mov_b32 s90, 11264
  buffer_load_dwordx4 v[40:43], v245, s[44:47], s90 offen sc1
  v_mfma_f32_32x32x16_bf16 v[224:239], a[84:87], v[96:99], v[224:239]
  s_waitcnt vmcnt(14)
  v_mfma_f32_32x32x16_bf16 a[224:239], a[80:83], v[100:103], a[224:239]
  buffer_load_dwordx4 v[44:47], v246, s[44:47], s90 offen sc1
  v_mfma_f32_32x32x16_bf16 a[240:255], a[84:87], v[100:103], a[240:255]
  s_buffer_load_dwordx4 s[76:79], s[40:43], s85 offset:128
  s_buffer_load_dwordx4 s[80:83], s[40:43], s85 offset:640
  s_mov_b32 s90, 18432
  buffer_load_dwordx4 v[48:51], v245, s[44:47], s90 offen sc1
  s_waitcnt vmcnt(15)
  v_mfma_f32_32x32x16_bf16 v[208:223], a[88:91], v[104:107], v[208:223]
  buffer_load_dwordx4 v[52:55], v246, s[44:47], s90 offen sc1
  v_mfma_f32_32x32x16_bf16 v[224:239], a[92:95], v[104:107], v[224:239]
  s_waitcnt vmcnt(15)
  v_mfma_f32_32x32x16_bf16 a[224:239], a[88:91], v[108:111], a[224:239]
  s_mov_b32 s90, 25600
  buffer_load_dwordx4 v[56:59], v245, s[44:47], s90 offen sc1
  v_mfma_f32_32x32x16_bf16 a[240:255], a[92:95], v[108:111], a[240:255]
  buffer_load_dwordx4 v[60:63], v246, s[44:47], s90 offen sc1
  s_waitcnt vmcnt(16)
  v_mfma_f32_32x32x16_bf16 v[208:223], a[96:99], v[112:115], v[208:223]
  s_waitcnt lgkmcnt(0)
  s_and_b64 s[76:77], s[76:77], s[78:79]
  s_and_b64 s[80:81], s[80:81], s[82:83]
  s_and_b64 s[76:77], s[76:77], s[80:81]
  s_and_b32 s76, s76, s77
  s_cbranch_scc0 Lc_29
Lr_30:
  s_mov_b32 s90, 5120
  buffer_load_dwordx4 v[64:67], v245, s[44:47], s90 offen sc1
  v_mfma_f32_32x32x16_bf16 v[224:239], a[100:103], v[112:115], v[224:239]
  s_waitcnt vmcnt(16)
  v_mfma_f32_32x32x16_bf16 a[224:239], a[96:99], v[116:119], a[224:239]
  buffer_load_dwordx4 v[68:71], v246, s[44:47], s90 offen sc1
  v_mfma_f32_32x32x16_bf16 a[240:255], a[100:103], v[116:119], a[240:255]
  s_mov_b32 s90, 12288
  buffer_load_dwordx4 v[72:75], v245, s[44:47], s90 offen sc1
  s_waitcnt vmcnt(17)
  v_mfma_f32_32x32x16_bf16 v[208:223], a[104:107], v[120:123], v[208:223]
  buffer_load_dwordx4 v[76:79], v246, s[44:47], s90 offen sc1
  v_mfma_f32_32x32x16_bf16 v[224:239], a[108:111], v[120:123], v[224:239]
  s_waitcnt vmcnt(17)
  v_mfma_f32_32x32x16_bf16 a[224:239], a[104:107], v[124:127], a[224:239]
  s_buffer_load_dwordx4 s[76:79], s[40:43], s85 offset:192
  s_buffer_load_dwordx4 s[80:83], s[40:43], s85 offset:704
  s_mov_b32 s90, 19456
  buffer_load_dwordx4 v[80:83], v245, s[44:47], s90 offen sc1
  v_mfma_f32_32x32x16_bf16 a[240:255], a[108:111], v[124:127], a[240:255]
  buffer_load_dwordx4 v[84:87], v246, s[44:47], s90 offen sc1
  s_waitcnt vmcnt(18)
  v_mfma_f32_32x32x16_bf16 v[208:223], a[112:115], v[16:19], v[208:223]
  s_mov_b32 s90, 26624
  buffer_load_dwordx4 v[88:91], v245, s[44:47], s90 offen sc1
  v_mfma_f32_32x32x16_bf16 v[224:239], a[116:119], v[16:19], v[224:239]
  s_waitcnt vmcnt(18)
  v_mfma_f32_32x32x16_bf16 a[224:239], a[112:115], v[20:23], a[224:239]
  buffer_load_dwordx4 v[92:95], v246, s[44:47], s90 offen sc1
  v_mfma_f32_32x32x16_bf16 a[240:255], a[116:119], v[20:23], a[240:255]
  s_waitcnt lgkmcnt(0)
  s_and_b64 s[76:77], s[76:77], s[78:79]
  s_and_b64 s[80:81], s[80:81], s[82:83]
  s_and_b64 s[76:77], s[76:77], s[80:81]
  s_and_b32 s76, s76, s77
  s_cbranch_scc0 Lc_33
Lr_34:
  s_mov_b32 s90, 6144
  buffer_load_dwordx4 v[96:99], v245, s[44:47], s90 offen sc1
  s_waitcnt vmcnt(19)
  v_mfma_f32_32x32x16_bf16 v[208:223], a[120:123], v[24:27], v[208:223]
  buffer_load_dwordx4 v[100:103], v246, s[44:47], s90 offen sc1
  v_mfma_f32_32x32x16_bf16 v[224:239], a[124:127], v[24:27], v[224:239]
  s_waitcnt vmcnt(18)
  v_mfma_f32_32x32x16_bf16 a[224:239], a[120:123], v[28:31], a[224:239]
  s_mov_b32 s90, 13312
  buffer_load_dwordx4 v[104:107], v245, s[44:47], s90 offen sc1
  v_mfma_f32_32x32x16_bf16 a[240:255], a[124:127], v[28:31], a[240:255]
  buffer_load_dwordx4 v[108:111], v246, s[44:47], s90 offen sc1
  s_waitcnt vmcnt(19)
  v_mfma_f32_32x32x16_bf16 v[208:223], a[128:131], v[32:35], v[208:223]
  s_mov_b32 s90, 20480
  buffer_load_dwordx4 v[112:115], v245, s[44:47], s90 offen sc1
  v_mfma_f32_32x32x16_bf16 v[224:239], a[132:135], v[32:35], v[224:239]
  s_waitcnt vmcnt(19)
  v_mfma_f32_32x32x16_bf16 a[224:239], a[128:131], v[36:39], a[224:239]
  buffer_load_dwordx4 v[116:119], v246, s[44:47], s90 offen sc1
  v_mfma_f32_32x32x16_bf16 a[240:255], a[132:135], v[36:39], a[240:255]
  s_waitcnt vmcnt(19)
  v_mfma_f32_32x32x16_bf16 v[208:223], a[136:139], v[40:43], v[208:223]
  s_mov_b32 s90, 27648
  buffer_load_dwordx4 v[120:123], v245, s[44:47], s90 offen sc1
  v_mfma_f32_32x32x16_bf16 v[224:239], a[140:143], v[40:43], v[224:239]
  s_waitcnt vmcnt(19)
  v_mfma_f32_32x32x16_bf16 a[224:239], a[136:139], v[44:47], a[224:239]
  buffer_load_dwordx4 v[124:127], v246, s[44:47], s90 offen sc1
  v_mfma_f32_32x32x16_bf16 a[240:255], a[140:143], v[44:47], a[240:255]
  s_waitcnt vmcnt(19)
  v_mfma_f32_32x32x16_bf16 v[208:223], a[144:147], v[48:51], v[208:223]
  s_add_u32 m0, s65, 0
  s_nop 0
  buffer_load_dwordx4 v243, s[4:7], m0 offen offset:0 sc1 lds
  v_mfma_f32_32x32x16_bf16 v[224:239], a[148:151], v[48:51], v[224:239]
  s_waitcnt vmcnt(19)
  v_mfma_f32_32x32x16_bf16 a[224:239], a[144:147], v[52:55], a[224:239]
  buffer_load_dwordx4 v243, s[4:7], m0 offen offset:1024 sc1 lds
  v_mfma_f32_32x32x16_bf16 a[240:255], a[148:151], v[52:55], a[240:255]
  s_waitcnt vmcnt(19)
  v_mfma_f32_32x32x16_bf16 v[208:223], a[152:155], v[56:59], v[208:223]
  s_add_u32 m0, s65, 8192
  s_nop 0
  buffer_load_dwordx4 v243, s[4:7], m0 offen offset:0 sc1 lds
  v_mfma_f32_32x32x16_bf16 v[224:239], a[156:159], v[56:59], v[224:239]
  s_waitcnt vmcnt(19)
  v_mfma_f32_32x32x16_bf16 a[224:239], a[152:155], v[60:63], a[224:239]
  buffer_load_dwordx4 v243, s[4:7], m0 offen offset:1024 sc1 lds
  v_mfma_f32_32x32x16_bf16 a[240:255], a[156:159], v[60:63], a[240:255]
  s_waitcnt vmcnt(18)
  v_mfma_f32_32x32x16_bf16 a[240:255], a[164:167], v[68:71], a[240:255]
  s_add_u32 m0, s65, 16384
  s_nop 0
  buffer_load_dwordx4 v243, s[4:7], m0 offen offset:0 sc1 lds
  s_waitcnt vmcnt(17)
  v_mfma_f32_32x32x16_bf16 a[240:255], a[172:175], v[76:79], a[240:255]
  s_waitcnt vmcnt(15)
  v_mfma_f32_32x32x16_bf16 a[240:255], a[180:183], v[84:87], a[240:255]
  buffer_load_dwordx4 v243, s[4:7], m0 offen offset:1024 sc1 lds
  s_waitcnt vmcnt(14)
  v_mfma_f32_32x32x16_bf16 a[240:255], a[188:191], v[92:95], a[240:255]
  s_waitcnt vmcnt(12)
  v_mfma_f32_32x32x16_bf16 a[240:255], a[196:199], v[100:103], a[240:255]
  s_add_u32 m0, s65, 24576
  s_nop 0
  buffer_load_dwordx4 v243, s[4:7], m0 offen offset:0 sc1 lds
  s_waitcnt vmcnt(11)
  v_mfma_f32_32x32x16_bf16 a[240:255], a[204:207], v[108:111], a[240:255]
  s_waitcnt vmcnt(9)
  v_mfma_f32_32x32x16_bf16 a[240:255], a[212:215], v[116:119], a[240:255]
  buffer_load_dwordx4 v243, s[4:7], m0 offen offset:1024 sc1 lds
  s_waitcnt vmcnt(8)
  v_mfma_f32_32x32x16_bf16 a[240:255], a[220:223], v[124:127], a[240:255]
  v_mfma_f32_32x32x16_bf16 a[224:239], a[160:163], v[68:71], a[224:239]
  s_add_u32 m0, s65, 32768
  s_nop 0
  buffer_load_dwordx4 v243, s[4:7], m0 offen offset:0 sc1 lds
  v_mfma_f32_32x32x16_bf16 a[224:239], a[168:171], v[76:79], a[224:239]
  ds_write_b128 v131, a[240:243] offset:0
  v_mfma_f32_32x32x16_bf16 a[224:239], a[176:179], v[84:87], a[224:239]
  buffer_load_dwordx4 v243, s[4:7], m0 offen offset:1024 sc1 lds
  v_mfma_f32_32x32x16_bf16 a[224:239], a[184:187], v[92:95], a[224:239]
  ds_write_b128 v131, a[244:247] offset:1024
  v_mfma_f32_32x32x16_bf16 a[224:239], a[192:195], v[100:103], a[224:239]
  s_add_u32 m0, s65, 40960
  s_nop 0
  buffer_load_dwordx4 v243, s[4:7], m0 offen offset:0 sc1 lds
  v_mfma_f32_32x32x16_bf16 a[224:239], a[200:203], v[108:111], a[224:239]
  ds_write_b128 v131, a[248:251] offset:2048
  v_mfma_f32_32x32x16_bf16 a[224:239], a[208:211], v[116:119], a[224:239]
  buffer_load_dwordx4 v243, s[4:7], m0 offen offset:1024 sc1 lds
  v_mfma_f32_32x32x16_bf16 a[224:239], a[216:219], v[124:127], a[224:239]
  ds_write_b128 v131, a[252:255] offset:3072
  v_mfma_f32_32x32x16_bf16 v[224:239], a[164:167], v[64:67], v[224:239]
  s_add_u32 m0, s65, 49152
  s_nop 0
  buffer_load_dwordx4 v243, s[4:7], m0 offen offset:0 sc1 lds
  v_mfma_f32_32x32x16_bf16 v[224:239], a[172:175], v[72:75], v[224:239]
  ds_write_b128 v130, a[224:227] offset:0
  v_mfma_f32_32x32x16_bf16 v[224:239], a[180:183], v[80:83], v[224:239]
  buffer_load_dwordx4 v243, s[4:7], m0 offen offset:1024 sc1 lds
  v_mfma_f32_32x32x16_bf16 v[224:239], a[188:191], v[88:91], v[224:239]
  ds_write_b128 v130, a[228:231] offset:1024
  v_mfma_f32_32x32x16_bf16 v[224:239], a[196:199], v[96:99], v[224:239]
  s_add_u32 m0, s65, 57344
  s_nop 0
  buffer_load_dwordx4 v243, s[4:7], m0 offen offset:0 sc1 lds
  v_mfma_f32_32x32x16_bf16 v[224:239], a[204:207], v[104:107], v[224:239]
  ds_write_b128 v130, a[232:235] offset:2048
  v_mfma_f32_32x32x16_bf16 v[224:239], a[212:215], v[112:115], v[224:239]
  buffer_load_dwordx4 v243, s[4:7], m0 offen offset:1024 sc1 lds
  v_mfma_f32_32x32x16_bf16 v[224:239], a[220:223], v[120:123], v[224:239]
  ds_write_b128 v130, a[236:239] offset:3072
  v_mfma_f32_32x32x16_bf16 v[208:223], a[160:163], v[64:67], v[208:223]
  s_add_u32 m0, s65, 65536
  s_nop 0
  buffer_load_dwordx4 v243, s[4:7], m0 offen offset:0 sc1 lds
  v_mfma_f32_32x32x16_bf16 v[208:223], a[168:171], v[72:75], v[208:223]
  ds_write_b128 v129, v[224:227] offset:0
  v_mfma_f32_32x32x16_bf16 v[208:223], a[176:179], v[80:83], v[208:223]
  buffer_load_dwordx4 v243, s[4:7], m0 offen offset:1024 sc1 lds
  v_mfma_f32_32x32x16_bf16 v[208:223], a[184:187], v[88:91], v[208:223]
  ds_write_b128 v129, v[228:231] offset:1024
  v_mfma_f32_32x32x16_bf16 v[208:223], a[192:195], v[96:99], v[208:223]
  s_add_u32 m0, s65, 73728
  s_nop 0
  buffer_load_dwordx4 v243, s[4:7], m0 offen offset:0 sc1 lds
  v_mfma_f32_32x32x16_bf16 v[208:223], a[200:203], v[104:107], v[208:223]
  ds_write_b128 v129, v[232:235] offset:2048
  v_mfma_f32_32x32x16_bf16 v[208:223], a[208:211], v[112:115], v[208:223]
  buffer_load_dwordx4 v243, s[4:7], m0 offen offset:1024 sc1 lds
  v_mfma_f32_32x32x16_bf16 v[208:223], a[216:219], v[120:123], v[208:223]
  ds_write_b128 v129, v[236:239] offset:3072
  s_waitcnt lgkmcnt(0)
  s_barrier
  ds_read_b128 v[16:19], v128 offset:0
  ds_read_b128 v[20:23], v128 offset:1024
  ds_read_b128 v[24:27], v128 offset:2048
  ds_read_b128 v[28:31], v128 offset:3072
  ds_read_b128 v[32:35], v128 offset:4096
  ds_read_b128 v[36:39], v128 offset:5120
  ds_read_b128 v[40:43], v128 offset:6144
  ds_read_b128 v[44:47], v128 offset:7168
  ds_read_b128 v[48:51], v128 offset:8192
  ds_read_b128 v[52:55], v128 offset:9216
  ds_read_b128 v[56:59], v128 offset:10240
  ds_read_b128 v[60:63], v128 offset:11264
  s_add_u32 s86, s97, 3145728
  s_add_u32 s87, s98, 262144
  s_add_u32 s96, s99, 16941056
  v_pk_add_f32 v[208:209], v[208:209], v[192:193]
  v_pk_add_f32 v[210:211], v[210:211], v[194:195]
  v_pk_add_f32 v[212:213], v[212:213], v[196:197]
  v_pk_add_f32 v[214:215], v[214:215], v[198:199]
  v_pk_add_f32 v[216:217], v[216:217], v[200:201]
  v_pk_add_f32 v[218:219], v[218:219], v[202:203]
  v_pk_add_f32 v[220:221], v[220:221], v[204:205]
  v_pk_add_f32 v[222:223], v[222:223], v[206:207]
  v_mov_b32 v192, 0
  v_mov_b32 v193, 0
  s_waitcnt lgkmcnt(8)
  v_pk_add_f32 v[208:209], v[208:209], v[16:17]
  v_pk_add_f32 v[210:211], v[210:211], v[18:19]
  v_pk_add_f32 v[212:213], v[212:213], v[20:21]
  v_pk_add_f32 v[214:215], v[214:215], v[22:23]
  v_pk_add_f32 v[216:217], v[216:217], v[24:25]
  v_pk_add_f32 v[218:219], v[218:219], v[26:27]
  v_pk_add_f32 v[220:221], v[220:221], v[28:29]
  v_pk_add_f32 v[222:223], v[222:223], v[30:31]
  s_waitcnt lgkmcnt(4)
  v_pk_add_f32 v[208:209], v[208:209], v[32:33]
  v_pk_add_f32 v[210:211], v[210:211], v[34:35]
  v_pk_add_f32 v[212:213], v[212:213], v[36:37]
  v_pk_add_f32 v[214:215], v[214:215], v[38:39]
  v_pk_add_f32 v[216:217], v[216:217], v[40:41]
  v_pk_add_f32 v[218:219], v[218:219], v[42:43]
  v_pk_add_f32 v[220:221], v[220:221], v[44:45]
  v_pk_add_f32 v[222:223], v[222:223], v[46:47]
  s_waitcnt lgkmcnt(0)
  v_pk_add_f32 v[208:209], v[208:209], v[48:49]
  v_pk_add_f32 v[210:211], v[210:211], v[50:51]
  v_pk_add_f32 v[212:213], v[212:213], v[52:53]
  v_pk_add_f32 v[214:215], v[214:215], v[54:55]
  v_pk_add_f32 v[216:217], v[216:217], v[56:57]
  v_pk_add_f32 v[218:219], v[218:219], v[58:59]
  v_pk_add_f32 v[220:221], v[220:221], v[60:61]
  v_pk_add_f32 v[222:223], v[222:223], v[62:63]
  v_cvt_pk_bf16_f32 v8, v208, v209
  v_cvt_pk_bf16_f32 v9, v210, v211
  v_cvt_pk_bf16_f32 v10, v212, v213
  v_cvt_pk_bf16_f32 v11, v214, v215
  v_cvt_pk_bf16_f32 v12, v216, v217
  v_cvt_pk_bf16_f32 v13, v218, v219
  v_cvt_pk_bf16_f32 v14, v220, v221
  v_cvt_pk_bf16_f32 v15, v222, v223
  buffer_store_dwordx4 v[8:11], v1, s[44:47], s86 offen
  buffer_store_dwordx4 v[12:15], v1, s[44:47], s86 offen offset:1024
  v_dot2c_f32_bf16 v192, s84, v8
  v_dot2c_f32_bf16 v193, v8, v8
  v_dot2c_f32_bf16 v192, s84, v9
  v_dot2c_f32_bf16 v193, v9, v9
  v_dot2c_f32_bf16 v192, s84, v10
  v_dot2c_f32_bf16 v193, v10, v10
  v_dot2c_f32_bf16 v192, s84, v11
  v_dot2c_f32_bf16 v193, v11, v11
  v_dot2c_f32_bf16 v192, s84, v12
  v_dot2c_f32_bf16 v193, v12, v12
  v_dot2c_f32_bf16 v192, s84, v13
  v_dot2c_f32_bf16 v193, v13, v13
  v_dot2c_f32_bf16 v192, s84, v14
  v_dot2c_f32_bf16 v193, v14, v14
  v_dot2c_f32_bf16 v192, s84, v15
  v_dot2c_f32_bf16 v193, v15, v15
  s_nop 1
  v_mov_b32 v194, v192
  v_mov_b32 v195, v193
  s_nop 0
  v_permlane32_swap_b32 v192, v194
  v_permlane32_swap_b32 v193, v195
  v_pk_add_f32 v[192:193], v[192:193], v[194:195]
  s_mov_b32 exec_hi, 0
  buffer_store_dwordx2 v[192:193], v1, s[44:47], s87 offen
  s_mov_b64 exec, -1
  s_add_u32 m0, s65, 81920
  s_nop 0
  buffer_load_dwordx4 v243, s[4:7], m0 offen offset:0 sc1 lds
  buffer_load_dwordx4 v243, s[4:7], m0 offen offset:1024 sc1 lds
  v_and_b32 v240, 15, v0
  v_min_u32_e64 v240, 13, v240
  v_lshlrev_b32 v240, 5, v240
  s_lshl_b32 s88, s56, 9
  s_add_u32 s88, s88, 16941056
  s_lshl_b32 s89, s56, 12
  s_add_u32 s89, s89, 262144
  s_mul_i32 s90, s56, 28672
  s_add_u32 s90, s90, 3145728
  s_and_b32 s86, s64, 0x400
  v_add_u32 v206, s86, v1
  v_xor_b32 v207, 0x400, v206
  v_and_b32_e64 v210, 27, v0
  v_cmp_eq_u32 vcc, 26, v210
  s_nop 1
  v_cndmask_b32 v210, 0, 1.0, vcc
  v_mov_b32_e64 v211, v210
  s_add_u32 s86, s66, 90112
  v_and_b32_e64 v208, 31, v0
  v_lshl_add_u32 v208, v208, 2, s86
  v_lshrrev_b32_e64 v209, 5, v0
  v_lshl_add_u32 v209, v209, 4, s86
  s_add_u32 s86, s68, 0xfffe6000
  v_add_u32 v204, s86, v1
  s_waitcnt vmcnt(2)
  v_mov_b32 v254, 1
  s_mov_b64 exec, 1
  buffer_store_dword v254, off, s[40:43], s96 offset:0
  s_mov_b64 exec, -1
L_p4skip0:
Lpoll_37:
  buffer_load_dword v254, v240, s[40:43], s88 offen offset:0 sc1
  s_sub_u32 s54, s54, 1
  s_max_i32 s54, s54, 0
  s_cselect_b64 s[92:93], exec, 0
  s_waitcnt vmcnt(0)
  v_cmp_ne_u32 vcc, 1, v254
  s_nop 0
  s_and_b64 exec, s[92:93], vcc
  s_cbranch_scc1 Lpoll_37
  s_mov_b64 exec, -1
  buffer_load_dwordx4 v[16:19], v1, s[44:47], s90 offen offset:0 sc1
  buffer_load_dwordx4 v[20:23], v1, s[44:47], s90 offen offset:1024 sc1
  buffer_load_dwordx4 v[24:27], v1, s[44:47], s90 offen offset:2048 sc1
  buffer_load_dwordx4 v[28:31], v1, s[44:47], s90 offen offset:3072 sc1
  s_add_u32 s40, s40, 16777216
  s_addc_u32 s41, s41, 0
  s_barrier
  ds_read_b128 v[176:179], v1 offset:0
  ds_read_b128 v[180:183], v1 offset:1024
  ds_read_b128 v[184:187], v1 offset:3072
  ds_read_b128 v[188:191], v1 offset:4096
  s_add_u32 s90, s90, 4096
  buffer_load_dwordx4 v[32:35], v1, s[44:47], s90 offen offset:0 sc1
  buffer_load_dwordx4 v[36:39], v1, s[44:47], s90 offen offset:1024 sc1
  buffer_load_dwordx4 v[40:43], v1, s[44:47], s90 offen offset:2048 sc1
  buffer_load_dwordx4 v[44:47], v1, s[44:47], s90 offen offset:3072 sc1
  s_waitcnt vmcnt(7) lgkmcnt(2)
  v_mfma_f32_32x32x16_bf16 v[128:143], v[16:19], v[176:179], 0
  ds_read_b128 v[192:195], v1 offset:6144
  s_add_u32 s90, s90, 4096
  buffer_load_dwordx4 v[48:51], v1, s[44:47], s90 offen offset:0 sc1
  v_mfma_f32_32x32x16_bf16 v[144:159], v[16:19], v[180:183], 0
  ds_read_b128 v[196:199], v1 offset:7168
  buffer_load_dwordx4 v[216:219], v1, s[44:47], s89 offen offset:0 sc1
  s_waitcnt vmcnt(8) lgkmcnt(2)
  v_mfma_f32_32x32x16_bf16 v[128:143], v[20:23], v[184:187], v[128:143]
  ds_read_b128 v[176:179], v1 offset:9216
  buffer_load_dwordx4 v[52:55], v1, s[44:47], s90 offen offset:1024 sc1
  v_mfma_f32_32x32x16_bf16 v[144:159], v[20:23], v[188:191], v[144:159]
  ds_read_b128 v[180:183], v1 offset:10240
  s_waitcnt vmcnt(8) lgkmcnt(2)
  v_mfma_f32_32x32x16_bf16 v[128:143], v[24:27], v[192:195], v[128:143]
  ds_read_b128 v[184:187], v1 offset:12288
  buffer_load_dwordx4 v[56:59], v1, s[44:47], s90 offen offset:2048 sc1
  v_mfma_f32_32x32x16_bf16 v[144:159], v[24:27], v[196:199], v[144:159]
  ds_read_b128 v[188:191], v1 offset:13312
  buffer_load_dwordx4 v[220:223], v1, s[44:47], s89 offen offset:1024 sc1
  s_waitcnt vmcnt(9) lgkmcnt(2)
  v_mfma_f32_32x32x16_bf16 v[128:143], v[28:31], v[176:179], v[128:143]
  ds_read_b128 v[192:195], v1 offset:15360
  buffer_load_dwordx4 v[60:63], v1, s[44:47], s90 offen offset:3072 sc1
  v_mfma_f32_32x32x16_bf16 v[144:159], v[28:31], v[180:183], v[144:159]
  ds_read_b128 v[196:199], v1 offset:16384
  s_waitcnt vmcnt(9) lgkmcnt(2)
  v_mfma_f32_32x32x16_bf16 v[128:143], v[32:35], v[184:187], v[128:143]
  ds_read_b128 v[176:179], v1 offset:18432
  s_add_u32 s90, s90, 4096
  buffer_load_dwordx4 v[64:67], v1, s[44:47], s90 offen offset:0 sc1
  v_mfma_f32_32x32x16_bf16 v[144:159], v[32:35], v[188:191], v[144:159]
  ds_read_b128 v[180:183], v1 offset:19456
  buffer_load_dwordx4 v[224:227], v1, s[44:47], s89 offen offset:2048 sc1
  s_waitcnt vmcnt(10) lgkmcnt(2)
  v_mfma_f32_32x32x16_bf16 v[128:143], v[36:39], v[192:195], v[128:143]
  ds_read_b128 v[184:187], v1 offset:21504
  buffer_load_dwordx4 v[68:71], v1, s[44:47], s90 offen offset:1024 sc1
  v_mfma_f32_32x32x16_bf16 v[144:159], v[36:39], v[196:199], v[144:159]
  ds_read_b128 v[188:191], v1 offset:22528
  s_waitcnt vmcnt(10) lgkmcnt(2)
  v_mfma_f32_32x32x16_bf16 v[128:143], v[40:43], v[176:179], v[128:143]
  ds_read_b128 v[192:195], v1 offset:24576
  buffer_load_dwordx4 v[72:75], v1, s[44:47], s90 offen offset:2048 sc1
  v_mfma_f32_32x32x16_bf16 v[144:159], v[40:43], v[180:183], v[144:159]
  ds_read_b128 v[196:199], v1 offset:25600
  buffer_load_dwordx4 v[228:231], v1, s[44:47], s89 offen offset:3072 sc1
  s_waitcnt vmcnt(11) lgkmcnt(2)
  v_mfma_f32_32x32x16_bf16 v[128:143], v[44:47], v[184:187], v[128:143]
  ds_read_b128 v[176:179], v1 offset:27648
  buffer_load_dwordx4 v[76:79], v1, s[44:47], s90 offen offset:3072 sc1
  v_mfma_f32_32x32x16_bf16 v[144:159], v[44:47], v[188:191], v[144:159]
  ds_read_b128 v[180:183], v1 offset:28672
  s_waitcnt vmcnt(11) lgkmcnt(2)
  v_mfma_f32_32x32x16_bf16 v[128:143], v[48:51], v[192:195], v[128:143]
  ds_read_b128 v[184:187], v1 offset:30720
  s_add_u32 s90, s90, 4096
  buffer_load_dwordx4 v[80:83], v1, s[44:47], s90 offen offset:0 sc1
  v_mfma_f32_32x32x16_bf16 v[144:159], v[48:51], v[196:199], v[144:159]
  ds_read_b128 v[188:191], v1 offset:31744
  s_waitcnt vmcnt(10) lgkmcnt(2)
  v_mfma_f32_32x32x16_bf16 v[128:143], v[52:55], v[176:179], v[128:143]
  ds_read_b128 v[192:195], v1 offset:33792
  buffer_load_dwordx4 v[84:87], v1, s[44:47], s90 offen offset:1024 sc1
  v_mfma_f32_32x32x16_bf16 v[144:159], v[52:55], v[180:183], v[144:159]
  ds_read_b128 v[196:199], v1 offset:34816
  s_waitcnt vmcnt(10) lgkmcnt(2)
  v_mfma_f32_32x32x16_bf16 v[128:143], v[56:59], v[184:187], v[128:143]
  ds_read_b128 v[176:179], v1 offset:36864
  buffer_load_dwordx4 v[88:91], v1, s[44:47], s90 offen offset:2048 sc1
  v_mfma_f32_32x32x16_bf16 v[144:159], v[56:59], v[188:191], v[144:159]
  ds_read_b128 v[180:183], v1 offset:37888
  s_waitcnt vmcnt(9) lgkmcnt(2)
  v_mfma_f32_32x32x16_bf16 v[128:143], v[60:63], v[192:195], v[128:143]
  ds_read_b128 v[184:187], v1 offset:39936
  buffer_load_dwordx4 v[92:95], v1, s[44:47], s90 offen offset:3072 sc1
  v_mfma_f32_32x32x16_bf16 v[144:159], v[60:63], v[196:199], v[144:159]
  ds_read_b128 v[188:191], v1 offset:40960
  s_waitcnt vmcnt(9) lgkmcnt(2)
  v_mfma_f32_32x32x16_bf16 v[128:143], v[64:67], v[176:179], v[128:143]
  ds_read_b128 v[192:195], v1 offset:43008
  s_add_u32 s90, s90, 4096
  buffer_load_dwordx4 v[96:99], v1, s[44:47], s90 offen offset:0 sc1
  v_mfma_f32_32x32x16_bf16 v[144:159], v[64:67], v[180:183], v[144:159]
  ds_read_b128 v[196:199], v1 offset:44032
  s_waitcnt vmcnt(8) lgkmcnt(2)
  v_mfma_f32_32x32x16_bf16 v[128:143], v[68:71], v[184:187], v[128:143]
  ds_read_b128 v[176:179], v1 offset:46080
  buffer_load_dwordx4 v[100:103], v1, s[44:47], s90 offen offset:1024 sc1
  v_mfma_f32_32x32x16_bf16 v[144:159], v[68:71], v[188:191], v[144:159]
  ds_read_b128 v[180:183], v1 offset:47104
  s_waitcnt vmcnt(8) lgkmcnt(2)
  v_mfma_f32_32x32x16_bf16 v[128:143], v[72:75], v[192:195], v[128:143]
  ds_read_b128 v[184:187], v1 offset:49152
  buffer_load_dwordx4 v[104:107], v1, s[44:47], s90 offen offset:2048 sc1
  v_mfma_f32_32x32x16_bf16 v[144:159], v[72:75], v[196:199], v[144:159]
  ds_read_b128 v[188:191], v1 offset:50176
  s_waitcnt vmcnt(8)
  s_waitcnt vmcnt(7) lgkmcnt(2)
  v_mfma_f32_32x32x16_bf16 v[128:143], v[76:79], v[176:179], v[128:143]
  ds_read_b128 v[192:195], v1 offset:52224
  buffer_load_dwordx4 v[108:111], v1, s[44:47], s90 offen offset:3072 sc1
  v_add_f32 v216, v216, v218
  v_add_f32 v217, v217, v219
  v_add_f32 v216, v216, v220
  v_add_f32 v217, v217, v221
  v_add_f32 v216, v216, v222
  v_mfma_f32_32x32x16_bf16 v[144:159], v[76:79], v[180:183], v[144:159]
  ds_read_b128 v[196:199], v1 offset:53248
  v_add_f32 v217, v217, v223
  v_add_f32 v216, v216, v224
  v_add_f32 v217, v217, v225
  v_add_f32 v216, v216, v226
  v_add_f32_e64 v217, v217, v227
  v_add_f32 v216, v216, v228
  s_waitcnt vmcnt(7) lgkmcnt(2)
  v_mfma_f32_32x32x16_bf16 v[128:143], v[80:83], v[184:187], v[128:143]
  ds_read_b128 v[176:179], v1 offset:55296
  s_add_u32 s90, s90, 4096
  buffer_load_dwordx4 v[112:115], v1, s[44:47], s90 offen offset:0 sc1
  v_add_f32 v217, v217, v229
  v_mov_b32 v218, v216
  v_mov_b32_e64 v219, v217
  s_nop 0
  v_permlane32_swap_b32 v216, v218
  v_mfma_f32_32x32x16_bf16 v[144:159], v[80:83], v[188:191], v[144:159]
  ds_read_b128 v[180:183], v1 offset:56320
  v_permlane32_swap_b32 v217, v219
  v_add_f32 v216, v216, v218
  v_add_f32_e64 v217, v217, v219
  v_mul_f32 v216, 0x3b124925, v216
  v_mul_f32 v217, 0x3b124925, v217
  v_fma_f32 v217, -v216, v216, v217
  s_waitcnt vmcnt(7) lgkmcnt(2)
  v_mfma_f32_32x32x16_bf16 v[128:143], v[84:87], v[192:195], v[128:143]
  ds_read_b128 v[184:187], v1 offset:58368
  buffer_load_dwordx4 v[116:119], v1, s[44:47], s90 offen offset:1024 sc1
  v_max_f32 v217, 0, v217
  v_add_f32 v217, 0x3727c5ac, v217
  v_rsq_f32_e64 v248, v217
  v_cvt_pk_bf16_f32 v200, -v216, -v216
  v_mfma_f32_32x32x16_bf16 v[144:159], v[84:87], v[196:199], v[144:159]
  ds_read_b128 v[188:191], v1 offset:59392
  v_mul_f32_e64 v250, v217, v248
  v_mul_f32 v249, 0x3fb8aa3b, v248
  v_mov_b32 v201, v200
  v_mov_b32 v202, v200
  v_mov_b32 v203, v200
  s_waitcnt vmcnt(7) lgkmcnt(2)
  v_mfma_f32_32x32x16_bf16 v[128:143], v[88:91], v[176:179], v[128:143]
  ds_read_b128 v[192:195], v1 offset:61440
  buffer_load_dwordx4 v[120:123], v1, s[44:47], s90 offen offset:2048 sc1
  v_mfma_f32_32x32x16_bf16 v[144:159], v[88:91], v[180:183], v[144:159]
  ds_read_b128 v[196:199], v1 offset:62464
  s_waitcnt vmcnt(7) lgkmcnt(2)
  v_mfma_f32_32x32x16_bf16 v[128:143], v[92:95], v[184:187], v[128:143]
  ds_read_b128 v[176:179], v1 offset:64512
  buffer_load_dwordx4 v[124:127], v1, s[44:47], s90 offen offset:3072 sc1
  v_mfma_f32_32x32x16_bf16 v[144:159], v[92:95], v[188:191], v[144:159]
  ds_read_b128 v[180:183], v2 offset:0
  s_waitcnt vmcnt(7) lgkmcnt(2)
  v_mfma_f32_32x32x16_bf16 v[128:143], v[96:99], v[192:195], v[128:143]
  v_and_b32 v205, 3, v0
  v_lshlrev_b32 v205, 7, v205
  ds_read_b128 v[184:187], v2 offset:2048
  global_load_dword v212, v205, s[100:101]
  v_mfma_f32_32x32x16_bf16 v[144:159], v[96:99], v[196:199], v[144:159]
  ds_read_b128 v[188:191], v2 offset:3072
  s_waitcnt vmcnt(7) lgkmcnt(2)
  v_mfma_f32_32x32x16_bf16 v[128:143], v[100:103], v[176:179], v[128:143]
  s_add_u32 m0, s65, 106496
  ds_read_b128 v[192:195], v2 offset:5120
  buffer_load_dwordx4 v204, s[4:7], m0 offen offset:0 sc1 lds
  v_mfma_f32_32x32x16_bf16 v[144:159], v[100:103], v[180:183], v[144:159]
  ds_read_b128 v[196:199], v2 offset:6144
  s_waitcnt vmcnt(7) lgkmcnt(2)
  v_mfma_f32_32x32x16_bf16 v[128:143], v[104:107], v[184:187], v[128:143]
  ds_read_b128 v[176:179], v2 offset:8192
  buffer_load_dwordx4 v204, s[4:7], m0 offen offset:1024 sc1 lds
  v_mfma_f32_32x32x16_bf16 v[144:159], v[104:107], v[188:191], v[144:159]
  ds_read_b128 v[180:183], v2 offset:9216
  s_waitcnt vmcnt(7) lgkmcnt(2)
  v_mfma_f32_32x32x16_bf16 v[128:143], v[108:111], v[192:195], v[128:143]
  s_add_u32 m0, s65, 114688
  ds_read_b128 v[184:187], v2 offset:11264
  buffer_load_dwordx4 v204, s[4:7], m0 offen offset:0 sc1 lds
  v_mfma_f32_32x32x16_bf16 v[144:159], v[108:111], v[196:199], v[144:159]
  ds_read_b128 v[188:191], v2 offset:12288
  ds_write2_b32 v208, v248, v249 offset0:0 offset1:32
  s_waitcnt vmcnt(7) lgkmcnt(3)
  v_mfma_f32_32x32x16_bf16 v[128:143], v[112:115], v[176:179], v[128:143]
  ds_read_b128 v[192:195], v2 offset:14336
  buffer_load_dwordx4 v204, s[4:7], m0 offen offset:1024 sc1 lds
  v_mfma_f32_32x32x16_bf16 v[144:159], v[112:115], v[180:183], v[144:159]
  ds_read_b128 v[196:199], v2 offset:15360
  ds_read_b128 v[160:163], v209 offset:0
  ds_read_b128 v[216:219], v209 offset:128
  s_waitcnt vmcnt(7) lgkmcnt(5)
  v_mfma_f32_32x32x16_bf16 v[128:143], v[116:119], v[184:187], v[128:143]
  s_add_u32 m0, s65, 122880
  ds_read_b128 v[176:179], v2 offset:17408
  buffer_load_dwordx4 v204, s[4:7], m0 offen offset:0 sc1 lds
  v_mfma_f32_32x32x16_bf16 v[144:159], v[116:119], v[188:191], v[144:159]
  ds_read_b128 v[180:183], v2 offset:18432
  ds_read_b128 v[164:167], v209 offset:32
  ds_read_b128 v[220:223], v209 offset:160
  s_waitcnt vmcnt(7) lgkmcnt(6)
  v_mfma_f32_32x32x16_bf16 v[128:143], v[120:123], v[192:195], v[128:143]
  v_add_u32 v252, 0x15000, v5
  ds_read2_b32 v[184:185], v252 offset0:0 offset1:32
  ds_read2_b32 v[186:187], v252 offset0:64 offset1:96
  buffer_load_dwordx4 v204, s[4:7], m0 offen offset:1024 sc1 lds
  v_mfma_f32_32x32x16_bf16 v[144:159], v[120:123], v[196:199], v[144:159]
  v_add_u32 v253, 0x15400, v5
  ds_read2_b32 v[188:189], v253 offset0:0 offset1:32
  ds_read2_b32 v[190:191], v253 offset0:64 offset1:96
  ds_read_b128 v[168:171], v209 offset:64
  ds_read_b128 v[224:227], v209 offset:192
  s_waitcnt vmcnt(7) lgkmcnt(8)
  v_mfma_f32_32x32x16_bf16 v[128:143], v[124:127], v[176:179], v[128:143]
  s_add_u32 m0, s65, 131072
  s_nop 0
  buffer_load_dwordx4 v204, s[4:7], m0 offen offset:0 sc1 lds
  v_mfma_f32_32x32x16_bf16 v[144:159], v[124:127], v[180:183], v[144:159]
  ds_read_b128 v[172:175], v209 offset:96
  ds_read_b128 v[228:231], v209 offset:224
  s_waitcnt lgkmcnt(4)
  v_mfma_f32_32x32x16_bf16 v[128:143], v[200:203], v[184:187], v[128:143]
  buffer_load_dwordx4 v204, s[4:7], m0 offen offset:1024 sc1 lds
  v_mfma_f32_32x32x16_bf16 v[144:159], v[200:203], v[188:191], v[144:159]
  ds_read_b128 v[176:179], v1 offset:2048
  ds_read_b128 v[180:183], v1 offset:5120
  ds_read_b128 v[184:187], v1 offset:8192
  ds_read_b128 v[188:191], v1 offset:11264
  s_lshl_b32 s87, s50, 12
  s_add_u32 s87, s87, s64
  s_waitcnt lgkmcnt(4)
  v_pk_mul_f32 v[128:129], v[128:129], v[216:217]
  v_pk_mul_f32 v[130:131], v[130:131], v[218:219]
  v_pk_mul_f32 v[132:133], v[132:133], v[220:221]
  v_pk_mul_f32 v[134:135], v[134:135], v[222:223]
  v_pk_mul_f32 v[136:137], v[136:137], v[224:225]
  v_pk_mul_f32 v[138:139], v[138:139], v[226:227]
  v_pk_mul_f32 v[140:141], v[140:141], v[228:229]
  v_pk_mul_f32 v[142:143], v[142:143], v[230:231]
  v_exp_f32_e64 v216, v128 clamp
  v_max_f32_e64 v128, 0, v128
  s_add_u32 m0, s65, 139264
  s_nop 0
  buffer_load_dwordx4 v204, s[4:7], m0 offen offset:0 sc1 lds
  v_exp_f32_e64 v217, v129 clamp
  v_max_f32 v129, 0, v129
  v_exp_f32_e64 v218, v130 clamp
  v_max_f32_e64 v130, 0, v130
  v_exp_f32_e64 v219, v131 clamp
  v_max_f32_e64 v131, 0, v131
  v_exp_f32_e64 v220, v132 clamp
  v_max_f32_e64 v132, 0, v132
  v_exp_f32_e64 v221, v133 clamp
  v_max_f32_e64 v133, 0, v133
  buffer_load_dwordx4 v204, s[4:7], m0 offen offset:1024 sc1 lds
  v_exp_f32_e64 v222, v134 clamp
  v_max_f32_e64 v134, 0, v134
  v_exp_f32_e64 v223, v135 clamp
  v_max_f32_e64 v135, 0, v135
  v_exp_f32_e64 v224, v136 clamp
  v_max_f32_e64 v136, 0, v136
  v_exp_f32_e64 v225, v137 clamp
  v_max_f32_e64 v137, 0, v137
  v_exp_f32_e64 v226, v138 clamp
  v_max_f32_e64 v138, 0, v138
  s_add_u32 m0, s65, 147456
  s_nop 0
  buffer_load_dwordx4 v204, s[4:7], m0 offen offset:0 sc1 lds
  v_exp_f32_e64 v227, v139 clamp
  v_max_f32 v139, 0, v139
  v_exp_f32_e64 v228, v140 clamp
  v_max_f32_e64 v140, 0, v140
  v_exp_f32_e64 v229, v141 clamp
  v_max_f32_e64 v141, 0, v141
  v_exp_f32_e64 v230, v142 clamp
  v_max_f32_e64 v142, 0, v142
  v_exp_f32_e64 v231, v143 clamp
  v_max_f32_e64 v143, 0, v143
  buffer_load_dwordx4 v204, s[4:7], m0 offen offset:1024 sc1 lds
  v_pk_fma_f32 v[144:145], v[144:145], v[160:161], v[210:211]
  v_pk_fma_f32 v[216:217], v[128:129], s[60:61], v[216:217]
  v_pk_fma_f32 v[146:147], v[146:147], v[162:163], v[210:211]
  v_pk_fma_f32 v[218:219], v[130:131], s[60:61], v[218:219]
  v_pk_fma_f32 v[148:149], v[148:149], v[164:165], v[210:211]
  v_pk_fma_f32 v[220:221], v[132:133], s[60:61], v[220:221]
  v_pk_fma_f32 v[150:151], v[150:151], v[166:167], v[210:211]
  v_pk_fma_f32 v[222:223], v[134:135], s[60:61], v[222:223]
  v_pk_fma_f32 v[152:153], v[152:153], v[168:169], v[210:211]
  v_pk_fma_f32 v[224:225], v[136:137], s[60:61], v[224:225]
  v_pk_fma_f32 v[154:155], v[154:155], v[170:171], v[210:211]
  v_pk_fma_f32 v[226:227], v[138:139], s[60:61], v[226:227]
  v_pk_fma_f32 v[156:157], v[156:157], v[172:173], v[210:211]
  v_pk_fma_f32 v[228:229], v[140:141], s[60:61], v[228:229]
  v_pk_fma_f32 v[158:159], v[158:159], v[174:175], v[210:211]
  v_pk_fma_f32 v[230:231], v[142:143], s[60:61], v[230:231]
  s_add_u32 m0, s65, 155648
  s_nop 0
  buffer_load_dwordx4 v204, s[4:7], m0 offen offset:0 sc1 lds
  v_pk_add_f32 v[216:217], v[216:217], s[62:63]
  v_cvt_pk_bf16_f32 v144, v144, v145
  v_pk_add_f32 v[218:219], v[218:219], s[62:63]
  v_cvt_pk_bf16_f32 v145, v146, v147
  v_pk_add_f32 v[220:221], v[220:221], s[62:63]
  v_cvt_pk_bf16_f32 v146, v148, v149
  v_pk_add_f32 v[222:223], v[222:223], s[62:63]
  v_cvt_pk_bf16_f32 v147, v150, v151
  v_pk_add_f32 v[224:225], v[224:225], s[62:63]
  v_cvt_pk_bf16_f32 v148, v152, v153
  v_pk_add_f32 v[226:227], v[226:227], s[62:63]
  v_cvt_pk_bf16_f32 v149, v154, v155
  v_pk_add_f32 v[228:229], v[228:229], s[62:63]
  v_cvt_pk_bf16_f32 v150, v156, v157
  v_pk_add_f32 v[230:231], v[230:231], s[62:63]
  v_cvt_pk_bf16_f32 v151, v158, v159
  buffer_load_dwordx4 v204, s[4:7], m0 offen offset:1024 sc1 lds
  v_cvt_pk_bf16_f32 v128, v216, v217
  v_cvt_pk_bf16_f32 v129, v218, v219
  v_cvt_pk_bf16_f32 v130, v220, v221
  v_cvt_pk_bf16_f32 v131, v222, v223
  s_nop 1
  v_mfma_f32_32x32x16_bf16 v[232:247], v[128:131], v[144:147], 0
  v_cvt_pk_bf16_f32 v132, v224, v225
  v_cvt_pk_bf16_f32 v133, v226, v227
  v_cvt_pk_bf16_f32 v134, v228, v229
  v_cvt_pk_bf16_f32 v135, v230, v231
  s_add_u32 s86, s66, 90112
  v_add_u32_e64 v208, s86, v1
  v_mfma_f32_32x32x16_bf16 v[232:247], v[132:135], v[148:151], v[232:247]
  s_add_u32 s86, s64, 90112
  v_add_u32 v209, s86, v6
  s_waitcnt lgkmcnt(3)
  v_mfma_f32_32x32x16_bf16 v[160:175], v[176:179], v[16:19], 0
  ds_read_b128 v[192:195], v1 offset:14336
  s_nop 2
  ds_write_b128 v208, v[232:235] offset:0
  ds_write_b128 v208, v[236:239] offset:1024
  ds_write_b128 v208, v[240:243] offset:2048
  ds_write_b128 v208, v[244:247] offset:3072
  s_waitcnt lgkmcnt(7)
  v_mfma_f32_32x32x16_bf16 v[160:175], v[180:183], v[20:23], v[160:175]
  ds_read_b128 v[196:199], v1 offset:17408
  s_waitcnt lgkmcnt(1)
  s_barrier
  ds_read2st64_b32 v[216:217], v209 offset0:0 offset1:1
  ds_read2st64_b32 v[218:219], v209 offset0:2 offset1:3
  ds_read2st64_b32 v[220:221], v209 offset0:16 offset1:17
  ds_read2st64_b32 v[222:223], v209 offset0:18 offset1:19
  ds_read2st64_b32 v[224:225], v209 offset0:32 offset1:33
  ds_read2st64_b32 v[226:227], v209 offset0:34 offset1:35
  ds_read2st64_b32 v[228:229], v209 offset0:48 offset1:49
  ds_read2st64_b32 v[230:231], v209 offset0:50 offset1:51
  v_mfma_f32_32x32x16_bf16 v[160:175], v[184:187], v[24:27], v[160:175]
  ds_read_b128 v[176:179], v1 offset:20480
  s_waitcnt lgkmcnt(1)
  v_add_f32 v216, v216, v220
  v_add_f32 v224, v224, v228
  v_add_f32 v217, v217, v221
  v_add_f32 v225, v225, v229
  v_add_f32 v218, v218, v222
  v_add_f32 v226, v226, v230
  v_add_f32 v219, v219, v223
  v_add_f32 v227, v227, v231
  v_add_f32 v216, v216, v224
  v_add_f32 v217, v217, v225
  v_add_f32 v218, v218, v226
  v_add_f32_e64 v219, v219, v227
  buffer_atomic_add_f32 v216, v6, s[40:43], s87 offen offset:0
  buffer_atomic_add_f32 v217, v6, s[40:43], s87 offen offset:256
  buffer_atomic_add_f32 v218, v6, s[40:43], s87 offen offset:512
  buffer_atomic_add_f32 v219, v6, s[40:43], s87 offen offset:768
  v_mfma_f32_32x32x16_bf16 v[160:175], v[188:191], v[28:31], v[160:175]
  ds_read_b128 v[180:183], v1 offset:23552
  s_add_u32 s91, s69, 0
  buffer_load_dwordx4 v[16:19], v206, s[4:7], s91 offen offset:0 sc1
  s_lshl_b32 s73, s50, 8
  s_lshl_b32 s87, s71, 4
  s_add_u32 s73, s73, s87
  s_add_u32 s73, s73, 65536
  v_mfma_f32_32x32x16_bf16 v[160:175], v[192:195], v[32:35], v[160:175]
  ds_read_b128 v[184:187], v1 offset:26624
  s_cmp_lg_u32 s48, 3
  s_cselect_b32 s73, 0x40000000, s73
  s_lshl_b32 s86, s56, 15
  s_lshl_b32 s87, s50, 11
  s_add_u32 s86, s86, s87
  s_add_u32 s86, s86, 1048576
  s_lshl_b32 s94, s56, 9
  v_mfma_f32_32x32x16_bf16 v[160:175], v[196:199], v[36:39], v[160:175]
  ds_read_b128 v[188:191], v1 offset:29696
  buffer_load_dwordx4 v[20:23], v207, s[4:7], s91 offen offset:0 sc1
  s_lshl_b32 s87, s50, 5
  s_add_u32 s94, s94, s87
  s_add_u32 s94, s94, 98304
  v_lshlrev_b32_e64 v208, 12, v0
  v_mov_b32 v209, 1
  s_waitcnt lgkmcnt(3)
  v_mfma_f32_32x32x16_bf16 v[160:175], v[176:179], v[40:43], v[160:175]
  ds_read_b128 v[192:195], v1 offset:32768
  v_mov_b32_e64 v251, v249
  v_mov_b32 v135, 0
  s_waitcnt lgkmcnt(3)
  v_mfma_f32_32x32x16_bf16 v[160:175], v[180:183], v[44:47], v[160:175]
  ds_read_b128 v[196:199], v1 offset:35840
  buffer_load_dwordx4 v[24:27], v206, s[4:7], s91 offen offset:2048 sc1
  s_waitcnt lgkmcnt(3)
  v_mfma_f32_32x32x16_bf16 v[160:175], v[184:187], v[48:51], v[160:175]
  ds_read_b128 v[176:179], v1 offset:38912
  s_waitcnt lgkmcnt(3)
  v_mfma_f32_32x32x16_bf16 v[160:175], v[188:191], v[52:55], v[160:175]
  ds_read_b128 v[180:183], v1 offset:41984
  buffer_load_dwordx4 v[28:31], v207, s[4:7], s91 offen offset:2048 sc1
  s_waitcnt lgkmcnt(3)
  v_mfma_f32_32x32x16_bf16 v[160:175], v[192:195], v[56:59], v[160:175]
  ds_read_b128 v[184:187], v1 offset:45056
  s_waitcnt lgkmcnt(3)
  v_mfma_f32_32x32x16_bf16 v[160:175], v[196:199], v[60:63], v[160:175]
  ds_read_b128 v[188:191], v1 offset:48128
  s_add_u32 s91, s69, 4096
  buffer_load_dwordx4 v[32:35], v206, s[4:7], s91 offen offset:0 sc1
  s_waitcnt lgkmcnt(3)
  v_mfma_f32_32x32x16_bf16 v[160:175], v[176:179], v[64:67], v[160:175]
  ds_read_b128 v[192:195], v1 offset:51200
  s_waitcnt lgkmcnt(3)
  v_mfma_f32_32x32x16_bf16 v[160:175], v[180:183], v[68:71], v[160:175]
  ds_read_b128 v[196:199], v1 offset:54272
  buffer_load_dwordx4 v[36:39], v207, s[4:7], s91 offen offset:0 sc1
  s_waitcnt lgkmcnt(3)
  v_mfma_f32_32x32x16_bf16 v[160:175], v[184:187], v[72:75], v[160:175]
  ds_read_b128 v[176:179], v1 offset:57344
  s_waitcnt lgkmcnt(3)
  v_mfma_f32_32x32x16_bf16 v[160:175], v[188:191], v[76:79], v[160:175]
  ds_read_b128 v[180:183], v1 offset:60416
  buffer_load_dwordx4 v[40:43], v206, s[4:7], s91 offen offset:2048 sc1
  s_waitcnt lgkmcnt(3)
  v_mfma_f32_32x32x16_bf16 v[160:175], v[192:195], v[80:83], v[160:175]
  ds_read_b128 v[184:187], v1 offset:63488
  s_waitcnt lgkmcnt(3)
  v_mfma_f32_32x32x16_bf16 v[160:175], v[196:199], v[84:87], v[160:175]
  ds_read_b128 v[188:191], v2 offset:1024
  buffer_load_dwordx4 v[44:47], v207, s[4:7], s91 offen offset:2048 sc1
  s_waitcnt lgkmcnt(3)
  v_mfma_f32_32x32x16_bf16 v[160:175], v[176:179], v[88:91], v[160:175]
  ds_read_b128 v[192:195], v2 offset:4096
  s_waitcnt lgkmcnt(3)
  v_mfma_f32_32x32x16_bf16 v[160:175], v[180:183], v[92:95], v[160:175]
  ds_read_b128 v[196:199], v2 offset:7168
  s_add_u32 s91, s69, 8192
  buffer_load_dwordx4 v[48:51], v206, s[4:7], s91 offen offset:0 sc1
  s_waitcnt lgkmcnt(3)
  v_mfma_f32_32x32x16_bf16 v[160:175], v[184:187], v[96:99], v[160:175]
  ds_read_b128 v[176:179], v2 offset:10240
  s_waitcnt lgkmcnt(3)
  v_mfma_f32_32x32x16_bf16 v[160:175], v[188:191], v[100:103], v[160:175]
  ds_read_b128 v[180:183], v2 offset:13312
  buffer_load_dwordx4 v[52:55], v207, s[4:7], s91 offen offset:0 sc1
  s_waitcnt lgkmcnt(3)
  v_mfma_f32_32x32x16_bf16 v[160:175], v[192:195], v[104:107], v[160:175]
  ds_read_b128 v[184:187], v2 offset:16384
  s_waitcnt vmcnt(10)
  s_barrier
  s_mov_b64 exec, 15
  buffer_store_dword v209, v208, s[40:43], s73 offen sc1
  s_mov_b64 exec, -1
  s_waitcnt lgkmcnt(3)
  v_mfma_f32_32x32x16_bf16 v[160:175], v[196:199], v[108:111], v[160:175]
  ds_read_b128 v[188:191], v2 offset:19456
  buffer_load_dwordx4 v[56:59], v206, s[4:7], s91 offen offset:2048 sc1
  s_waitcnt lgkmcnt(3)
  v_mfma_f32_32x32x16_bf16 v[160:175], v[176:179], v[112:115], v[160:175]
  v_add_u32 v252, 0x15800, v5
  ds_read2_b32 v[192:193], v252 offset0:0 offset1:32
  ds_read2_b32 v[194:195], v252 offset0:64 offset1:96
  s_waitcnt lgkmcnt(4)
  v_mfma_f32_32x32x16_bf16 v[160:175], v[180:183], v[116:119], v[160:175]
  buffer_load_dwordx4 v[60:63], v207, s[4:7], s91 offen offset:2048 sc1
  s_waitcnt lgkmcnt(3)
  v_mfma_f32_32x32x16_bf16 v[160:175], v[184:187], v[120:123], v[160:175]
  s_waitcnt lgkmcnt(2)
  v_mfma_f32_32x32x16_bf16 v[160:175], v[188:191], v[124:127], v[160:175]
  s_add_u32 s91, s69, 12288
  buffer_load_dwordx4 v[64:67], v206, s[4:7], s91 offen offset:0 sc1
  s_waitcnt lgkmcnt(0)
  v_mfma_f32_32x32x16_bf16 v[160:175], v[192:195], v[200:203], v[160:175]
  s_nop 4
  s_nop 6
  v_pk_mul_f32 v[160:161], v[160:161], v[250:251] op_sel:[0,1] op_sel_hi:[1,1]
  v_pk_mul_f32 v[162:163], v[162:163], v[250:251] op_sel:[0,1] op_sel_hi:[1,1]
  v_pk_mul_f32 v[164:165], v[164:165], v[250:251] op_sel:[0,1] op_sel_hi:[1,1]
  v_pk_mul_f32 v[166:167], v[166:167], v[250:251] op_sel:[0,1] op_sel_hi:[1,1]
  v_pk_mul_f32 v[168:169], v[168:169], v[250:251] op_sel:[0,1] op_sel_hi:[1,1]
  v_pk_mul_f32 v[170:171], v[170:171], v[250:251] op_sel:[0,1] op_sel_hi:[1,1]
  v_pk_mul_f32 v[172:173], v[172:173], v[250:251] op_sel:[0,1] op_sel_hi:[1,1]
  v_exp_f32_e64 v216, v160 clamp
  v_max_f32 v160, 0, v160
  v_exp_f32_e64 v217, v161 clamp
  v_max_f32_e64 v161, 0, v161
  v_exp_f32_e64 v218, v162 clamp
  v_max_f32_e64 v162, 0, v162
  v_exp_f32_e64 v219, v163 clamp
  v_max_f32_e64 v163, 0, v163
  v_exp_f32_e64 v220, v164 clamp
  v_max_f32_e64 v164, 0, v164
  v_exp_f32_e64 v221, v165 clamp
  v_max_f32_e64 v165, 0, v165
  v_exp_f32_e64 v222, v166 clamp
  v_max_f32_e64 v166, 0, v166
  v_exp_f32_e64 v223, v167 clamp
  v_max_f32_e64 v167, 0, v167
  v_exp_f32_e64 v224, v168 clamp
  v_max_f32_e64 v168, 0, v168
  v_exp_f32_e64 v225, v169 clamp
  v_max_f32_e64 v169, 0, v169
  v_exp_f32_e64 v226, v170 clamp
  v_max_f32_e64 v170, 0, v170
  v_exp_f32_e64 v227, v171 clamp
  v_max_f32_e64 v171, 0, v171
  v_exp_f32_e64 v228, v172 clamp
  v_max_f32_e64 v172, 0, v172
  v_exp_f32_e64 v229, v173 clamp
  v_max_f32_e64 v173, 0, v173
  v_pk_fma_f32 v[216:217], v[160:161], s[60:61], v[216:217]
  v_pk_fma_f32 v[218:219], v[162:163], s[60:61], v[218:219]
  v_pk_fma_f32 v[220:221], v[164:165], s[60:61], v[220:221]
  v_pk_fma_f32 v[222:223], v[166:167], s[60:61], v[222:223]
  v_pk_fma_f32 v[224:225], v[168:169], s[60:61], v[224:225]
  v_pk_fma_f32 v[226:227], v[170:171], s[60:61], v[226:227]
  v_pk_fma_f32 v[228:229], v[172:173], s[60:61], v[228:229]
  v_pk_add_f32 v[216:217], v[216:217], s[62:63]
  v_pk_add_f32 v[218:219], v[218:219], s[62:63]
  v_pk_add_f32 v[220:221], v[220:221], s[62:63]
  v_pk_add_f32 v[222:223], v[222:223], s[62:63]
  v_pk_add_f32 v[224:225], v[224:225], s[62:63]
  v_pk_add_f32 v[226:227], v[226:227], s[62:63]
  v_pk_add_f32 v[228:229], v[228:229], s[62:63]
  v_cvt_pk_bf16_f32 v128, v216, v217
  v_cvt_pk_bf16_f32 v129, v218, v219
  v_cvt_pk_bf16_f32 v130, v220, v221
  v_cvt_pk_bf16_f32 v131, v222, v223
  v_cvt_pk_bf16_f32 v132, v224, v225
  v_cvt_pk_bf16_f32 v133, v226, v227
  v_cvt_pk_bf16_f32 v134, v228, v229
  buffer_store_dwordx4 v[128:131], v1, s[44:47], s86 offen
  buffer_store_dwordx4 v[132:135], v1, s[44:47], s86 offen offset:1024
  buffer_load_dwordx4 v[68:71], v207, s[4:7], s91 offen offset:0 sc1
  buffer_load_dwordx4 v[72:75], v206, s[4:7], s91 offen offset:2048 sc1
  buffer_load_dwordx4 v[76:79], v207, s[4:7], s91 offen offset:2048 sc1
  s_barrier
  s_waitcnt vmcnt(3)
  v_mov_b32 v254, 1
  s_mov_b64 exec, 1
  buffer_store_dword v254, off, s[40:43], s94 offset:0
  s_mov_b64 exec, -1
  s_add_u32 s86, s68, 0xe000
  v_add_u32 v4, s86, v1
  v_and_b32 v240, 3, v0
  v_lshlrev_b32 v240, 5, v240
  v_bfe_u32 v241, v0, 2, 1
  v_lshl_add_u32 v240, v241, 9, v240
  s_lshl_b32 s88, s57, 9
  s_lshl_b32 s86, s48, 7
  s_add_u32 s88, s88, s86
  s_add_u32 s88, s88, 98304
  s_lshl_b32 s90, s58, 15
  s_lshl_b32 s86, s48, 13
  s_add_u32 s90, s90, s86
  s_add_u32 s90, s90, 1048576
  s_xor_b32 s91, s90, 0x8000
  s_add_u32 s74, s72, s64
  s_add_u32 s74, s74, 65536
  s_lshl_b32 s89, s48, 14
  s_cmp_ge_u32 s49, 28
  s_cbranch_scc1 Lc_39
  v_lshlrev_b32_e64 v208, 16, v8
  v_and_b32 v209, 0xffff0000, v8
  v_lshlrev_b32_e64 v210, 16, v9
  v_and_b32 v211, 0xffff0000, v9
  v_lshlrev_b32_e64 v212, 16, v10
  v_and_b32 v213, 0xffff0000, v10
  v_lshlrev_b32_e64 v214, 16, v11
  v_and_b32 v215, 0xffff0000, v11
  v_lshlrev_b32_e64 v216, 16, v12
  v_and_b32 v217, 0xffff0000, v12
  v_lshlrev_b32_e64 v218, 16, v13
  v_and_b32 v219, 0xffff0000, v13
  v_lshlrev_b32_e64 v220, 16, v14
  v_and_b32 v221, 0xffff0000, v14
  v_lshlrev_b32_e64 v222, 16, v15
  v_and_b32 v223, 0xffff0000, v15
  s_xor_b32 s80, s48, 0
  s_mul_i32 s80, s80, 12288
  s_add_u32 s80, s80, 57344
  s_xor_b32 s81, s48, 1
  s_mul_i32 s81, s81, 12288
  s_add_u32 s81, s81, 57344
  s_xor_b32 s82, s48, 2
  s_mul_i32 s82, s82, 12288
  s_add_u32 s82, s82, 61440
  s_xor_b32 s83, s48, 3
  s_mul_i32 s83, s83, 12288
  s_add_u32 s83, s83, 65536
Lpoll_40:
  buffer_load_dword v254, v240, s[40:43], s88 offen offset:0 sc1
  s_sub_u32 s54, s54, 1
  s_max_i32 s54, s54, 0
  s_cselect_b64 s[92:93], exec, 0
  s_waitcnt vmcnt(0)
  v_cmp_ne_u32 vcc, 1, v254
  s_nop 0
  s_and_b64 exec, s[92:93], vcc
  s_cbranch_scc1 Lpoll_40
  s_mov_b64 exec, -1
  buffer_load_dwordx4 v[88:91], v1, s[44:47], s91 offen offset:0 sc1
  buffer_load_dwordx4 v[92:95], v1, s[44:47], s91 offen offset:1024 sc1
  buffer_load_dwordx4 v[104:107], v1, s[44:47], s91 offen offset:2048 sc1
  buffer_load_dwordx4 v[108:111], v1, s[44:47], s91 offen offset:3072 sc1
  s_add_u32 s91, s91, 4096
  buffer_load_dword v253, v1, s[40:43], s74 offen sc1
  buffer_load_dwordx4 v[120:123], v1, s[44:47], s91 offen offset:0 sc1
  buffer_load_dwordx4 v[124:127], v1, s[44:47], s91 offen offset:1024 sc1
  buffer_load_dwordx4 v[136:139], v1, s[44:47], s91 offen offset:2048 sc1
  buffer_load_dwordx4 v[140:143], v1, s[44:47], s91 offen offset:3072 sc1
  buffer_load_dwordx4 v[80:83], v1, s[44:47], s90 offen offset:0 sc1
  buffer_load_dwordx4 v[84:87], v1, s[44:47], s90 offen offset:1024 sc1
  buffer_load_dwordx4 v[96:99], v1, s[44:47], s90 offen offset:2048 sc1
  buffer_load_dwordx4 v[100:103], v1, s[44:47], s90 offen offset:3072 sc1
  s_add_u32 s90, s90, 4096
  s_waitcnt vmcnt(8)
  v_cmp_ne_u32 vcc, 1, v253
  s_nop 0
  s_cmp_eq_u64 vcc, 0
  s_cbranch_scc0 Lc_42
Lr_43:
  buffer_load_dwordx4 v[144:147], v1, s[40:43], s89 offen offset:0 sc1
  buffer_load_dwordx4 v[148:151], v1, s[40:43], s89 offen offset:1024 sc1
  buffer_load_dwordx4 v[152:155], v1, s[40:43], s89 offen offset:2048 sc1
  buffer_load_dwordx4 v[156:159], v1, s[40:43], s89 offen offset:3072 sc1
  s_add_u32 s89, s89, 4096
  buffer_load_dwordx4 v[160:163], v1, s[40:43], s89 offen offset:0 sc1
  buffer_load_dwordx4 v[164:167], v1, s[40:43], s89 offen offset:1024 sc1
  buffer_load_dwordx4 v[168:171], v1, s[40:43], s89 offen offset:2048 sc1
  buffer_load_dwordx4 v[172:175], v1, s[40:43], s89 offen offset:3072 sc1
  s_add_u32 s89, s89, 4096
  buffer_load_dwordx4 v[176:179], v1, s[40:43], s89 offen offset:0 sc1
  buffer_load_dwordx4 v[180:183], v1, s[40:43], s89 offen offset:1024 sc1
  buffer_load_dwordx4 v[184:187], v1, s[40:43], s89 offen offset:2048 sc1
  buffer_load_dwordx4 v[188:191], v1, s[40:43], s89 offen offset:3072 sc1
  s_add_u32 s89, s89, 4096
  buffer_load_dwordx4 v[192:195], v1, s[40:43], s89 offen offset:0 sc1
  buffer_load_dwordx4 v[196:199], v1, s[40:43], s89 offen offset:1024 sc1
  buffer_load_dwordx4 v[200:203], v1, s[40:43], s89 offen offset:2048 sc1
  buffer_load_dwordx4 v[204:207], v1, s[40:43], s89 offen offset:3072 sc1
  s_add_u32 s89, s89, 4096
  s_waitcnt vmcnt(12)
  v_cvt_pk_bf16_f32 v144, v144, v145
  v_cvt_pk_bf16_f32 v145, v146, v147
  v_cvt_pk_bf16_f32 v146, v148, v149
  v_cvt_pk_bf16_f32 v147, v150, v151
  v_cvt_pk_bf16_f32 v148, v152, v153
  v_cvt_pk_bf16_f32 v149, v154, v155
  v_cvt_pk_bf16_f32 v150, v156, v157
  v_cvt_pk_bf16_f32 v151, v158, v159
  v_mfma_f32_32x32x16_bf16 v[240:255], v[144:147], v[88:91], 0
  s_nop 0
  v_mfma_f32_32x32x16_bf16 v[240:255], v[148:151], v[92:95], v[240:255]
  s_waitcnt vmcnt(8)
  v_cvt_pk_bf16_f32 v152, v160, v161
  v_cvt_pk_bf16_f32 v153, v162, v163
  v_cvt_pk_bf16_f32 v154, v164, v165
  v_cvt_pk_bf16_f32 v155, v166, v167
  v_cvt_pk_bf16_f32 v156, v168, v169
  v_cvt_pk_bf16_f32 v157, v170, v171
  v_cvt_pk_bf16_f32 v158, v172, v173
  v_cvt_pk_bf16_f32 v159, v174, v175
  v_mfma_f32_32x32x16_bf16 v[160:175], v[152:155], v[104:107], 0
  s_nop 1
  v_add_f32 v254, s62, v254
  v_rcp_f32 v254, v254
  s_nop 0
  v_mul_f32 v240, v240, v254
  v_mul_f32_e64 v241, v241, v254
  v_cvt_pk_bf16_f32 v88, v240, v241
  v_mul_f32_e64 v242, v242, v254
  v_mfma_f32_32x32x16_bf16 v[160:175], v[156:159], v[108:111], v[160:175]
  v_mul_f32_e64 v243, v243, v254
  v_cvt_pk_bf16_f32 v89, v242, v243
  v_mul_f32 v244, v244, v254
  v_mul_f32 v245, v245, v254
  v_cvt_pk_bf16_f32 v90, v244, v245
  v_mul_f32 v246, v246, v254
  v_mul_f32 v247, v247, v254
  v_cvt_pk_bf16_f32 v91, v246, v247
  v_mul_f32 v248, v248, v254
  v_mul_f32 v249, v249, v254
  v_cvt_pk_bf16_f32 v92, v248, v249
  v_mul_f32 v250, v250, v254
  v_mul_f32 v251, v251, v254
  v_cvt_pk_bf16_f32 v93, v250, v251
  v_mul_f32 v252, v252, v254
  v_mul_f32 v253, v253, v254
  v_cvt_pk_bf16_f32 v94, v252, v253
  s_waitcnt vmcnt(4)
  v_mfma_f32_32x32x16_bf16 a[224:239], v[16:19], v[88:91], 0
  buffer_load_dwordx4 v[112:115], v1, s[44:47], s90 offen offset:0 sc1
  v_cvt_pk_bf16_f32 v176, v176, v177
  v_cvt_pk_bf16_f32 v177, v178, v179
  v_cvt_pk_bf16_f32 v178, v180, v181
  v_cvt_pk_bf16_f32 v179, v182, v183
  v_cvt_pk_bf16_f32 v180, v184, v185
  v_cvt_pk_bf16_f32 v181, v186, v187
  v_mfma_f32_32x32x16_bf16 a[224:239], v[24:27], v[92:95], a[224:239]
  v_cvt_pk_bf16_f32 v182, v188, v189
  v_cvt_pk_bf16_f32 v183, v190, v191
  v_add_f32 v174, s62, v174
  v_rcp_f32 v174, v174
  s_nop 0
  v_mul_f32 v160, v160, v174
  v_mul_f32 v161, v161, v174
  v_mfma_f32_32x32x16_bf16 v[240:255], v[176:179], v[120:123], 0
  buffer_load_dwordx4 v[116:119], v1, s[44:47], s90 offen offset:1024 sc1
  v_cvt_pk_bf16_f32 v104, v160, v161
  v_mul_f32 v162, v162, v174
  v_mul_f32 v163, v163, v174
  v_cvt_pk_bf16_f32 v105, v162, v163
  v_mul_f32 v164, v164, v174
  v_mul_f32 v165, v165, v174
  v_mfma_f32_32x32x16_bf16 v[240:255], v[180:183], v[124:127], v[240:255]
  v_cvt_pk_bf16_f32 v106, v164, v165
  v_mul_f32 v166, v166, v174
  v_mul_f32 v167, v167, v174
  v_cvt_pk_bf16_f32 v107, v166, v167
  v_mul_f32 v168, v168, v174
  v_mul_f32 v169, v169, v174
  v_cvt_pk_bf16_f32 v108, v168, v169
  v_mfma_f32_32x32x16_bf16 a[240:255], v[20:23], v[88:91], 0
  buffer_load_dwordx4 v[128:131], v1, s[44:47], s90 offen offset:2048 sc1
  v_mul_f32 v170, v170, v174
  v_mul_f32 v171, v171, v174
  v_cvt_pk_bf16_f32 v109, v170, v171
  v_mul_f32 v172, v172, v174
  v_mul_f32 v173, v173, v174
  v_cvt_pk_bf16_f32 v110, v172, v173
  v_mfma_f32_32x32x16_bf16 a[240:255], v[28:31], v[92:95], a[240:255]
  s_waitcnt vmcnt(3)
  v_mfma_f32_32x32x16_bf16 a[224:239], v[32:35], v[104:107], a[224:239]
  buffer_load_dwordx4 v[132:135], v1, s[44:47], s90 offen offset:3072 sc1
  v_cvt_pk_bf16_f32 v192, v192, v193
  v_cvt_pk_bf16_f32 v193, v194, v195
  v_cvt_pk_bf16_f32 v194, v196, v197
  v_cvt_pk_bf16_f32 v195, v198, v199
  v_cvt_pk_bf16_f32 v196, v200, v201
  v_cvt_pk_bf16_f32 v197, v202, v203
  v_mfma_f32_32x32x16_bf16 a[224:239], v[40:43], v[108:111], a[224:239]
  v_cvt_pk_bf16_f32 v198, v204, v205
  v_cvt_pk_bf16_f32 v199, v206, v207
  v_add_f32 v254, s62, v254
  v_rcp_f32 v254, v254
  s_nop 0
  v_mul_f32 v240, v240, v254
  v_mul_f32 v241, v241, v254
  v_mfma_f32_32x32x16_bf16 v[160:175], v[192:195], v[136:139], 0
  s_add_u32 m0, s65, 0
  s_nop 0
  buffer_load_dwordx4 v4, s[4:7], m0 offen offset:0 sc1 lds
  v_cvt_pk_bf16_f32 v120, v240, v241
  v_mul_f32 v242, v242, v254
  v_mul_f32 v243, v243, v254
  v_cvt_pk_bf16_f32 v121, v242, v243
  v_mfma_f32_32x32x16_bf16 v[160:175], v[196:199], v[140:143], v[160:175]
  v_mul_f32 v244, v244, v254
  v_mul_f32 v245, v245, v254
  v_cvt_pk_bf16_f32 v122, v244, v245
  v_mul_f32 v246, v246, v254
  v_mul_f32 v247, v247, v254
  v_cvt_pk_bf16_f32 v123, v246, v247
  v_mul_f32_e64 v248, v248, v254
  v_mfma_f32_32x32x16_bf16 a[240:255], v[36:39], v[104:107], a[240:255]
  buffer_load_dwordx4 v4, s[4:7], m0 offen offset:1024 sc1 lds
  v_mul_f32_e64 v249, v249, v254
  v_cvt_pk_bf16_f32 v124, v248, v249
  v_mul_f32 v250, v250, v254
  v_mul_f32 v251, v251, v254
  v_cvt_pk_bf16_f32 v125, v250, v251
  v_mul_f32_e64 v252, v252, v254
  v_mfma_f32_32x32x16_bf16 a[240:255], v[44:47], v[108:111], a[240:255]
  v_mul_f32_e64 v253, v253, v254
  v_cvt_pk_bf16_f32 v126, v252, v253
  v_mfma_f32_32x32x16_bf16 a[224:239], v[48:51], v[120:123], a[224:239]
  s_add_u32 m0, s65, 8192
  s_nop 0
  buffer_load_dwordx4 v4, s[4:7], m0 offen offset:0 sc1 lds
  v_add_f32 v174, s62, v174
  v_rcp_f32 v174, v174
  s_nop 0
  v_mul_f32_e64 v160, v160, v174
  v_mfma_f32_32x32x16_bf16 a[224:239], v[56:59], v[124:127], a[224:239]
  v_mul_f32_e64 v161, v161, v174
  v_cvt_pk_bf16_f32 v136, v160, v161
  v_mul_f32 v162, v162, v174
  v_mul_f32 v163, v163, v174
  v_cvt_pk_bf16_f32 v137, v162, v163
  v_mul_f32 v164, v164, v174
  v_mul_f32 v165, v165, v174
  v_mfma_f32_32x32x16_bf16 v[240:255], v[144:147], v[80:83], 0
  buffer_load_dwordx4 v4, s[4:7], m0 offen offset:1024 sc1 lds
  v_cvt_pk_bf16_f32 v138, v164, v165
  v_mul_f32 v166, v166, v174
  v_mul_f32 v167, v167, v174
  v_cvt_pk_bf16_f32 v139, v166, v167
  v_mul_f32 v168, v168, v174
  v_mul_f32 v169, v169, v174
  v_mfma_f32_32x32x16_bf16 v[240:255], v[148:151], v[84:87], v[240:255]
  v_cvt_pk_bf16_f32 v140, v168, v169
  v_mul_f32 v170, v170, v174
  v_mul_f32 v171, v171, v174
  v_cvt_pk_bf16_f32 v141, v170, v171
  v_mul_f32 v172, v172, v174
  v_mul_f32 v173, v173, v174
  v_cvt_pk_bf16_f32 v142, v172, v173
  v_mfma_f32_32x32x16_bf16 a[240:255], v[52:55], v[120:123], a[240:255]
  s_add_u32 m0, s65, 16384
  s_nop 0
  buffer_load_dwordx4 v4, s[4:7], m0 offen offset:0 sc1 lds
  v_add_u32 v184, s80, v1
  v_add_u32 v185, s81, v1
  v_add_u32 v186, s82, v1
  v_add_u32_e64 v187, s83, v1
  v_mfma_f32_32x32x16_bf16 a[240:255], v[60:63], v[124:127], a[240:255]
  v_mfma_f32_32x32x16_bf16 a[224:239], v[64:67], v[136:139], a[224:239]
  buffer_load_dwordx4 v4, s[4:7], m0 offen offset:1024 sc1 lds
  v_add_f32 v254, s62, v254
  v_rcp_f32 v254, v254
  s_nop 0
  v_mul_f32 v240, v240, v254
  v_mul_f32_e64 v241, v241, v254
  v_cvt_pk_bf16_f32 v80, v240, v241
  v_mfma_f32_32x32x16_bf16 a[224:239], v[72:75], v[140:143], a[224:239]
  v_mul_f32 v242, v242, v254
  v_mul_f32 v243, v243, v254
  v_cvt_pk_bf16_f32 v81, v242, v243
  v_mul_f32 v244, v244, v254
  v_mul_f32 v245, v245, v254
  v_cvt_pk_bf16_f32 v82, v244, v245
  v_mul_f32_e64 v246, v246, v254
  v_mfma_f32_32x32x16_bf16 v[160:175], v[152:155], v[96:99], 0
  s_add_u32 m0, s65, 24576
  s_nop 0
  buffer_load_dwordx4 v4, s[4:7], m0 offen offset:0 sc1 lds
  v_mul_f32 v247, v247, v254
  v_cvt_pk_bf16_f32 v83, v246, v247
  v_mul_f32 v248, v248, v254
  v_mul_f32 v249, v249, v254
  v_mfma_f32_32x32x16_bf16 v[160:175], v[156:159], v[100:103], v[160:175]
  v_cvt_pk_bf16_f32 v84, v248, v249
  v_mul_f32 v250, v250, v254
  v_mul_f32 v251, v251, v254
  v_cvt_pk_bf16_f32 v85, v250, v251
  v_mul_f32 v252, v252, v254
  v_mul_f32 v253, v253, v254
  v_cvt_pk_bf16_f32 v86, v252, v253
  v_mfma_f32_32x32x16_bf16 a[240:255], v[68:71], v[136:139], a[240:255]
  buffer_load_dwordx4 v4, s[4:7], m0 offen offset:1024 sc1 lds
  v_mfma_f32_32x32x16_bf16 a[240:255], v[76:79], v[140:143], a[240:255]
  v_mfma_f32_32x32x16_bf16 v[224:239], v[20:23], v[80:83], 0
  v_add_f32 v174, s62, v174
  v_rcp_f32 v174, v174
  s_nop 0
  v_mul_f32 v160, v160, v174
  v_mul_f32_e64 v161, v161, v174
  v_cvt_pk_bf16_f32 v96, v160, v161
  v_mul_f32_e64 v162, v162, v174
  v_mfma_f32_32x32x16_bf16 v[224:239], v[28:31], v[84:87], v[224:239]
  ds_write_b128 v186, a[224:227] offset:0
  v_mul_f32_e64 v163, v163, v174
  v_cvt_pk_bf16_f32 v97, v162, v163
  v_mul_f32 v164, v164, v174
  v_mul_f32 v165, v165, v174
  v_cvt_pk_bf16_f32 v98, v164, v165
  v_mul_f32 v166, v166, v174
  s_waitcnt vmcnt(10)
  v_mfma_f32_32x32x16_bf16 v[240:255], v[176:179], v[112:115], 0
  v_mul_f32_e64 v167, v167, v174
  v_cvt_pk_bf16_f32 v99, v166, v167
  v_mul_f32 v168, v168, v174
  v_mul_f32 v169, v169, v174
  v_cvt_pk_bf16_f32 v100, v168, v169
  v_mul_f32 v170, v170, v174
  v_mul_f32 v171, v171, v174
  v_mfma_f32_32x32x16_bf16 v[240:255], v[180:183], v[116:119], v[240:255]
  ds_write_b128 v186, a[228:231] offset:1024
  v_cvt_pk_bf16_f32 v101, v170, v171
  v_mul_f32 v172, v172, v174
  v_mul_f32 v173, v173, v174
  v_cvt_pk_bf16_f32 v102, v172, v173
  v_mfma_f32_32x32x16_bf16 v[224:239], v[36:39], v[96:99], v[224:239]
  s_nop 3
  v_add_f32 v254, s62, v254
  v_rcp_f32 v254, v254
  s_nop 0
  v_mul_f32 v240, v240, v254
  v_mul_f32 v241, v241, v254
  v_cvt_pk_bf16_f32 v112, v240, v241
  v_mul_f32_e64 v242, v242, v254
  v_mfma_f32_32x32x16_bf16 v[224:239], v[44:47], v[100:103], v[224:239]
  ds_write_b128 v186, a[232:235] offset:2048
  v_mul_f32_e64 v243, v243, v254
  v_cvt_pk_bf16_f32 v113, v242, v243
  v_mul_f32 v244, v244, v254
  v_mul_f32 v245, v245, v254
  v_cvt_pk_bf16_f32 v114, v244, v245
  v_mul_f32 v246, v246, v254
  s_waitcnt vmcnt(8)
  v_mfma_f32_32x32x16_bf16 v[160:175], v[192:195], v[128:131], 0
  v_mul_f32_e64 v247, v247, v254
  v_cvt_pk_bf16_f32 v115, v246, v247
  v_mul_f32 v248, v248, v254
  v_mul_f32 v249, v249, v254
  v_cvt_pk_bf16_f32 v116, v248, v249
  v_mul_f32 v250, v250, v254
  v_mul_f32 v251, v251, v254
  v_mfma_f32_32x32x16_bf16 v[160:175], v[196:199], v[132:135], v[160:175]
  ds_write_b128 v186, a[236:239] offset:3072
  v_cvt_pk_bf16_f32 v117, v250, v251
  v_mul_f32 v252, v252, v254
  v_mul_f32 v253, v253, v254
  v_cvt_pk_bf16_f32 v118, v252, v253
  v_mfma_f32_32x32x16_bf16 v[224:239], v[52:55], v[112:115], v[224:239]
  s_nop 3
  v_add_f32 v174, s62, v174
  v_rcp_f32 v174, v174
  s_nop 0
  v_mul_f32 v160, v160, v174
  v_mul_f32 v161, v161, v174
  v_cvt_pk_bf16_f32 v128, v160, v161
  v_mul_f32_e64 v162, v162, v174
  v_mfma_f32_32x32x16_bf16 v[224:239], v[60:63], v[116:119], v[224:239]
  ds_write_b128 v187, a[240:243] offset:0
  v_mul_f32_e64 v163, v163, v174
  v_cvt_pk_bf16_f32 v129, v162, v163
  v_mul_f32 v164, v164, v174
  v_mul_f32 v165, v165, v174
  v_cvt_pk_bf16_f32 v130, v164, v165
  v_mul_f32_e64 v166, v166, v174
  v_mfma_f32_32x32x16_bf16 v[208:223], v[16:19], v[80:83], v[208:223]
  v_mul_f32_e64 v167, v167, v174
  v_cvt_pk_bf16_f32 v131, v166, v167
  v_mul_f32 v168, v168, v174
  v_mul_f32 v169, v169, v174
  v_cvt_pk_bf16_f32 v132, v168, v169
  v_mul_f32 v170, v170, v174
  v_mul_f32 v171, v171, v174
  v_mfma_f32_32x32x16_bf16 v[208:223], v[24:27], v[84:87], v[208:223]
  ds_write_b128 v187, a[244:247] offset:1024
  v_cvt_pk_bf16_f32 v133, v170, v171
  v_mul_f32 v172, v172, v174
  v_mul_f32 v173, v173, v174
  v_cvt_pk_bf16_f32 v134, v172, v173
  v_mfma_f32_32x32x16_bf16 v[224:239], v[68:71], v[128:131], v[224:239]
  s_nop 0
  v_mfma_f32_32x32x16_bf16 v[224:239], v[76:79], v[132:135], v[224:239]
  ds_write_b128 v187, a[248:251] offset:2048
  v_mfma_f32_32x32x16_bf16 v[208:223], v[32:35], v[96:99], v[208:223]
  v_mfma_f32_32x32x16_bf16 v[208:223], v[40:43], v[100:103], v[208:223]
  ds_write_b128 v187, a[252:255] offset:3072
  v_mfma_f32_32x32x16_bf16 v[208:223], v[48:51], v[112:115], v[208:223]
  v_mfma_f32_32x32x16_bf16 v[208:223], v[56:59], v[116:119], v[208:223]
  ds_write_b128 v185, v[224:227] offset:0
  v_mfma_f32_32x32x16_bf16 v[208:223], v[64:67], v[128:131], v[208:223]
  ds_write_b128 v185, v[228:231] offset:1024
  v_mfma_f32_32x32x16_bf16 v[208:223], v[72:75], v[132:135], v[208:223]
  ds_write_b128 v185, v[232:235] offset:2048
  ds_write_b128 v185, v[236:239] offset:3072
  s_add_u32 m0, s65, 32768
  s_nop 0
  buffer_load_dwordx4 v4, s[4:7], m0 offen offset:0 sc1 lds
  buffer_load_dwordx4 v4, s[4:7], m0 offen offset:1024 sc1 lds
  s_add_u32 m0, s65, 40960
  s_nop 0
  buffer_load_dwordx4 v4, s[4:7], m0 offen offset:0 sc1 lds
  buffer_load_dwordx4 v4, s[4:7], m0 offen offset:1024 sc1 lds
  s_add_u32 m0, s65, 49152
  s_nop 0
  buffer_load_dwordx4 v4, s[4:7], m0 offen offset:0 sc1 lds
  buffer_load_dwordx4 v4, s[4:7], m0 offen offset:1024 sc1 lds
  s_waitcnt lgkmcnt(0)
  s_barrier
  ds_read_b128 v[80:83], v184 offset:0
  ds_read_b128 v[84:87], v184 offset:1024
  ds_read_b128 v[88:91], v184 offset:2048
  ds_read_b128 v[92:95], v184 offset:3072
  ds_read_b128 v[96:99], v184 offset:4096
  ds_read_b128 v[100:103], v184 offset:5120
  ds_read_b128 v[104:107], v184 offset:6144
  ds_read_b128 v[108:111], v184 offset:7168
  ds_read_b128 v[112:115], v184 offset:8192
  ds_read_b128 v[116:119], v184 offset:9216
  ds_read_b128 v[120:123], v184 offset:10240
  ds_read_b128 v[124:127], v184 offset:11264
  s_add_u32 s86, s97, 3145728
  s_add_u32 s87, s98, 262144
  s_add_u32 s96, s99, 131072
  v_mov_b32_e64 v160, 0
  v_mov_b32 v161, 0
  s_waitcnt lgkmcnt(8)
  v_pk_add_f32 v[208:209], v[208:209], v[80:81]
  v_pk_add_f32 v[210:211], v[210:211], v[82:83]
  v_pk_add_f32 v[212:213], v[212:213], v[84:85]
  v_pk_add_f32 v[214:215], v[214:215], v[86:87]
  v_pk_add_f32 v[216:217], v[216:217], v[88:89]
  v_pk_add_f32 v[218:219], v[218:219], v[90:91]
  v_pk_add_f32 v[220:221], v[220:221], v[92:93]
  v_pk_add_f32 v[222:223], v[222:223], v[94:95]
  s_waitcnt lgkmcnt(4)
  v_pk_add_f32 v[208:209], v[208:209], v[96:97]
  v_pk_add_f32 v[210:211], v[210:211], v[98:99]
  v_pk_add_f32 v[212:213], v[212:213], v[100:101]
  v_pk_add_f32 v[214:215], v[214:215], v[102:103]
  v_pk_add_f32 v[216:217], v[216:217], v[104:105]
  v_pk_add_f32 v[218:219], v[218:219], v[106:107]
  v_pk_add_f32 v[220:221], v[220:221], v[108:109]
  v_pk_add_f32 v[222:223], v[222:223], v[110:111]
  s_waitcnt lgkmcnt(0)
  v_pk_add_f32 v[208:209], v[208:209], v[112:113]
  v_pk_add_f32 v[210:211], v[210:211], v[114:115]
  v_pk_add_f32 v[212:213], v[212:213], v[116:117]
  v_pk_add_f32 v[214:215], v[214:215], v[118:119]
  v_pk_add_f32 v[216:217], v[216:217], v[120:121]
  v_pk_add_f32 v[218:219], v[218:219], v[122:123]
  v_pk_add_f32 v[220:221], v[220:221], v[124:125]
  v_pk_add_f32 v[222:223], v[222:223], v[126:127]
  v_cvt_pk_bf16_f32 v8, v208, v209
  v_cvt_pk_bf16_f32 v9, v210, v211
  v_cvt_pk_bf16_f32 v10, v212, v213
  v_cvt_pk_bf16_f32 v11, v214, v215
  v_cvt_pk_bf16_f32 v12, v216, v217
  v_cvt_pk_bf16_f32 v13, v218, v219
  v_cvt_pk_bf16_f32 v14, v220, v221
  v_cvt_pk_bf16_f32 v15, v222, v223
  buffer_store_dwordx4 v[8:11], v1, s[44:47], s86 offen
  buffer_store_dwordx4 v[12:15], v1, s[44:47], s86 offen offset:1024
  v_dot2c_f32_bf16 v160, s84, v8
  v_dot2c_f32_bf16 v161, v8, v8
  v_dot2c_f32_bf16 v160, s84, v9
  v_dot2c_f32_bf16 v161, v9, v9
  v_dot2c_f32_bf16 v160, s84, v10
  v_dot2c_f32_bf16 v161, v10, v10
  v_dot2c_f32_bf16 v160, s84, v11
  v_dot2c_f32_bf16 v161, v11, v11
  v_dot2c_f32_bf16 v160, s84, v12
  v_dot2c_f32_bf16 v161, v12, v12
  v_dot2c_f32_bf16 v160, s84, v13
  v_dot2c_f32_bf16 v161, v13, v13
  v_dot2c_f32_bf16 v160, s84, v14
  v_dot2c_f32_bf16 v161, v14, v14
  v_dot2c_f32_bf16 v160, s84, v15
  v_dot2c_f32_bf16 v161, v15, v15
  s_nop 1
  v_mov_b32 v162, v160
  v_mov_b32 v163, v161
  s_nop 0
  v_permlane32_swap_b32 v160, v162
  v_permlane32_swap_b32 v161, v163
  v_pk_add_f32 v[160:161], v[160:161], v[162:163]
  s_mov_b32 exec_hi, 0
  buffer_store_dwordx2 v[160:161], v1, s[44:47], s87 offen
  s_mov_b64 exec, -1
  v_and_b32 v240, 15, v0
  v_min_u32 v240, 13, v240
  v_lshlrev_b32 v240, 5, v240
  s_lshl_b32 s88, s56, 9
  s_add_u32 s88, s88, 131072
  s_lshl_b32 s89, s56, 12
  s_add_u32 s89, s89, 262144
  s_mul_i32 s90, s56, 28672
  s_add_u32 s90, s90, 3145728
  s_add_u32 s86, s68, 0xe000
  v_add_u32 v229, s86, v1
  s_add_u32 s86, s68, 0xac00
  v_add_u32_e64 v228, s86, v1
  s_mul_i32 s73, s56, 114688
  s_mul_i32 s86, s50, 7168
  s_add_u32 s73, s73, s86
  s_add_u32 s73, s73, 7340032
  s_add_u32 s74, s73, 4096
  s_lshl_b32 s94, s56, 9
  s_lshl_b32 s86, s50, 2
  s_add_u32 s94, s94, s86
  s_add_u32 s94, s94, 196608
  s_waitcnt vmcnt(0)
  v_mov_b32_e64 v254, 1
  s_mov_b64 exec, 1
  buffer_store_dword v254, off, s[40:43], s96 offset:0
  s_mov_b64 exec, -1
L_p2skip1:
  s_waitcnt lgkmcnt(0)
  s_barrier
  ds_read_b128 v[192:195], v2 offset:40960
  ds_read_b128 v[196:199], v2 offset:41984
  ds_read_b128 v[200:203], v2 offset:43008
  ds_read_b128 v[204:207], v2 offset:44032
  ds_read_b128 v[208:211], v2 offset:45056
  ds_read_b128 v[212:215], v2 offset:46080
Lpoll_46:
  buffer_load_dword v254, v240, s[40:43], s88 offen offset:0 sc1
  s_sub_u32 s54, s54, 1
  s_max_i32 s54, s54, 0
  s_cselect_b64 s[92:93], exec, 0
  s_waitcnt vmcnt(0)
  v_cmp_ne_u32 vcc, 1, v254
  s_nop 0
  s_and_b64 exec, s[92:93], vcc
  s_cbranch_scc1 Lpoll_46
  s_mov_b64 exec, -1
  buffer_load_dwordx4 v[16:19], v1, s[44:47], s90 offen offset:0 sc1
  buffer_load_dwordx4 v[20:23], v1, s[44:47], s90 offen offset:1024 sc1
  buffer_load_dwordx4 v[24:27], v1, s[44:47], s90 offen offset:2048 sc1
  buffer_load_dwordx4 v[28:31], v1, s[44:47], s90 offen offset:3072 sc1
  s_add_u32 s90, s90, 4096
  buffer_load_dwordx4 v[32:35], v1, s[44:47], s90 offen offset:0 sc1
  buffer_load_dwordx4 v[36:39], v1, s[44:47], s90 offen offset:1024 sc1
  buffer_load_dwordx4 v[40:43], v1, s[44:47], s90 offen offset:2048 sc1
  buffer_load_dwordx4 v[44:47], v1, s[44:47], s90 offen offset:3072 sc1
  s_waitcnt vmcnt(7) lgkmcnt(4)
  v_mfma_f32_32x32x16_bf16 v[128:143], v[192:195], v[16:19], 0
  ds_read_b128 v[216:219], v2 offset:47104
  s_add_u32 s90, s90, 4096
  buffer_load_dwordx4 v[48:51], v1, s[44:47], s90 offen offset:0 sc1
  v_mfma_f32_32x32x16_bf16 v[144:159], v[196:199], v[16:19], 0
  ds_read_b128 v[220:223], v2 offset:48128
  s_waitcnt vmcnt(7) lgkmcnt(4)
  v_mfma_f32_32x32x16_bf16 v[160:175], v[200:203], v[16:19], 0
  ds_read_b128 v[192:195], v2 offset:49152
  buffer_load_dwordx4 v[176:179], v1, s[44:47], s89 offen offset:0 sc1
  v_mfma_f32_32x32x16_bf16 v[128:143], v[204:207], v[20:23], v[128:143]
  ds_read_b128 v[196:199], v2 offset:50176
  buffer_load_dwordx4 v[52:55], v1, s[44:47], s90 offen offset:1024 sc1
  s_waitcnt lgkmcnt(4)
  v_mfma_f32_32x32x16_bf16 v[144:159], v[208:211], v[20:23], v[144:159]
  ds_read_b128 v[200:203], v2 offset:51200
  v_mfma_f32_32x32x16_bf16 v[160:175], v[212:215], v[20:23], v[160:175]
  ds_read_b128 v[204:207], v2 offset:52224
  s_waitcnt vmcnt(8) lgkmcnt(4)
  v_mfma_f32_32x32x16_bf16 v[128:143], v[216:219], v[24:27], v[128:143]
  ds_read_b128 v[208:211], v2 offset:53248
  buffer_load_dwordx4 v[56:59], v1, s[44:47], s90 offen offset:2048 sc1
  v_mfma_f32_32x32x16_bf16 v[144:159], v[220:223], v[24:27], v[144:159]
  ds_read_b128 v[212:215], v2 offset:54272
  s_waitcnt vmcnt(8) lgkmcnt(4)
  v_mfma_f32_32x32x16_bf16 v[160:175], v[192:195], v[24:27], v[160:175]
  ds_read_b128 v[216:219], v2 offset:55296
  buffer_load_dwordx4 v[180:183], v1, s[44:47], s89 offen offset:1024 sc1
  v_mfma_f32_32x32x16_bf16 v[128:143], v[196:199], v[28:31], v[128:143]
  ds_read_b128 v[220:223], v2 offset:56320
  buffer_load_dwordx4 v[60:63], v1, s[44:47], s90 offen offset:3072 sc1
  s_waitcnt lgkmcnt(4)
  v_mfma_f32_32x32x16_bf16 v[144:159], v[200:203], v[28:31], v[144:159]
  ds_read_b128 v[192:195], v2 offset:57344
  v_mfma_f32_32x32x16_bf16 v[160:175], v[204:207], v[28:31], v[160:175]
  ds_read_b128 v[196:199], v2 offset:58368
  s_waitcnt vmcnt(9) lgkmcnt(4)
  v_mfma_f32_32x32x16_bf16 v[128:143], v[208:211], v[32:35], v[128:143]
  ds_read_b128 v[200:203], v2 offset:59392
  s_add_u32 s90, s90, 4096
  buffer_load_dwordx4 v[64:67], v1, s[44:47], s90 offen offset:0 sc1
  v_mfma_f32_32x32x16_bf16 v[144:159], v[212:215], v[32:35], v[144:159]
  ds_read_b128 v[204:207], v2 offset:60416
  s_waitcnt vmcnt(9) lgkmcnt(4)
  v_mfma_f32_32x32x16_bf16 v[160:175], v[216:219], v[32:35], v[160:175]
  ds_read_b128 v[208:211], v2 offset:61440
  buffer_load_dwordx4 v[184:187], v1, s[44:47], s89 offen offset:2048 sc1
  v_mfma_f32_32x32x16_bf16 v[128:143], v[220:223], v[36:39], v[128:143]
  ds_read_b128 v[212:215], v2 offset:62464
  buffer_load_dwordx4 v[68:71], v1, s[44:47], s90 offen offset:1024 sc1
  s_waitcnt lgkmcnt(4)
  v_mfma_f32_32x32x16_bf16 v[144:159], v[192:195], v[36:39], v[144:159]
  ds_read_b128 v[216:219], v2 offset:63488
  v_mfma_f32_32x32x16_bf16 v[160:175], v[196:199], v[36:39], v[160:175]
  ds_read_b128 v[220:223], v2 offset:64512
  s_waitcnt vmcnt(10) lgkmcnt(4)
  v_mfma_f32_32x32x16_bf16 v[128:143], v[200:203], v[40:43], v[128:143]
  ds_read_b128 v[192:195], v3 offset:0
  buffer_load_dwordx4 v[72:75], v1, s[44:47], s90 offen offset:2048 sc1
  v_mfma_f32_32x32x16_bf16 v[144:159], v[204:207], v[40:43], v[144:159]
  ds_read_b128 v[196:199], v3 offset:1024
  s_waitcnt vmcnt(10) lgkmcnt(4)
  v_mfma_f32_32x32x16_bf16 v[160:175], v[208:211], v[40:43], v[160:175]
  ds_read_b128 v[200:203], v3 offset:2048
  buffer_load_dwordx4 v[188:191], v1, s[44:47], s89 offen offset:3072 sc1
  v_mfma_f32_32x32x16_bf16 v[128:143], v[212:215], v[44:47], v[128:143]
  ds_read_b128 v[204:207], v3 offset:3072
  buffer_load_dwordx4 v[76:79], v1, s[44:47], s90 offen offset:3072 sc1
  s_waitcnt lgkmcnt(4)
  v_mfma_f32_32x32x16_bf16 v[144:159], v[216:219], v[44:47], v[144:159]
  ds_read_b128 v[208:211], v3 offset:4096
  v_mfma_f32_32x32x16_bf16 v[160:175], v[220:223], v[44:47], v[160:175]
  ds_read_b128 v[212:215], v3 offset:5120
  s_waitcnt vmcnt(11) lgkmcnt(4)
  v_mfma_f32_32x32x16_bf16 v[128:143], v[192:195], v[48:51], v[128:143]
  ds_read_b128 v[216:219], v3 offset:6144
  s_add_u32 s90, s90, 4096
  buffer_load_dwordx4 v[80:83], v1, s[44:47], s90 offen offset:0 sc1
  v_mfma_f32_32x32x16_bf16 v[144:159], v[196:199], v[48:51], v[144:159]
  ds_read_b128 v[220:223], v3 offset:7168
  s_waitcnt vmcnt(10) lgkmcnt(4)
  v_mfma_f32_32x32x16_bf16 v[160:175], v[200:203], v[48:51], v[160:175]
  s_add_u32 m0, s64, 57344
  ds_read_b128 v[192:195], v3 offset:8192
  buffer_load_dwordx4 v229, s[4:7], m0 offen offset:0 sc1 lds
  v_mfma_f32_32x32x16_bf16 v[128:143], v[204:207], v[52:55], v[128:143]
  ds_read_b128 v[196:199], v3 offset:9216
  buffer_load_dwordx4 v[84:87], v1, s[44:47], s90 offen offset:1024 sc1
  s_waitcnt lgkmcnt(4)
  v_mfma_f32_32x32x16_bf16 v[144:159], v[208:211], v[52:55], v[144:159]
  ds_read_b128 v[200:203], v3 offset:10240
  v_mfma_f32_32x32x16_bf16 v[160:175], v[212:215], v[52:55], v[160:175]
  ds_read_b128 v[204:207], v3 offset:11264
  s_waitcnt vmcnt(11) lgkmcnt(4)
  v_mfma_f32_32x32x16_bf16 v[128:143], v[216:219], v[56:59], v[128:143]
  ds_read_b128 v[208:211], v3 offset:12288
  buffer_load_dwordx4 v[88:91], v1, s[44:47], s90 offen offset:2048 sc1
  v_mfma_f32_32x32x16_bf16 v[144:159], v[220:223], v[56:59], v[144:159]
  ds_read_b128 v[212:215], v3 offset:13312
  s_waitcnt vmcnt(10) lgkmcnt(4)
  v_mfma_f32_32x32x16_bf16 v[160:175], v[192:195], v[56:59], v[160:175]
  s_add_u32 m0, s64, 61440
  ds_read_b128 v[216:219], v3 offset:14336
  buffer_load_dwordx4 v229, s[4:7], m0 offen offset:0 sc1 lds
  v_mfma_f32_32x32x16_bf16 v[128:143], v[196:199], v[60:63], v[128:143]
  ds_read_b128 v[220:223], v3 offset:15360
  buffer_load_dwordx4 v[92:95], v1, s[44:47], s90 offen offset:3072 sc1
  s_waitcnt lgkmcnt(4)
  v_mfma_f32_32x32x16_bf16 v[144:159], v[200:203], v[60:63], v[144:159]
  ds_read_b128 v[192:195], v3 offset:16384
  v_mfma_f32_32x32x16_bf16 v[160:175], v[204:207], v[60:63], v[160:175]
  ds_read_b128 v[196:199], v3 offset:17408
  s_waitcnt vmcnt(11) lgkmcnt(4)
  v_mfma_f32_32x32x16_bf16 v[128:143], v[208:211], v[64:67], v[128:143]
  ds_read_b128 v[200:203], v3 offset:18432
  s_add_u32 s90, s90, 4096
  buffer_load_dwordx4 v[96:99], v1, s[44:47], s90 offen offset:0 sc1
  v_mfma_f32_32x32x16_bf16 v[144:159], v[212:215], v[64:67], v[144:159]
  ds_read_b128 v[204:207], v3 offset:19456
  s_waitcnt vmcnt(10) lgkmcnt(4)
  v_mfma_f32_32x32x16_bf16 v[160:175], v[216:219], v[64:67], v[160:175]
  s_add_u32 m0, s64, 65536
  ds_read_b128 v[208:211], v3 offset:20480
  buffer_load_dwordx4 v229, s[4:7], m0 offen offset:0 sc1 lds
  v_mfma_f32_32x32x16_bf16 v[128:143], v[220:223], v[68:71], v[128:143]
  ds_read_b128 v[212:215], v3 offset:21504
  buffer_load_dwordx4 v[100:103], v1, s[44:47], s90 offen offset:1024 sc1
  s_waitcnt lgkmcnt(4)
  v_mfma_f32_32x32x16_bf16 v[144:159], v[192:195], v[68:71], v[144:159]
  ds_read_b128 v[216:219], v3 offset:22528
  v_mfma_f32_32x32x16_bf16 v[160:175], v[196:199], v[68:71], v[160:175]
  ds_read_b128 v[220:223], v3 offset:23552
  s_waitcnt vmcnt(11) lgkmcnt(4)
  v_mfma_f32_32x32x16_bf16 v[128:143], v[200:203], v[72:75], v[128:143]
  ds_read_b128 v[192:195], v3 offset:24576
  buffer_load_dwordx4 v[104:107], v1, s[44:47], s90 offen offset:2048 sc1
  v_mfma_f32_32x32x16_bf16 v[144:159], v[204:207], v[72:75], v[144:159]
  ds_read_b128 v[196:199], v3 offset:25600
  s_waitcnt vmcnt(10) lgkmcnt(4)
  v_mfma_f32_32x32x16_bf16 v[160:175], v[208:211], v[72:75], v[160:175]
  s_add_u32 m0, s64, 69632
  ds_read_b128 v[200:203], v3 offset:26624
  buffer_load_dwordx4 v229, s[4:7], m0 offen offset:0 sc1 lds
  v_mfma_f32_32x32x16_bf16 v[128:143], v[212:215], v[76:79], v[128:143]
  ds_read_b128 v[204:207], v3 offset:27648
  buffer_load_dwordx4 v[108:111], v1, s[44:47], s90 offen offset:3072 sc1
  s_and_b32 s86, s64, 0x400
  v_add_u32 v240, s86, v1
  v_xor_b32 v241, 0x400, v240
  v_add_f32 v176, v176, v178
  s_waitcnt lgkmcnt(4)
  v_mfma_f32_32x32x16_bf16 v[144:159], v[216:219], v[76:79], v[144:159]
  ds_read_b128 v[208:211], v3 offset:28672
  v_add_f32 v177, v177, v179
  v_add_f32 v176, v176, v180
  v_add_f32 v177, v177, v181
  v_add_f32 v176, v176, v182
  v_add_f32 v177, v177, v183
  v_add_f32 v176, v176, v184
  v_mfma_f32_32x32x16_bf16 v[160:175], v[220:223], v[76:79], v[160:175]
  ds_read_b128 v[212:215], v3 offset:29696
  v_add_f32 v177, v177, v185
  v_add_f32 v176, v176, v186
  v_add_f32 v177, v177, v187
  v_add_f32 v176, v176, v188
  v_add_f32 v177, v177, v189
  s_waitcnt vmcnt(11) lgkmcnt(4)
  v_mfma_f32_32x32x16_bf16 v[128:143], v[192:195], v[80:83], v[128:143]
  ds_read_b128 v[216:219], v3 offset:30720
  s_add_u32 s90, s90, 4096
  buffer_load_dwordx4 v[112:115], v1, s[44:47], s90 offen offset:0 sc1
  v_mov_b32_e64 v178, v176
  v_mov_b32 v179, v177
  s_nop 0
  v_permlane32_swap_b32 v176, v178
  v_permlane32_swap_b32 v177, v179
  v_mfma_f32_32x32x16_bf16 v[144:159], v[196:199], v[80:83], v[144:159]
  ds_read_b128 v[220:223], v3 offset:31744
  v_add_f32 v176, v176, v178
  v_add_f32 v177, v177, v179
  v_mul_f32 v176, 0x3b124925, v176
  v_mul_f32 v177, 0x3b124925, v177
  v_fma_f32 v177, -v176, v176, v177
  s_waitcnt vmcnt(10) lgkmcnt(4)
  v_mfma_f32_32x32x16_bf16 v[160:175], v[200:203], v[80:83], v[160:175]
  s_add_u32 m0, s64, 73728
  ds_read_b128 v[192:195], v1 offset:0
  buffer_load_dwordx4 v229, s[4:7], m0 offen offset:0 sc1 lds
  v_max_f32 v177, 0, v177
  v_add_f32 v177, 0x3727c5ac, v177
  v_rsq_f32_e64 v248, v177
  v_mfma_f32_32x32x16_bf16 v[128:143], v[204:207], v[84:87], v[128:143]
  ds_read_b128 v[196:199], v1 offset:1024
  buffer_load_dwordx4 v[116:119], v1, s[44:47], s90 offen offset:1024 sc1
  v_cvt_pk_bf16_f32 v224, -v176, -v176
  v_mul_f32_e64 v250, v177, v248
  v_mul_f32 v249, 0x3fb8aa3b, v248
  v_mov_b32 v225, v224
  s_waitcnt lgkmcnt(4)
  v_mfma_f32_32x32x16_bf16 v[144:159], v[208:211], v[84:87], v[144:159]
  ds_read_b128 v[200:203], v1 offset:2048
  v_mov_b32 v226, v224
  v_mov_b32 v227, v224
  v_and_b32 v244, 3, v0
  v_lshlrev_b32 v244, 2, v244
  v_bfe_u32 v245, v0, 2, 1
  v_lshl_add_u32 v244, v245, 9, v244
  v_mfma_f32_32x32x16_bf16 v[160:175], v[212:215], v[84:87], v[160:175]
  ds_read_b128 v[204:207], v1 offset:3072
  s_lshl_b32 s86, s57, 9
  s_lshl_b32 s87, s48, 4
  s_add_u32 s86, s86, s87
  s_add_u32 s85, s86, 196608
  v_add_u32_e64 v244, s85, v244
  s_waitcnt vmcnt(11) lgkmcnt(4)
  v_mfma_f32_32x32x16_bf16 v[128:143], v[216:219], v[88:91], v[128:143]
  ds_read_b128 v[208:211], v1 offset:4096
  buffer_load_dwordx4 v[120:123], v1, s[44:47], s90 offen offset:2048 sc1
  s_mul_i32 s87, s48, 28672
  s_add_u32 s87, s87, 7340032
  s_mul_i32 s86, s58, 114688
  s_add_u32 s86, s86, s87
  v_add_u32 v245, s86, v1
  v_mfma_f32_32x32x16_bf16 v[144:159], v[220:223], v[88:91], v[144:159]
  ds_read_b128 v[212:215], v1 offset:5120
  s_xor_b32 s86, s58, 1
  s_mul_i32 s86, s86, 114688
  s_add_u32 s86, s86, s87
  v_add_u32_e64 v246, s86, v1
  s_waitcnt vmcnt(10) lgkmcnt(4)
  s_barrier
  v_mfma_f32_32x32x16_bf16 v[160:175], v[192:195], v[88:91], v[160:175]
  s_add_u32 m0, s64, 77824
  ds_read_b128 v[216:219], v1 offset:6144
  buffer_load_dwordx4 v229, s[4:7], m0 offen offset:0 sc1 lds
  v_mfma_f32_32x32x16_bf16 v[128:143], v[196:199], v[92:95], v[128:143]
  ds_read_b128 v[220:223], v1 offset:7168
  buffer_load_dwordx4 v[124:127], v1, s[44:47], s90 offen offset:3072 sc1
  s_waitcnt lgkmcnt(4)
  v_mfma_f32_32x32x16_bf16 v[144:159], v[200:203], v[92:95], v[144:159]
  ds_read_b128 v[192:195], v1 offset:8192
  v_mfma_f32_32x32x16_bf16 v[160:175], v[204:207], v[92:95], v[160:175]
  ds_read_b128 v[196:199], v1 offset:9216
  s_waitcnt vmcnt(11) lgkmcnt(4)
  v_mfma_f32_32x32x16_bf16 v[128:143], v[208:211], v[96:99], v[128:143]
  s_add_u32 m0, s64, 81920
  ds_read_b128 v[200:203], v1 offset:10240
  buffer_load_dwordx4 v229, s[4:7], m0 offen offset:0 sc1 lds
  v_mfma_f32_32x32x16_bf16 v[144:159], v[212:215], v[96:99], v[144:159]
  ds_read_b128 v[204:207], v1 offset:11264
  s_waitcnt vmcnt(10) lgkmcnt(4)
  v_mfma_f32_32x32x16_bf16 v[160:175], v[216:219], v[96:99], v[160:175]
  s_add_u32 m0, s64, 86016
  ds_read_b128 v[208:211], v1 offset:12288
  buffer_load_dwordx4 v229, s[4:7], m0 offen offset:0 sc1 lds
  v_mfma_f32_32x32x16_bf16 v[128:143], v[220:223], v[100:103], v[128:143]
  ds_read_b128 v[212:215], v1 offset:13312
  s_waitcnt lgkmcnt(4)
  v_mfma_f32_32x32x16_bf16 v[144:159], v[192:195], v[100:103], v[144:159]
  s_add_u32 m0, s64, 90112
  ds_read_b128 v[216:219], v1 offset:14336
  buffer_load_dwordx4 v229, s[4:7], m0 offen offset:0 sc1 lds
  v_mfma_f32_32x32x16_bf16 v[160:175], v[196:199], v[100:103], v[160:175]
  ds_read_b128 v[220:223], v1 offset:15360
  s_waitcnt vmcnt(11) lgkmcnt(4)
  v_mfma_f32_32x32x16_bf16 v[128:143], v[200:203], v[104:107], v[128:143]
  s_add_u32 m0, s65, 106496
  ds_read_b128 v[192:195], v1 offset:16384
  buffer_load_dwordx4 v228, s[4:7], m0 offen offset:0 sc1 lds
  v_mfma_f32_32x32x16_bf16 v[144:159], v[204:207], v[104:107], v[144:159]
  ds_read_b128 v[196:199], v1 offset:17408
  s_waitcnt vmcnt(10) lgkmcnt(4)
  v_mfma_f32_32x32x16_bf16 v[160:175], v[208:211], v[104:107], v[160:175]
  ds_read_b128 v[200:203], v1 offset:18432
  buffer_load_dwordx4 v228, s[4:7], m0 offen offset:1024 sc1 lds
  v_mfma_f32_32x32x16_bf16 v[128:143], v[212:215], v[108:111], v[128:143]
  ds_read_b128 v[204:207], v1 offset:19456
  s_waitcnt lgkmcnt(4)
  v_mfma_f32_32x32x16_bf16 v[144:159], v[216:219], v[108:111], v[144:159]
  s_add_u32 m0, s65, 114688
  ds_read_b128 v[208:211], v1 offset:20480
  buffer_load_dwordx4 v228, s[4:7], m0 offen offset:0 sc1 lds
  v_mfma_f32_32x32x16_bf16 v[160:175], v[220:223], v[108:111], v[160:175]
  ds_read_b128 v[212:215], v1 offset:21504
  s_waitcnt vmcnt(11) lgkmcnt(4)
  v_mfma_f32_32x32x16_bf16 v[128:143], v[192:195], v[112:115], v[128:143]
  ds_read_b128 v[216:219], v1 offset:22528
  buffer_load_dwordx4 v228, s[4:7], m0 offen offset:1024 sc1 lds
  v_mfma_f32_32x32x16_bf16 v[144:159], v[196:199], v[112:115], v[144:159]
  ds_read_b128 v[220:223], v1 offset:23552
  s_waitcnt vmcnt(10) lgkmcnt(4)
  v_mfma_f32_32x32x16_bf16 v[160:175], v[200:203], v[112:115], v[160:175]
  s_add_u32 m0, s65, 122880
  ds_read_b128 v[192:195], v1 offset:24576
  buffer_load_dwordx4 v228, s[4:7], m0 offen offset:0 sc1 lds
  v_mfma_f32_32x32x16_bf16 v[128:143], v[204:207], v[116:119], v[128:143]
  ds_read_b128 v[196:199], v1 offset:25600
  s_waitcnt lgkmcnt(4)
  v_mfma_f32_32x32x16_bf16 v[144:159], v[208:211], v[116:119], v[144:159]
  ds_read_b128 v[200:203], v1 offset:26624
  buffer_load_dwordx4 v228, s[4:7], m0 offen offset:1024 sc1 lds
  v_mfma_f32_32x32x16_bf16 v[160:175], v[212:215], v[116:119], v[160:175]
  ds_read_b128 v[204:207], v1 offset:27648
  s_waitcnt vmcnt(11) lgkmcnt(4)
  v_mfma_f32_32x32x16_bf16 v[128:143], v[216:219], v[120:123], v[128:143]
  s_add_u32 m0, s65, 131072
  v_add_u32 v251, 0x7000, v5
  ds_read2_b32 v[208:209], v251 offset0:0 offset1:32
  ds_read2_b32 v[210:211], v251 offset0:64 offset1:96
  buffer_load_dwordx4 v228, s[4:7], m0 offen offset:0 sc1 lds
  v_mfma_f32_32x32x16_bf16 v[144:159], v[220:223], v[120:123], v[144:159]
  v_add_u32 v252, 0x7400, v5
  ds_read2_b32 v[212:213], v252 offset0:0 offset1:32
  ds_read2_b32 v[214:215], v252 offset0:64 offset1:96
  s_waitcnt vmcnt(10) lgkmcnt(6)
  v_mfma_f32_32x32x16_bf16 v[160:175], v[192:195], v[120:123], v[160:175]
  v_add_u32 v253, 0x7800, v5
  ds_read2_b32 v[216:217], v253 offset0:0 offset1:32
  ds_read2_b32 v[218:219], v253 offset0:64 offset1:96
  buffer_load_dwordx4 v228, s[4:7], m0 offen offset:1024 sc1 lds
  v_mfma_f32_32x32x16_bf16 v[128:143], v[196:199], v[124:127], v[128:143]
  ds_read_b128 v[220:223], v1 offset:31744
  s_waitcnt lgkmcnt(7)
  v_mfma_f32_32x32x16_bf16 v[144:159], v[200:203], v[124:127], v[144:159]
  s_add_u32 m0, s65, 139264
  ds_read_b128 v[192:195], v1 offset:32768
  buffer_load_dwordx4 v228, s[4:7], m0 offen offset:0 sc1 lds
  v_mfma_f32_32x32x16_bf16 v[160:175], v[204:207], v[124:127], v[160:175]
  ds_read_b128 v[196:199], v1 offset:33792
  s_waitcnt lgkmcnt(5)
  v_mfma_f32_32x32x16_bf16 v[128:143], v[208:211], v[224:227], v[128:143]
  ds_read_b128 v[200:203], v1 offset:34816
  buffer_load_dwordx4 v228, s[4:7], m0 offen offset:1024 sc1 lds
  v_mfma_f32_32x32x16_bf16 v[144:159], v[212:215], v[224:227], v[144:159]
  ds_read_b128 v[204:207], v1 offset:35840
  s_waitcnt lgkmcnt(4)
  v_mfma_f32_32x32x16_bf16 v[160:175], v[216:219], v[224:227], v[160:175]
  s_add_u32 m0, s65, 147456
  ds_read_b128 v[208:211], v1 offset:36864
  buffer_load_dwordx4 v228, s[4:7], m0 offen offset:0 sc1 lds
  v_mul_f32 v128, v128, v249
  v_mul_f32 v129, v129, v249
  v_mul_f32 v130, v130, v249
  v_mul_f32_e64 v131, v131, v249
  v_mfma_f32_32x32x16_bf16 v[176:191], v[220:223], v[16:19], 0
  ds_read_b128 v[212:215], v1 offset:37888
  v_mul_f32 v132, v132, v249
  v_mul_f32 v133, v133, v249
  v_mul_f32_e64 v134, v134, v249
  v_mul_f32 v135, v135, v249
  s_waitcnt lgkmcnt(4)
  v_mfma_f32_32x32x16_bf16 v[176:191], v[192:195], v[20:23], v[176:191]
  ds_read_b128 v[216:219], v1 offset:38912
  buffer_load_dwordx4 v228, s[4:7], m0 offen offset:1024 sc1 lds
  v_exp_f32_e64 v128, -v128
  v_exp_f32_e64 v129, -v129
  v_mfma_f32_32x32x16_bf16 v[176:191], v[196:199], v[24:27], v[176:191]
  ds_read_b128 v[220:223], v1 offset:39936
  v_exp_f32_e64 v130, -v130
  v_fma_f32 v128, v128, v250, v250
  v_exp_f32_e64 v131, -v131
  s_waitcnt lgkmcnt(4)
  v_mfma_f32_32x32x16_bf16 v[176:191], v[200:203], v[28:31], v[176:191]
  s_add_u32 m0, s65, 155648
  ds_read_b128 v[192:195], v1 offset:40960
  buffer_load_dwordx4 v228, s[4:7], m0 offen offset:0 sc1 lds
  v_fma_f32 v129, v129, v250, v250
  v_exp_f32_e64 v132, -v132
  v_fma_f32 v130, v130, v250, v250
  v_mfma_f32_32x32x16_bf16 v[176:191], v[204:207], v[32:35], v[176:191]
  ds_read_b128 v[196:199], v1 offset:41984
  v_exp_f32_e64 v133, -v133
  v_fma_f32 v131, v131, v250, v250
  v_exp_f32_e64 v134, -v134
  s_waitcnt lgkmcnt(4)
  v_mfma_f32_32x32x16_bf16 v[176:191], v[208:211], v[36:39], v[176:191]
  ds_read_b128 v[200:203], v1 offset:43008
  buffer_load_dwordx4 v228, s[4:7], m0 offen offset:1024 sc1 lds
  v_fma_f32 v132, v132, v250, v250
  v_exp_f32_e64 v135, -v135
  v_fma_f32 v133, v133, v250, v250
  v_fma_f32 v134, v134, v250, v250
  v_mfma_f32_32x32x16_bf16 v[176:191], v[212:215], v[40:43], v[176:191]
  ds_read_b128 v[204:207], v1 offset:44032
  v_fma_f32 v135, v135, v250, v250
  v_rcp_f32_e64 v128, v128
  v_rcp_f32 v129, v129
  s_waitcnt lgkmcnt(4)
  v_mfma_f32_32x32x16_bf16 v[176:191], v[216:219], v[44:47], v[176:191]
  v_and_b32 v232, 3, v0
  v_lshlrev_b32 v232, 7, v232
  ds_read_b128 v[208:211], v1 offset:45056
  global_load_dword v233, v232, s[100:101]
  v_rcp_f32 v130, v130
  v_mul_f32 v128, v128, v136
  v_mfma_f32_32x32x16_bf16 v[176:191], v[220:223], v[48:51], v[176:191]
  ds_read_b128 v[212:215], v1 offset:46080
  v_rcp_f32 v131, v131
  v_mul_f32 v129, v129, v137
  v_rcp_f32 v132, v132
  s_waitcnt lgkmcnt(4)
  v_mfma_f32_32x32x16_bf16 v[176:191], v[192:195], v[52:55], v[176:191]
  ds_read_b128 v[216:219], v1 offset:47104
  v_mul_f32 v130, v130, v138
  v_rcp_f32 v133, v133
  v_mul_f32 v131, v131, v139
  v_rcp_f32 v134, v134
  v_mfma_f32_32x32x16_bf16 v[176:191], v[196:199], v[56:59], v[176:191]
  ds_read_b128 v[220:223], v1 offset:48128
  v_mul_f32 v132, v132, v140
  v_rcp_f32 v135, v135
  v_mul_f32_e64 v133, v133, v141
  v_mul_f32 v134, v134, v142
  s_waitcnt lgkmcnt(4)
  v_mfma_f32_32x32x16_bf16 v[176:191], v[200:203], v[60:63], v[176:191]
  ds_read_b128 v[192:195], v1 offset:49152
  v_mul_f32_e64 v135, v135, v143
  v_cvt_pk_bf16_f32 v136, v128, v129
  v_cvt_pk_bf16_f32 v137, v130, v131
  v_cvt_pk_bf16_f32 v138, v132, v133
  v_cvt_pk_bf16_f32 v139, v134, v135
  v_mfma_f32_32x32x16_bf16 v[176:191], v[204:207], v[64:67], v[176:191]
  ds_read_b128 v[196:199], v1 offset:50176
  buffer_store_dwordx4 v[136:139], v1, s[44:47], s73 offen offset:0 sc1
  v_mul_f32 v144, v144, v249
  v_mul_f32 v145, v145, v249
  v_mul_f32_e64 v146, v146, v249
  v_mul_f32 v147, v147, v249
  s_waitcnt lgkmcnt(4)
  v_mfma_f32_32x32x16_bf16 v[176:191], v[208:211], v[68:71], v[176:191]
  ds_read_b128 v[200:203], v1 offset:51200
  v_mul_f32 v148, v148, v249
  v_mul_f32 v149, v149, v249
  v_mul_f32 v150, v150, v249
  v_mul_f32 v151, v151, v249
  v_exp_f32_e64 v144, -v144
  v_mfma_f32_32x32x16_bf16 v[176:191], v[212:215], v[72:75], v[176:191]
  ds_read_b128 v[204:207], v1 offset:52224
  v_exp_f32_e64 v145, -v145
  v_exp_f32_e64 v146, -v146
  v_fma_f32 v144, v144, v250, v250
  s_waitcnt lgkmcnt(4)
  v_mfma_f32_32x32x16_bf16 v[176:191], v[216:219], v[76:79], v[176:191]
  ds_read_b128 v[208:211], v1 offset:53248
  v_exp_f32_e64 v147, -v147
  v_fma_f32 v145, v145, v250, v250
  v_exp_f32_e64 v148, -v148
  v_fma_f32 v146, v146, v250, v250
  v_mfma_f32_32x32x16_bf16 v[176:191], v[220:223], v[80:83], v[176:191]
  ds_read_b128 v[212:215], v1 offset:54272
  v_exp_f32_e64 v149, -v149
  v_fma_f32 v147, v147, v250, v250
  v_exp_f32_e64 v150, -v150
  s_waitcnt lgkmcnt(4)
  v_mfma_f32_32x32x16_bf16 v[176:191], v[192:195], v[84:87], v[176:191]
  ds_read_b128 v[216:219], v1 offset:55296
  v_fma_f32 v148, v148, v250, v250
  v_exp_f32_e64 v151, -v151
  v_fma_f32 v149, v149, v250, v250
  v_fma_f32 v150, v150, v250, v250
  v_fma_f32 v151, v151, v250, v250
  v_mfma_f32_32x32x16_bf16 v[176:191], v[196:199], v[88:91], v[176:191]
  ds_read_b128 v[220:223], v1 offset:56320
  v_rcp_f32_e64 v144, v144
  v_rcp_f32 v145, v145
  s_waitcnt lgkmcnt(4)
  s_waitcnt vmcnt(16)
  s_barrier
  v_mfma_f32_32x32x16_bf16 v[176:191], v[200:203], v[92:95], v[176:191]
  ds_read_b128 v[192:195], v1 offset:57344
  v_rcp_f32 v146, v146
  v_mul_f32 v144, v144, v152
  v_rcp_f32 v147, v147
  v_mul_f32 v145, v145, v153
  v_mfma_f32_32x32x16_bf16 v[176:191], v[204:207], v[96:99], v[176:191]
  ds_read_b128 v[196:199], v1 offset:58368
  v_rcp_f32 v148, v148
  v_mul_f32 v146, v146, v154
  v_rcp_f32 v149, v149
  s_waitcnt lgkmcnt(4)
  v_mfma_f32_32x32x16_bf16 v[176:191], v[208:211], v[100:103], v[176:191]
  ds_read_b128 v[200:203], v1 offset:59392
  v_mul_f32 v147, v147, v155
  v_rcp_f32 v150, v150
  v_mul_f32 v148, v148, v156
  v_rcp_f32 v151, v151
  v_mfma_f32_32x32x16_bf16 v[176:191], v[212:215], v[104:107], v[176:191]
  v_add_u32 v252, 0xec00, v5
  ds_read2_b32 v[204:205], v252 offset0:0 offset1:32
  ds_read2_b32 v[206:207], v252 offset0:64 offset1:96
  v_mul_f32 v149, v149, v157
  v_mul_f32 v150, v150, v158
  v_mul_f32 v151, v151, v159
  s_waitcnt lgkmcnt(5)
  v_mfma_f32_32x32x16_bf16 v[176:191], v[216:219], v[108:111], v[176:191]
  ds_read_b128 v[208:211], v1 offset:61440
  v_cvt_pk_bf16_f32 v152, v144, v145
  v_cvt_pk_bf16_f32 v153, v146, v147
  v_cvt_pk_bf16_f32 v154, v148, v149
  v_cvt_pk_bf16_f32 v155, v150, v151
  v_mfma_f32_32x32x16_bf16 v[176:191], v[220:223], v[112:115], v[176:191]
  ds_read_b128 v[212:215], v1 offset:62464
  buffer_store_dwordx4 v[152:155], v1, s[44:47], s73 offen offset:1024 sc1
  v_mul_f32 v160, v160, v249
  v_mul_f32 v161, v161, v249
  v_mul_f32_e64 v162, v162, v249
  v_mul_f32 v163, v163, v249
  s_waitcnt lgkmcnt(5)
  v_mfma_f32_32x32x16_bf16 v[176:191], v[192:195], v[116:119], v[176:191]
  ds_read_b128 v[216:219], v1 offset:63488
  v_mul_f32 v164, v164, v249
  v_mul_f32 v165, v165, v249
  v_mul_f32 v166, v166, v249
  v_mul_f32 v167, v167, v249
  v_exp_f32_e64 v160, -v160
  v_mfma_f32_32x32x16_bf16 v[176:191], v[196:199], v[120:123], v[176:191]
  ds_read_b128 v[220:223], v1 offset:64512
  v_exp_f32_e64 v161, -v161
  v_exp_f32_e64 v162, -v162
  v_fma_f32 v160, v160, v250, v250
  s_waitcnt lgkmcnt(4)
  v_mfma_f32_32x32x16_bf16 v[176:191], v[200:203], v[124:127], v[176:191]
  ds_read_b128 v[192:195], v2 offset:0
  v_exp_f32_e64 v163, -v163
  v_fma_f32 v161, v161, v250, v250
  v_exp_f32_e64 v164, -v164
  v_fma_f32 v162, v162, v250, v250
  v_mfma_f32_32x32x16_bf16 v[176:191], v[204:207], v[224:227], v[176:191]
  ds_read_b128 v[196:199], v2 offset:1024
  v_exp_f32_e64 v165, -v165
  v_fma_f32 v163, v163, v250, v250
  v_exp_f32_e64 v166, -v166
  s_waitcnt lgkmcnt(4)
  v_mfma_f32_32x32x16_bf16 v[128:143], v[208:211], v[16:19], 0
  ds_read_b128 v[200:203], v2 offset:2048
  v_fma_f32 v164, v164, v250, v250
  v_exp_f32_e64 v167, -v167
  v_fma_f32 v165, v165, v250, v250
  v_fma_f32 v166, v166, v250, v250
  v_fma_f32 v167, v167, v250, v250
  v_mfma_f32_32x32x16_bf16 v[128:143], v[212:215], v[20:23], v[128:143]
  ds_read_b128 v[204:207], v2 offset:3072
  v_rcp_f32_e64 v160, v160
  v_rcp_f32 v161, v161
  s_waitcnt lgkmcnt(4)
  v_mfma_f32_32x32x16_bf16 v[128:143], v[216:219], v[24:27], v[128:143]
  ds_read_b128 v[208:211], v2 offset:4096
  v_rcp_f32 v162, v162
  v_mul_f32 v160, v160, v168
  v_rcp_f32 v163, v163
  v_mul_f32 v161, v161, v169
  v_mfma_f32_32x32x16_bf16 v[128:143], v[220:223], v[28:31], v[128:143]
  ds_read_b128 v[212:215], v2 offset:5120
  v_rcp_f32 v164, v164
  v_mul_f32 v162, v162, v170
  v_rcp_f32 v165, v165
  s_waitcnt lgkmcnt(4)
  v_mfma_f32_32x32x16_bf16 v[128:143], v[192:195], v[32:35], v[128:143]
  ds_read_b128 v[216:219], v2 offset:6144
  v_mul_f32 v163, v163, v171
  v_rcp_f32 v166, v166
  v_mul_f32 v164, v164, v172
  v_rcp_f32 v167, v167
  v_mfma_f32_32x32x16_bf16 v[128:143], v[196:199], v[36:39], v[128:143]
  ds_read_b128 v[220:223], v2 offset:7168
  v_mul_f32 v165, v165, v173
  v_mul_f32 v166, v166, v174
  v_mul_f32_e64 v167, v167, v175
  v_cvt_pk_bf16_f32 v168, v160, v161
  v_cvt_pk_bf16_f32 v169, v162, v163
  s_waitcnt lgkmcnt(4)
  v_mfma_f32_32x32x16_bf16 v[128:143], v[200:203], v[40:43], v[128:143]
  ds_read_b128 v[192:195], v2 offset:8192
  v_cvt_pk_bf16_f32 v170, v164, v165
  v_cvt_pk_bf16_f32 v171, v166, v167
  v_mfma_f32_32x32x16_bf16 v[128:143], v[204:207], v[44:47], v[128:143]
  ds_read_b128 v[196:199], v2 offset:9216
  buffer_store_dwordx4 v[168:171], v1, s[44:47], s73 offen offset:2048 sc1
  v_mul_f32 v176, v176, v249
  v_mul_f32 v177, v177, v249
  v_mul_f32 v178, v178, v249
  v_mul_f32 v179, v179, v249
  s_waitcnt lgkmcnt(4)
  v_mfma_f32_32x32x16_bf16 v[128:143], v[208:211], v[48:51], v[128:143]
  ds_read_b128 v[200:203], v2 offset:10240
  v_mul_f32 v180, v180, v249
  v_mul_f32 v181, v181, v249
  v_mul_f32 v182, v182, v249
  v_mul_f32 v183, v183, v249
  v_exp_f32_e64 v176, -v176
  v_mfma_f32_32x32x16_bf16 v[128:143], v[212:215], v[52:55], v[128:143]
  ds_read_b128 v[204:207], v2 offset:11264
  v_exp_f32_e64 v177, -v177
  v_exp_f32_e64 v178, -v178
  v_fma_f32 v176, v176, v250, v250
  s_waitcnt lgkmcnt(4)
  v_mfma_f32_32x32x16_bf16 v[128:143], v[216:219], v[56:59], v[128:143]
  ds_read_b128 v[208:211], v2 offset:12288
  v_exp_f32_e64 v179, -v179
  v_fma_f32 v177, v177, v250, v250
  v_exp_f32_e64 v180, -v180
  v_fma_f32 v178, v178, v250, v250
  v_mfma_f32_32x32x16_bf16 v[128:143], v[220:223], v[60:63], v[128:143]
  ds_read_b128 v[212:215], v2 offset:13312
  v_exp_f32_e64 v181, -v181
  v_fma_f32 v179, v179, v250, v250
  v_exp_f32_e64 v182, -v182
  s_waitcnt lgkmcnt(4)
  v_mfma_f32_32x32x16_bf16 v[128:143], v[192:195], v[64:67], v[128:143]
  ds_read_b128 v[216:219], v2 offset:14336
  v_fma_f32 v180, v180, v250, v250
  v_exp_f32_e64 v183, -v183
  v_fma_f32 v181, v181, v250, v250
  v_fma_f32 v182, v182, v250, v250
  v_fma_f32 v183, v183, v250, v250
  v_mfma_f32_32x32x16_bf16 v[128:143], v[196:199], v[68:71], v[128:143]
  ds_read_b128 v[220:223], v2 offset:15360
  v_rcp_f32_e64 v176, v176
  v_rcp_f32 v177, v177
  s_waitcnt lgkmcnt(4)
  v_mfma_f32_32x32x16_bf16 v[128:143], v[200:203], v[72:75], v[128:143]
  ds_read_b128 v[192:195], v2 offset:16384
  v_rcp_f32 v178, v178
  v_mul_f32 v176, v176, v184
  v_rcp_f32 v179, v179
  v_mul_f32 v177, v177, v185
  v_mfma_f32_32x32x16_bf16 v[128:143], v[204:207], v[76:79], v[128:143]
  ds_read_b128 v[196:199], v2 offset:17408
  s_waitcnt vmcnt(1)
  v_mov_b32_e64 v254, 1
  s_mov_b64 exec, 1
  buffer_store_dword v254, off, s[40:43], s94 offset:0
  s_mov_b64 exec, -1
  s_waitcnt lgkmcnt(4)
  v_mfma_f32_32x32x16_bf16 v[128:143], v[208:211], v[80:83], v[128:143]
  ds_read_b128 v[200:203], v2 offset:18432
  v_rcp_f32 v180, v180
  v_mul_f32 v178, v178, v186
  v_rcp_f32 v181, v181
  v_mul_f32 v179, v179, v187
  v_mfma_f32_32x32x16_bf16 v[128:143], v[212:215], v[84:87], v[128:143]
  ds_read_b128 v[204:207], v2 offset:19456
  v_rcp_f32 v182, v182
  v_mul_f32 v180, v180, v188
  v_rcp_f32 v183, v183
  s_waitcnt lgkmcnt(4)
  v_mfma_f32_32x32x16_bf16 v[128:143], v[216:219], v[88:91], v[128:143]
  ds_read_b128 v[208:211], v2 offset:20480
  v_mul_f32 v181, v181, v189
  v_mul_f32 v182, v182, v190
  v_mul_f32_e64 v183, v183, v191
  v_cvt_pk_bf16_f32 v184, v176, v177
  v_cvt_pk_bf16_f32 v185, v178, v179
  v_cvt_pk_bf16_f32 v186, v180, v181
  v_mfma_f32_32x32x16_bf16 v[128:143], v[220:223], v[92:95], v[128:143]
  ds_read_b128 v[212:215], v2 offset:21504
  v_cvt_pk_bf16_f32 v187, v182, v183
  s_waitcnt lgkmcnt(4)
  v_mfma_f32_32x32x16_bf16 v[128:143], v[192:195], v[96:99], v[128:143]
  ds_read_b128 v[216:219], v2 offset:22528
  buffer_store_dwordx4 v[184:187], v1, s[44:47], s73 offen offset:3072 sc1
  v_mfma_f32_32x32x16_bf16 v[128:143], v[196:199], v[100:103], v[128:143]
  ds_read_b128 v[220:223], v2 offset:23552
  s_waitcnt lgkmcnt(4)
  v_mfma_f32_32x32x16_bf16 v[128:143], v[200:203], v[104:107], v[128:143]
  v_add_u32 v251, 0x16000, v5
  ds_read2_b32 v[192:193], v251 offset0:0 offset1:32
  ds_read2_b32 v[194:195], v251 offset0:64 offset1:96
  s_barrier
  v_mfma_f32_32x32x16_bf16 v[128:143], v[204:207], v[108:111], v[128:143]
  ds_read_b128 v[196:199], v2 offset:40960
  s_waitcnt lgkmcnt(5)
  v_mfma_f32_32x32x16_bf16 v[128:143], v[208:211], v[112:115], v[128:143]
  v_and_b32 v232, 3, v0
  v_lshlrev_b32 v232, 7, v232
  ds_read_b128 v[200:203], v2 offset:41984
  global_load_dword v233, v232, s[100:101]
  v_mfma_f32_32x32x16_bf16 v[128:143], v[212:215], v[116:119], v[128:143]
  ds_read_b128 v[204:207], v2 offset:43008
  s_waitcnt lgkmcnt(5)
  v_mfma_f32_32x32x16_bf16 v[128:143], v[216:219], v[120:123], v[128:143]
  ds_read_b128 v[208:211], v2 offset:44032
  v_mfma_f32_32x32x16_bf16 v[128:143], v[220:223], v[124:127], v[128:143]
  ds_read_b128 v[212:215], v2 offset:45056
  s_waitcnt lgkmcnt(4)
  v_mfma_f32_32x32x16_bf16 v[128:143], v[192:195], v[224:227], v[128:143]
  ds_read_b128 v[216:219], v2 offset:46080
  v_mfma_f32_32x32x16_bf16 v[144:159], v[196:199], v[16:19], 0
  ds_read_b128 v[220:223], v2 offset:47104
  s_waitcnt lgkmcnt(4)
  v_mfma_f32_32x32x16_bf16 v[144:159], v[200:203], v[20:23], v[144:159]
  ds_read_b128 v[192:195], v2 offset:48128
  v_mul_f32 v128, v128, v249
  v_mul_f32 v129, v129, v249
  v_mul_f32 v130, v130, v249
  v_mul_f32 v131, v131, v249
  v_mul_f32 v132, v132, v249
  v_mul_f32_e64 v133, v133, v249
  v_mfma_f32_32x32x16_bf16 v[144:159], v[204:207], v[24:27], v[144:159]
  ds_read_b128 v[196:199], v2 offset:49152
  v_mul_f32 v134, v134, v249
  v_mul_f32 v135, v135, v249
  v_exp_f32_e64 v128, -v128
  s_waitcnt lgkmcnt(4)
  v_mfma_f32_32x32x16_bf16 v[144:159], v[208:211], v[28:31], v[144:159]
  ds_read_b128 v[200:203], v2 offset:50176
  v_exp_f32_e64 v129, -v129
  v_exp_f32_e64 v130, -v130
  v_fma_f32 v128, v128, v250, v250
  v_mfma_f32_32x32x16_bf16 v[144:159], v[212:215], v[32:35], v[144:159]
  ds_read_b128 v[204:207], v2 offset:51200
  v_exp_f32_e64 v131, -v131
  v_fma_f32 v129, v129, v250, v250
  v_exp_f32_e64 v132, -v132
  s_waitcnt lgkmcnt(4)
  v_mfma_f32_32x32x16_bf16 v[144:159], v[216:219], v[36:39], v[144:159]
  ds_read_b128 v[208:211], v2 offset:52224
  v_fma_f32 v130, v130, v250, v250
  v_exp_f32_e64 v133, -v133
  v_fma_f32 v131, v131, v250, v250
  v_exp_f32_e64 v134, -v134
  v_mfma_f32_32x32x16_bf16 v[144:159], v[220:223], v[40:43], v[144:159]
  ds_read_b128 v[212:215], v2 offset:53248
  v_fma_f32 v132, v132, v250, v250
  v_exp_f32_e64 v135, -v135
  v_fma_f32 v133, v133, v250, v250
  v_fma_f32 v134, v134, v250, v250
  s_waitcnt lgkmcnt(4)
  v_mfma_f32_32x32x16_bf16 v[144:159], v[192:195], v[44:47], v[144:159]
  ds_read_b128 v[216:219], v2 offset:54272
  v_fma_f32 v135, v135, v250, v250
  v_rcp_f32 v128, v128
  v_rcp_f32_e64 v129, v129
  v_mfma_f32_32x32x16_bf16 v[144:159], v[196:199], v[48:51], v[144:159]
  ds_read_b128 v[220:223], v2 offset:55296
  v_rcp_f32 v130, v130
  v_mul_f32 v128, v128, v136
  v_rcp_f32 v131, v131
  s_waitcnt lgkmcnt(4)
  v_mfma_f32_32x32x16_bf16 v[144:159], v[200:203], v[52:55], v[144:159]
  ds_read_b128 v[192:195], v2 offset:56320
  v_mul_f32 v129, v129, v137
  v_rcp_f32 v132, v132
  v_mul_f32 v130, v130, v138
  v_rcp_f32 v133, v133
  v_mfma_f32_32x32x16_bf16 v[144:159], v[204:207], v[56:59], v[144:159]
  ds_read_b128 v[196:199], v2 offset:57344
  v_mul_f32 v131, v131, v139
  v_rcp_f32 v134, v134
  v_mul_f32 v132, v132, v140
  s_waitcnt lgkmcnt(4)
  v_mfma_f32_32x32x16_bf16 v[144:159], v[208:211], v[60:63], v[144:159]
  ds_read_b128 v[200:203], v2 offset:58368
  v_rcp_f32 v135, v135
  v_mul_f32 v133, v133, v141
  v_mul_f32 v134, v134, v142
  v_mul_f32 v135, v135, v143
  v_cvt_pk_bf16_f32 v136, v128, v129
  v_mfma_f32_32x32x16_bf16 v[144:159], v[212:215], v[64:67], v[144:159]
  ds_read_b128 v[204:207], v2 offset:59392
  buffer_load_dword v247, v244, s[40:43], 0 offen offset:0 sc1
  s_waitcnt vmcnt(2)
  v_mov_b32_e64 v254, 1
  s_mov_b64 exec, 1
  buffer_store_dword v254, off, s[40:43], s94 offset:64
  s_mov_b64 exec, -1
  s_waitcnt lgkmcnt(4)
  v_mfma_f32_32x32x16_bf16 v[144:159], v[216:219], v[68:71], v[144:159]
  ds_read_b128 v[208:211], v2 offset:60416
  v_cvt_pk_bf16_f32 v137, v130, v131
  v_cvt_pk_bf16_f32 v138, v132, v133
  v_cvt_pk_bf16_f32 v139, v134, v135
  v_mfma_f32_32x32x16_bf16 v[144:159], v[220:223], v[72:75], v[144:159]
  ds_read_b128 v[212:215], v2 offset:61440
  buffer_store_dwordx4 v[136:139], v1, s[44:47], s74 offen offset:0 sc1
  s_waitcnt lgkmcnt(4)
  v_mfma_f32_32x32x16_bf16 v[144:159], v[192:195], v[76:79], v[144:159]
  ds_read_b128 v[216:219], v2 offset:62464
  v_mfma_f32_32x32x16_bf16 v[144:159], v[196:199], v[80:83], v[144:159]
  ds_read_b128 v[220:223], v2 offset:63488
  s_waitcnt lgkmcnt(4)
  v_mfma_f32_32x32x16_bf16 v[144:159], v[200:203], v[84:87], v[144:159]
  ds_read_b128 v[192:195], v2 offset:64512
  v_mfma_f32_32x32x16_bf16 v[144:159], v[204:207], v[88:91], v[144:159]
  ds_read_b128 v[196:199], v3 offset:0
  s_waitcnt lgkmcnt(4)
  v_mfma_f32_32x32x16_bf16 v[144:159], v[208:211], v[92:95], v[144:159]
  ds_read_b128 v[200:203], v3 offset:1024
  v_mfma_f32_32x32x16_bf16 v[144:159], v[212:215], v[96:99], v[144:159]
  ds_read_b128 v[204:207], v3 offset:2048
  s_waitcnt lgkmcnt(4)
  v_mfma_f32_32x32x16_bf16 v[144:159], v[216:219], v[100:103], v[144:159]
  ds_read_b128 v[208:211], v3 offset:3072
  v_mfma_f32_32x32x16_bf16 v[144:159], v[220:223], v[104:107], v[144:159]
  v_add_u32 v253, 0x21000, v5
  ds_read2_b32 v[212:213], v253 offset0:0 offset1:32
  ds_read2_b32 v[214:215], v253 offset0:64 offset1:96
  s_waitcnt lgkmcnt(5)
  v_mfma_f32_32x32x16_bf16 v[144:159], v[192:195], v[108:111], v[144:159]
  ds_read_b128 v[216:219], v3 offset:5120
  v_mfma_f32_32x32x16_bf16 v[144:159], v[196:199], v[112:115], v[144:159]
  ds_read_b128 v[220:223], v3 offset:6144
  s_waitcnt lgkmcnt(5)
  v_mfma_f32_32x32x16_bf16 v[144:159], v[200:203], v[116:119], v[144:159]
  ds_read_b128 v[192:195], v3 offset:7168
  v_mfma_f32_32x32x16_bf16 v[144:159], v[204:207], v[120:123], v[144:159]
  ds_read_b128 v[196:199], v3 offset:8192
  s_waitcnt lgkmcnt(4)
  v_mfma_f32_32x32x16_bf16 v[144:159], v[208:211], v[124:127], v[144:159]
  ds_read_b128 v[200:203], v3 offset:9216
  v_mfma_f32_32x32x16_bf16 v[144:159], v[212:215], v[224:227], v[144:159]
  ds_read_b128 v[204:207], v3 offset:10240
  s_waitcnt lgkmcnt(4)
  v_mfma_f32_32x32x16_bf16 v[160:175], v[216:219], v[16:19], 0
  ds_read_b128 v[208:211], v3 offset:11264
  s_waitcnt vmcnt(2)
  v_mfma_f32_32x32x16_bf16 v[160:175], v[220:223], v[20:23], v[160:175]
  ds_read_b128 v[212:215], v3 offset:12288
  s_mov_b32 s90, 0
  buffer_load_dwordx4 v[16:19], v245, s[44:47], s90 offen sc1
  v_mul_f32 v144, v144, v249
  v_mul_f32 v145, v145, v249
  v_mul_f32 v146, v146, v249
  s_waitcnt lgkmcnt(4)
  v_mfma_f32_32x32x16_bf16 v[160:175], v[192:195], v[24:27], v[160:175]
  ds_read_b128 v[216:219], v3 offset:13312
  v_mul_f32 v147, v147, v249
  v_mul_f32 v148, v148, v249
  v_mul_f32 v149, v149, v249
  v_mul_f32 v150, v150, v249
  v_mul_f32_e64 v151, v151, v249
  v_mfma_f32_32x32x16_bf16 v[160:175], v[196:199], v[28:31], v[160:175]
  ds_read_b128 v[220:223], v3 offset:14336
  buffer_load_dwordx4 v[20:23], v246, s[44:47], s90 offen sc1
  v_exp_f32_e64 v144, -v144
  v_exp_f32_e64 v145, -v145
  s_waitcnt lgkmcnt(4)
  v_mfma_f32_32x32x16_bf16 v[160:175], v[200:203], v[32:35], v[160:175]
  ds_read_b128 v[192:195], v3 offset:15360
  v_exp_f32_e64 v146, -v146
  v_fma_f32 v144, v144, v250, v250
  v_exp_f32_e64 v147, -v147
  v_fma_f32 v145, v145, v250, v250
  v_mfma_f32_32x32x16_bf16 v[160:175], v[204:207], v[36:39], v[160:175]
  ds_read_b128 v[196:199], v3 offset:16384
  s_mov_b32 s90, 7168
  buffer_load_dwordx4 v[24:27], v245, s[44:47], s90 offen sc1
  s_waitcnt vmcnt(3)
  v_mov_b32 v254, 1
  s_mov_b64 exec, 1
  buffer_store_dword v254, off, s[40:43], s94 offset:256
  s_mov_b64 exec, -1
  s_waitcnt lgkmcnt(4)
  v_mfma_f32_32x32x16_bf16 v[160:175], v[208:211], v[40:43], v[160:175]
  ds_read_b128 v[200:203], v3 offset:17408
  v_exp_f32_e64 v148, -v148
  v_fma_f32 v146, v146, v250, v250
  v_exp_f32_e64 v149, -v149
  v_fma_f32 v147, v147, v250, v250
  v_mfma_f32_32x32x16_bf16 v[160:175], v[212:215], v[44:47], v[160:175]
  ds_read_b128 v[204:207], v3 offset:18432
  buffer_load_dwordx4 v[28:31], v246, s[44:47], s90 offen sc1
  v_exp_f32_e64 v150, -v150
  v_fma_f32 v148, v148, v250, v250
  s_waitcnt lgkmcnt(4)
  v_mfma_f32_32x32x16_bf16 v[160:175], v[216:219], v[48:51], v[160:175]
  ds_read_b128 v[208:211], v3 offset:19456
  v_exp_f32_e64 v151, -v151
  v_fma_f32 v149, v149, v250, v250
  v_fma_f32 v150, v150, v250, v250
  v_fma_f32 v151, v151, v250, v250
  v_mfma_f32_32x32x16_bf16 v[160:175], v[220:223], v[52:55], v[160:175]
  ds_read_b128 v[212:215], v3 offset:20480
  s_mov_b32 s90, 14336
  buffer_load_dwordx4 v[32:35], v245, s[44:47], s90 offen sc1
  v_rcp_f32_e64 v144, v144
  s_waitcnt lgkmcnt(4)
  v_mfma_f32_32x32x16_bf16 v[160:175], v[192:195], v[56:59], v[160:175]
  ds_read_b128 v[216:219], v3 offset:21504
  v_rcp_f32 v145, v145
  v_rcp_f32 v146, v146
  v_mul_f32_e64 v144, v144, v152
  v_mfma_f32_32x32x16_bf16 v[160:175], v[196:199], v[60:63], v[160:175]
  ds_read_b128 v[220:223], v3 offset:22528
  buffer_load_dwordx4 v[36:39], v246, s[44:47], s90 offen sc1
  v_rcp_f32_e64 v147, v147
  v_mul_f32 v145, v145, v153
  s_waitcnt lgkmcnt(4)
  v_mfma_f32_32x32x16_bf16 v[160:175], v[200:203], v[64:67], v[160:175]
  ds_read_b128 v[192:195], v3 offset:23552
  v_rcp_f32 v148, v148
  v_mul_f32 v146, v146, v154
  v_rcp_f32 v149, v149
  v_mul_f32 v147, v147, v155
  v_mfma_f32_32x32x16_bf16 v[160:175], v[204:207], v[68:71], v[160:175]
  ds_read_b128 v[196:199], v3 offset:24576
  s_mov_b32 s90, 21504
  buffer_load_dwordx4 v[40:43], v245, s[44:47], s90 offen sc1
  v_rcp_f32_e64 v150, v150
  v_mul_f32 v148, v148, v156
  s_waitcnt lgkmcnt(4)
  v_mfma_f32_32x32x16_bf16 v[160:175], v[208:211], v[72:75], v[160:175]
  ds_read_b128 v[200:203], v3 offset:25600
  v_rcp_f32 v151, v151
  v_mul_f32 v149, v149, v157
  v_mul_f32 v150, v150, v158
  v_mul_f32 v151, v151, v159
  v_cvt_pk_bf16_f32 v152, v144, v145
  v_mfma_f32_32x32x16_bf16 v[160:175], v[212:215], v[76:79], v[160:175]
  ds_read_b128 v[204:207], v3 offset:26624
  buffer_load_dwordx4 v[44:47], v246, s[44:47], s90 offen sc1
  v_cvt_pk_bf16_f32 v153, v146, v147
  v_cvt_pk_bf16_f32 v154, v148, v149
  v_cvt_pk_bf16_f32 v155, v150, v151
  s_waitcnt lgkmcnt(4)
  v_mfma_f32_32x32x16_bf16 v[160:175], v[216:219], v[80:83], v[160:175]
  ds_read_b128 v[208:211], v3 offset:27648
  buffer_store_dwordx4 v[152:155], v1, s[44:47], s74 offen offset:1024 sc1
  v_mfma_f32_32x32x16_bf16 v[160:175], v[220:223], v[84:87], v[160:175]
  ds_read_b128 v[212:215], v3 offset:28672
  s_mov_b32 s90, 1024
  buffer_load_dwordx4 v[48:51], v245, s[44:47], s90 offen sc1
  s_waitcnt lgkmcnt(4)
  v_mfma_f32_32x32x16_bf16 v[160:175], v[192:195], v[88:91], v[160:175]
  ds_read_b128 v[216:219], v3 offset:29696
  v_mfma_f32_32x32x16_bf16 v[160:175], v[196:199], v[92:95], v[160:175]
  ds_read_b128 v[220:223], v3 offset:30720
  buffer_load_dwordx4 v[52:55], v246, s[44:47], s90 offen sc1
  s_waitcnt lgkmcnt(4)
  v_mfma_f32_32x32x16_bf16 v[160:175], v[200:203], v[96:99], v[160:175]
  ds_read_b128 v[192:195], v3 offset:31744
  v_mfma_f32_32x32x16_bf16 v[160:175], v[204:207], v[100:103], v[160:175]
  ds_read_b128 v[196:199], v2 offset:25600
  s_mov_b32 s90, 8192
  buffer_load_dwordx4 v[56:59], v245, s[44:47], s90 offen sc1
  s_waitcnt lgkmcnt(4)
  v_mfma_f32_32x32x16_bf16 v[160:175], v[208:211], v[104:107], v[160:175]
  v_add_u32 v252, 0x16800, v5
  ds_read2_b32 v[200:201], v252 offset0:0 offset1:32
  ds_read2_b32 v[202:203], v252 offset0:64 offset1:96
  v_mfma_f32_32x32x16_bf16 v[160:175], v[212:215], v[108:111], v[160:175]
  buffer_load_dwordx4 v[60:63], v246, s[44:47], s90 offen sc1
  s_waitcnt lgkmcnt(4)
  v_mfma_f32_32x32x16_bf16 v[160:175], v[216:219], v[112:115], v[160:175]
  s_buffer_load_dwordx4 s[76:79], s[40:43], s85 offset:64
  s_buffer_load_dwordx4 s[80:83], s[40:43], s85 offset:576
  v_mfma_f32_32x32x16_bf16 v[160:175], v[220:223], v[116:119], v[160:175]
  s_mov_b32 s90, 15360
  buffer_load_dwordx4 v[64:67], v245, s[44:47], s90 offen sc1
  s_waitcnt lgkmcnt(2)
  v_mfma_f32_32x32x16_bf16 v[160:175], v[192:195], v[120:123], v[160:175]
  v_mfma_f32_32x32x16_bf16 v[160:175], v[196:199], v[124:127], v[160:175]
  buffer_load_dwordx4 v[68:71], v246, s[44:47], s90 offen sc1
  s_waitcnt lgkmcnt(0)
  v_mfma_f32_32x32x16_bf16 v[160:175], v[200:203], v[224:227], v[160:175]
  s_cmp_ge_u32 s49, 28
  s_cbranch_scc1 Lc_48
  v_cmp_ne_u32 vcc, 1, v247
  s_waitcnt lgkmcnt(0)
  s_and_b64 s[76:77], s[76:77], s[78:79]
  s_and_b64 s[80:81], s[80:81], s[82:83]
  s_and_b64 s[76:77], s[76:77], s[80:81]
  s_and_b32 s76, s76, s77
  s_cmp_eq_u64 vcc, 0
  s_cselect_b32 s77, 1, 0
  s_and_b32 s76, s76, s77
  s_cbranch_scc0 Lc_49
Lr_50:
  s_waitcnt vmcnt(15)
  v_mfma_f32_32x32x16_bf16 v[208:223], a[0:3], v[16:19], 0
  s_mov_b32 s90, 22528
  buffer_load_dwordx4 v[72:75], v245, s[44:47], s90 offen sc1
  v_mfma_f32_32x32x16_bf16 v[224:239], a[4:7], v[16:19], 0
  v_mul_f32 v160, v160, v249
  v_mul_f32 v161, v161, v249
  v_mul_f32 v162, v162, v249
  v_mul_f32 v163, v163, v249
  v_mul_f32 v164, v164, v249
  v_mul_f32 v165, v165, v249
  v_mul_f32 v166, v166, v249
  s_waitcnt vmcnt(15)
  v_mfma_f32_32x32x16_bf16 a[224:239], a[0:3], v[20:23], 0
  buffer_load_dwordx4 v[76:79], v246, s[44:47], s90 offen sc1
  v_mul_f32_e64 v167, v167, v249
  v_exp_f32_e64 v160, -v160
  v_exp_f32_e64 v161, -v161
  v_mfma_f32_32x32x16_bf16 a[240:255], a[4:7], v[20:23], 0
  v_exp_f32_e64 v162, -v162
  v_fma_f32 v160, v160, v250, v250
  v_exp_f32_e64 v163, -v163
  v_fma_f32 v161, v161, v250, v250
  s_barrier
  s_waitcnt vmcnt(15)
  v_mfma_f32_32x32x16_bf16 v[208:223], a[8:11], v[24:27], v[208:223]
  s_mov_b32 s90, 2048
  buffer_load_dwordx4 v[80:83], v245, s[44:47], s90 offen sc1
  v_exp_f32_e64 v164, -v164
  v_fma_f32 v162, v162, v250, v250
  v_exp_f32_e64 v165, -v165
  v_mfma_f32_32x32x16_bf16 v[224:239], a[12:15], v[24:27], v[224:239]
  v_fma_f32 v163, v163, v250, v250
  v_exp_f32_e64 v166, -v166
  v_fma_f32 v164, v164, v250, v250
  v_exp_f32_e64 v167, -v167
  v_fma_f32 v165, v165, v250, v250
  s_waitcnt vmcnt(14)
  v_mfma_f32_32x32x16_bf16 a[224:239], a[8:11], v[28:31], a[224:239]
  buffer_load_dwordx4 v[84:87], v246, s[44:47], s90 offen sc1
  v_fma_f32 v166, v166, v250, v250
  v_fma_f32 v167, v167, v250, v250
  v_rcp_f32 v160, v160
  v_rcp_f32_e64 v161, v161
  v_mfma_f32_32x32x16_bf16 a[240:255], a[12:15], v[28:31], a[240:255]
  v_rcp_f32 v162, v162
  v_mul_f32 v160, v160, v168
  v_rcp_f32_e64 v163, v163
  v_mul_f32 v161, v161, v169
  s_waitcnt vmcnt(14)
  v_mfma_f32_32x32x16_bf16 v[208:223], a[16:19], v[32:35], v[208:223]
  s_mov_b32 s90, 9216
  buffer_load_dwordx4 v[88:91], v245, s[44:47], s90 offen sc1
  v_rcp_f32 v164, v164
  v_mul_f32 v162, v162, v170
  v_rcp_f32_e64 v165, v165
  v_mfma_f32_32x32x16_bf16 v[224:239], a[20:23], v[32:35], v[224:239]
  v_mul_f32 v163, v163, v171
  v_rcp_f32 v166, v166
  v_mul_f32 v164, v164, v172
  v_rcp_f32 v167, v167
  v_mul_f32 v165, v165, v173
  s_waitcnt vmcnt(14)
  v_mfma_f32_32x32x16_bf16 a[224:239], a[16:19], v[36:39], a[224:239]
  buffer_load_dwordx4 v[92:95], v246, s[44:47], s90 offen sc1
  v_mul_f32 v166, v166, v174
  v_mul_f32 v167, v167, v175
  v_cvt_pk_bf16_f32 v168, v160, v161
  v_cvt_pk_bf16_f32 v169, v162, v163
  v_cvt_pk_bf16_f32 v170, v164, v165
  v_cvt_pk_bf16_f32 v171, v166, v167
  v_mfma_f32_32x32x16_bf16 a[240:255], a[20:23], v[36:39], a[240:255]
  buffer_store_dwordx4 v[168:171], v1, s[44:47], s74 offen offset:2048 sc1
  s_waitcnt vmcnt(15)
  v_mfma_f32_32x32x16_bf16 v[208:223], a[24:27], v[40:43], v[208:223]
  s_mov_b32 s90, 16384
  buffer_load_dwordx4 v[96:99], v245, s[44:47], s90 offen sc1
  v_mfma_f32_32x32x16_bf16 v[224:239], a[28:31], v[40:43], v[224:239]
  s_waitcnt vmcnt(14)
  v_mov_b32 v254, 1
  s_mov_b64 exec, 1
  buffer_store_dword v254, off, s[40:43], s94 offset:128
  s_mov_b64 exec, -1
  v_mfma_f32_32x32x16_bf16 a[224:239], a[24:27], v[44:47], a[224:239]
  buffer_load_dwordx4 v[100:103], v246, s[44:47], s90 offen sc1
  v_mfma_f32_32x32x16_bf16 a[240:255], a[28:31], v[44:47], a[240:255]
  s_waitcnt vmcnt(15)
  v_mfma_f32_32x32x16_bf16 v[208:223], a[32:35], v[48:51], v[208:223]
  s_mov_b32 s90, 23552
  buffer_load_dwordx4 v[104:107], v245, s[44:47], s90 offen sc1
  v_mfma_f32_32x32x16_bf16 v[224:239], a[36:39], v[48:51], v[224:239]
  s_waitcnt vmcnt(15)
  v_mfma_f32_32x32x16_bf16 a[224:239], a[32:35], v[52:55], a[224:239]
  buffer_load_dwordx4 v[108:111], v246, s[44:47], s90 offen sc1
  v_mfma_f32_32x32x16_bf16 a[240:255], a[36:39], v[52:55], a[240:255]
  s_waitcnt vmcnt(15)
  v_mfma_f32_32x32x16_bf16 v[208:223], a[40:43], v[56:59], v[208:223]
  s_mov_b32 s90, 3072
  buffer_load_dwordx4 v[112:115], v245, s[44:47], s90 offen sc1
  v_mfma_f32_32x32x16_bf16 v[224:239], a[44:47], v[56:59], v[224:239]
  s_waitcnt vmcnt(15)
  v_mfma_f32_32x32x16_bf16 a[224:239], a[40:43], v[60:63], a[224:239]
  buffer_load_dwordx4 v[116:119], v246, s[44:47], s90 offen sc1
  v_mfma_f32_32x32x16_bf16 a[240:255], a[44:47], v[60:63], a[240:255]
  s_waitcnt vmcnt(15)
  v_mfma_f32_32x32x16_bf16 v[208:223], a[48:51], v[64:67], v[208:223]
  s_mov_b32 s90, 10240
  buffer_load_dwordx4 v[120:123], v245, s[44:47], s90 offen sc1
  v_mfma_f32_32x32x16_bf16 v[224:239], a[52:55], v[64:67], v[224:239]
  s_waitcnt vmcnt(15)
  v_mfma_f32_32x32x16_bf16 a[224:239], a[48:51], v[68:71], a[224:239]
  buffer_load_dwordx4 v[124:127], v246, s[44:47], s90 offen sc1
  v_mfma_f32_32x32x16_bf16 a[240:255], a[52:55], v[68:71], a[240:255]
  s_waitcnt vmcnt(15)
  v_mfma_f32_32x32x16_bf16 v[208:223], a[56:59], v[72:75], v[208:223]
  s_buffer_load_dwordx4 s[76:79], s[40:43], s85 offset:256
  s_buffer_load_dwordx4 s[80:83], s[40:43], s85 offset:768
  s_mov_b32 s90, 17408
  buffer_load_dwordx4 v[16:19], v245, s[44:47], s90 offen sc1
  v_mfma_f32_32x32x16_bf16 v[224:239], a[60:63], v[72:75], v[224:239]
  s_waitcnt vmcnt(15)
  v_mfma_f32_32x32x16_bf16 a[224:239], a[56:59], v[76:79], a[224:239]
  buffer_load_dwordx4 v[20:23], v246, s[44:47], s90 offen sc1
  v_mfma_f32_32x32x16_bf16 a[240:255], a[60:63], v[76:79], a[240:255]
  s_waitcnt vmcnt(15)
  v_mfma_f32_32x32x16_bf16 v[208:223], a[64:67], v[80:83], v[208:223]
  s_mov_b32 s90, 24576
  buffer_load_dwordx4 v[24:27], v245, s[44:47], s90 offen sc1
  v_mfma_f32_32x32x16_bf16 v[224:239], a[68:71], v[80:83], v[224:239]
  s_waitcnt vmcnt(12)
  v_mov_b32_e64 v254, 1
  s_mov_b64 exec, 1
  buffer_store_dword v254, off, s[40:43], s94 offset:192
  s_mov_b64 exec, -1
  s_xor_b32 s86, s48, 1
  s_mul_i32 s86, s86, 12288
  v_mfma_f32_32x32x16_bf16 a[224:239], a[64:67], v[84:87], a[224:239]
  buffer_load_dwordx4 v[28:31], v246, s[44:47], s90 offen sc1
  s_add_u32 s86, s86, 106496
  v_add_u32 v129, s86, v1
  s_xor_b32 s86, s48, 2
  s_mul_i32 s86, s86, 12288
  s_add_u32 s86, s86, 110592
  v_add_u32_e64 v130, s86, v1
  v_mfma_f32_32x32x16_bf16 a[240:255], a[68:71], v[84:87], a[240:255]
  s_xor_b32 s86, s48, 3
  s_mul_i32 s86, s86, 12288
  s_add_u32 s86, s86, 114688
  v_add_u32 v131, s86, v1
  s_mul_i32 s86, s48, 12288
  s_add_u32 s86, s86, 106496
  v_add_u32_e64 v128, s86, v1
  v_mfma_f32_32x32x16_bf16 v[208:223], a[72:75], v[88:91], v[208:223]
  s_waitcnt lgkmcnt(0)
  s_and_b64 s[76:77], s[76:77], s[78:79]
  s_and_b64 s[80:81], s[80:81], s[82:83]
  s_and_b64 s[76:77], s[76:77], s[80:81]
  s_and_b32 s76, s76, s77
  s_cbranch_scc0 Lc_53
Lr_54:
  s_mov_b32 s90, 4096
  buffer_load_dwordx4 v[32:35], v245, s[44:47], s90 offen sc1
  v_mfma_f32_32x32x16_bf16 v[224:239], a[76:79], v[88:91], v[224:239]
  v_lshlrev_b32_e64 v192, 16, v8
  v_and_b32 v193, 0xffff0000, v8
  v_lshlrev_b32_e64 v194, 16, v9
  v_and_b32 v195, 0xffff0000, v9
  v_lshlrev_b32_e64 v196, 16, v10
  v_and_b32 v197, 0xffff0000, v10
  v_lshlrev_b32_e64 v198, 16, v11
  v_mfma_f32_32x32x16_bf16 a[224:239], a[72:75], v[92:95], a[224:239]
  buffer_load_dwordx4 v[36:39], v246, s[44:47], s90 offen sc1
  v_and_b32 v199, 0xffff0000, v11
  v_lshlrev_b32_e64 v200, 16, v12
  v_and_b32 v201, 0xffff0000, v12
  v_lshlrev_b32_e64 v202, 16, v13
  v_and_b32 v203, 0xffff0000, v13
  v_lshlrev_b32_e64 v204, 16, v14
  v_mfma_f32_32x32x16_bf16 a[240:255], a[76:79], v[92:95], a[240:255]
  v_and_b32 v205, 0xffff0000, v14
  v_lshlrev_b32_e64 v206, 16, v15
  v_and_b32 v207, 0xffff0000, v15
  s_waitcnt vmcnt(15)
  v_mfma_f32_32x32x16_bf16 v[208:223], a[80:83], v[96:99], v[208:223]
  s_mov_b32 s90, 11264
  buffer_load_dwordx4 v[40:43], v245, s[44:47], s90 offen sc1
  v_mfma_f32_32x32x16_bf16 v[224:239], a[84:87], v[96:99], v[224:239]
  s_waitcnt vmcnt(14)
  v_mfma_f32_32x32x16_bf16 a[224:239], a[80:83], v[100:103], a[224:239]
  buffer_load_dwordx4 v[44:47], v246, s[44:47], s90 offen sc1
  v_mfma_f32_32x32x16_bf16 a[240:255], a[84:87], v[100:103], a[240:255]
  s_buffer_load_dwordx4 s[76:79], s[40:43], s85 offset:128
  s_buffer_load_dwordx4 s[80:83], s[40:43], s85 offset:640
  s_mov_b32 s90, 18432
  buffer_load_dwordx4 v[48:51], v245, s[44:47], s90 offen sc1
  s_waitcnt vmcnt(15)
  v_mfma_f32_32x32x16_bf16 v[208:223], a[88:91], v[104:107], v[208:223]
  buffer_load_dwordx4 v[52:55], v246, s[44:47], s90 offen sc1
  v_mfma_f32_32x32x16_bf16 v[224:239], a[92:95], v[104:107], v[224:239]
  s_waitcnt vmcnt(15)
  v_mfma_f32_32x32x16_bf16 a[224:239], a[88:91], v[108:111], a[224:239]
  s_mov_b32 s90, 25600
  buffer_load_dwordx4 v[56:59], v245, s[44:47], s90 offen sc1
  v_mfma_f32_32x32x16_bf16 a[240:255], a[92:95], v[108:111], a[240:255]
  buffer_load_dwordx4 v[60:63], v246, s[44:47], s90 offen sc1
  s_waitcnt vmcnt(16)
  v_mfma_f32_32x32x16_bf16 v[208:223], a[96:99], v[112:115], v[208:223]
  s_waitcnt lgkmcnt(0)
  s_and_b64 s[76:77], s[76:77], s[78:79]
  s_and_b64 s[80:81], s[80:81], s[82:83]
  s_and_b64 s[76:77], s[76:77], s[80:81]
  s_and_b32 s76, s76, s77
  s_cbranch_scc0 Lc_57
Lr_58:
  s_mov_b32 s90, 5120
  buffer_load_dwordx4 v[64:67], v245, s[44:47], s90 offen sc1
  v_mfma_f32_32x32x16_bf16 v[224:239], a[100:103], v[112:115], v[224:239]
  s_waitcnt vmcnt(16)
  v_mfma_f32_32x32x16_bf16 a[224:239], a[96:99], v[116:119], a[224:239]
  buffer_load_dwordx4 v[68:71], v246, s[44:47], s90 offen sc1
  v_mfma_f32_32x32x16_bf16 a[240:255], a[100:103], v[116:119], a[240:255]
  s_mov_b32 s90, 12288
  buffer_load_dwordx4 v[72:75], v245, s[44:47], s90 offen sc1
  s_waitcnt vmcnt(17)
  v_mfma_f32_32x32x16_bf16 v[208:223], a[104:107], v[120:123], v[208:223]
  buffer_load_dwordx4 v[76:79], v246, s[44:47], s90 offen sc1
  v_mfma_f32_32x32x16_bf16 v[224:239], a[108:111], v[120:123], v[224:239]
  s_waitcnt vmcnt(17)
  v_mfma_f32_32x32x16_bf16 a[224:239], a[104:107], v[124:127], a[224:239]
  s_buffer_load_dwordx4 s[76:79], s[40:43], s85 offset:192
  s_buffer_load_dwordx4 s[80:83], s[40:43], s85 offset:704
  s_mov_b32 s90, 19456
  buffer_load_dwordx4 v[80:83], v245, s[44:47], s90 offen sc1
  v_mfma_f32_32x32x16_bf16 a[240:255], a[108:111], v[124:127], a[240:255]
  buffer_load_dwordx4 v[84:87], v246, s[44:47], s90 offen sc1
  s_waitcnt vmcnt(18)
  v_mfma_f32_32x32x16_bf16 v[208:223], a[112:115], v[16:19], v[208:223]
  s_mov_b32 s90, 26624
  buffer_load_dwordx4 v[88:91], v245, s[44:47], s90 offen sc1
  v_mfma_f32_32x32x16_bf16 v[224:239], a[116:119], v[16:19], v[224:239]
  s_waitcnt vmcnt(18)
  v_mfma_f32_32x32x16_bf16 a[224:239], a[112:115], v[20:23], a[224:239]
  buffer_load_dwordx4 v[92:95], v246, s[44:47], s90 offen sc1
  v_mfma_f32_32x32x16_bf16 a[240:255], a[116:119], v[20:23], a[240:255]
  s_waitcnt lgkmcnt(0)
  s_and_b64 s[76:77], s[76:77], s[78:79]
  s_and_b64 s[80:81], s[80:81], s[82:83]
  s_and_b64 s[76:77], s[76:77], s[80:81]
  s_and_b32 s76, s76, s77
  s_cbranch_scc0 Lc_61
Lr_62:
  s_mov_b32 s90, 6144
  buffer_load_dwordx4 v[96:99], v245, s[44:47], s90 offen sc1
  s_waitcnt vmcnt(19)
  v_mfma_f32_32x32x16_bf16 v[208:223], a[120:123], v[24:27], v[208:223]
  buffer_load_dwordx4 v[100:103], v246, s[44:47], s90 offen sc1
  v_mfma_f32_32x32x16_bf16 v[224:239], a[124:127], v[24:27], v[224:239]
  s_waitcnt vmcnt(18)
  v_mfma_f32_32x32x16_bf16 a[224:239], a[120:123], v[28:31], a[224:239]
  s_mov_b32 s90, 13312
  buffer_load_dwordx4 v[104:107], v245, s[44:47], s90 offen sc1
  v_mfma_f32_32x32x16_bf16 a[240:255], a[124:127], v[28:31], a[240:255]
  buffer_load_dwordx4 v[108:111], v246, s[44:47], s90 offen sc1
  s_waitcnt vmcnt(19)
  v_mfma_f32_32x32x16_bf16 v[208:223], a[128:131], v[32:35], v[208:223]
  s_mov_b32 s90, 20480
  buffer_load_dwordx4 v[112:115], v245, s[44:47], s90 offen sc1
  v_mfma_f32_32x32x16_bf16 v[224:239], a[132:135], v[32:35], v[224:239]
  s_waitcnt vmcnt(19)
  v_mfma_f32_32x32x16_bf16 a[224:239], a[128:131], v[36:39], a[224:239]
  buffer_load_dwordx4 v[116:119], v246, s[44:47], s90 offen sc1
  v_mfma_f32_32x32x16_bf16 a[240:255], a[132:135], v[36:39], a[240:255]
  s_waitcnt vmcnt(19)
  v_mfma_f32_32x32x16_bf16 v[208:223], a[136:139], v[40:43], v[208:223]
  s_mov_b32 s90, 27648
  buffer_load_dwordx4 v[120:123], v245, s[44:47], s90 offen sc1
  v_mfma_f32_32x32x16_bf16 v[224:239], a[140:143], v[40:43], v[224:239]
  s_waitcnt vmcnt(19)
  v_mfma_f32_32x32x16_bf16 a[224:239], a[136:139], v[44:47], a[224:239]
  buffer_load_dwordx4 v[124:127], v246, s[44:47], s90 offen sc1
  v_mfma_f32_32x32x16_bf16 a[240:255], a[140:143], v[44:47], a[240:255]
  s_waitcnt vmcnt(19)
  v_mfma_f32_32x32x16_bf16 v[208:223], a[144:147], v[48:51], v[208:223]
  v_mfma_f32_32x32x16_bf16 v[224:239], a[148:151], v[48:51], v[224:239]
  s_waitcnt vmcnt(18)
  v_mfma_f32_32x32x16_bf16 a[224:239], a[144:147], v[52:55], a[224:239]
  v_mfma_f32_32x32x16_bf16 a[240:255], a[148:151], v[52:55], a[240:255]
  s_waitcnt vmcnt(17)
  v_mfma_f32_32x32x16_bf16 v[208:223], a[152:155], v[56:59], v[208:223]
  v_mfma_f32_32x32x16_bf16 v[224:239], a[156:159], v[56:59], v[224:239]
  s_waitcnt vmcnt(16)
  v_mfma_f32_32x32x16_bf16 a[224:239], a[152:155], v[60:63], a[224:239]
  v_mfma_f32_32x32x16_bf16 a[240:255], a[156:159], v[60:63], a[240:255]
  s_waitcnt vmcnt(14)
  v_mfma_f32_32x32x16_bf16 a[240:255], a[164:167], v[68:71], a[240:255]
  s_waitcnt vmcnt(12)
  v_mfma_f32_32x32x16_bf16 a[240:255], a[172:175], v[76:79], a[240:255]
  s_waitcnt vmcnt(10)
  v_mfma_f32_32x32x16_bf16 a[240:255], a[180:183], v[84:87], a[240:255]
  s_waitcnt vmcnt(8)
  v_mfma_f32_32x32x16_bf16 a[240:255], a[188:191], v[92:95], a[240:255]
  s_waitcnt vmcnt(6)
  v_mfma_f32_32x32x16_bf16 a[240:255], a[196:199], v[100:103], a[240:255]
  s_waitcnt vmcnt(4)
  v_mfma_f32_32x32x16_bf16 a[240:255], a[204:207], v[108:111], a[240:255]
  s_waitcnt vmcnt(2)
  v_mfma_f32_32x32x16_bf16 a[240:255], a[212:215], v[116:119], a[240:255]
  s_waitcnt vmcnt(0)
  v_mfma_f32_32x32x16_bf16 a[240:255], a[220:223], v[124:127], a[240:255]
  v_mfma_f32_32x32x16_bf16 a[224:239], a[160:163], v[68:71], a[224:239]
  v_mfma_f32_32x32x16_bf16 a[224:239], a[168:171], v[76:79], a[224:239]
  ds_write_b128 v131, a[240:243] offset:0
  v_mfma_f32_32x32x16_bf16 a[224:239], a[176:179], v[84:87], a[224:239]
  v_mfma_f32_32x32x16_bf16 a[224:239], a[184:187], v[92:95], a[224:239]
  ds_write_b128 v131, a[244:247] offset:1024
  v_mfma_f32_32x32x16_bf16 a[224:239], a[192:195], v[100:103], a[224:239]
  v_mfma_f32_32x32x16_bf16 a[224:239], a[200:203], v[108:111], a[224:239]
  ds_write_b128 v131, a[248:251] offset:2048
  v_mfma_f32_32x32x16_bf16 a[224:239], a[208:211], v[116:119], a[224:239]
  v_mfma_f32_32x32x16_bf16 a[224:239], a[216:219], v[124:127], a[224:239]
  ds_write_b128 v131, a[252:255] offset:3072
  v_mfma_f32_32x32x16_bf16 v[224:239], a[164:167], v[64:67], v[224:239]
  v_mfma_f32_32x32x16_bf16 v[224:239], a[172:175], v[72:75], v[224:239]
  ds_write_b128 v130, a[224:227] offset:0
  v_mfma_f32_32x32x16_bf16 v[224:239], a[180:183], v[80:83], v[224:239]
  v_mfma_f32_32x32x16_bf16 v[224:239], a[188:191], v[88:91], v[224:239]
  ds_write_b128 v130, a[228:231] offset:1024
  v_mfma_f32_32x32x16_bf16 v[224:239], a[196:199], v[96:99], v[224:239]
  v_mfma_f32_32x32x16_bf16 v[224:239], a[204:207], v[104:107], v[224:239]
  ds_write_b128 v130, a[232:235] offset:2048
  v_mfma_f32_32x32x16_bf16 v[224:239], a[212:215], v[112:115], v[224:239]
  v_mfma_f32_32x32x16_bf16 v[224:239], a[220:223], v[120:123], v[224:239]
  ds_write_b128 v130, a[236:239] offset:3072
  v_mfma_f32_32x32x16_bf16 v[208:223], a[160:163], v[64:67], v[208:223]
  v_mfma_f32_32x32x16_bf16 v[208:223], a[168:171], v[72:75], v[208:223]
  ds_write_b128 v129, v[224:227] offset:0
  v_mfma_f32_32x32x16_bf16 v[208:223], a[176:179], v[80:83], v[208:223]
  v_mfma_f32_32x32x16_bf16 v[208:223], a[184:187], v[88:91], v[208:223]
  ds_write_b128 v129, v[228:231] offset:1024
  v_mfma_f32_32x32x16_bf16 v[208:223], a[192:195], v[96:99], v[208:223]
  v_mfma_f32_32x32x16_bf16 v[208:223], a[200:203], v[104:107], v[208:223]
  ds_write_b128 v129, v[232:235] offset:2048
  v_mfma_f32_32x32x16_bf16 v[208:223], a[208:211], v[112:115], v[208:223]
  v_mfma_f32_32x32x16_bf16 v[208:223], a[216:219], v[120:123], v[208:223]
  ds_write_b128 v129, v[236:239] offset:3072
  s_waitcnt lgkmcnt(0)
  s_barrier
  ds_read_b128 v[16:19], v128 offset:0
  ds_read_b128 v[20:23], v128 offset:1024
  ds_read_b128 v[24:27], v128 offset:2048
  ds_read_b128 v[28:31], v128 offset:3072
  ds_read_b128 v[32:35], v128 offset:4096
  ds_read_b128 v[36:39], v128 offset:5120
  ds_read_b128 v[40:43], v128 offset:6144
  ds_read_b128 v[44:47], v128 offset:7168
  ds_read_b128 v[48:51], v128 offset:8192
  ds_read_b128 v[52:55], v128 offset:9216
  ds_read_b128 v[56:59], v128 offset:10240
  ds_read_b128 v[60:63], v128 offset:11264
  v_pk_add_f32 v[208:209], v[208:209], v[192:193]
  v_pk_add_f32 v[210:211], v[210:211], v[194:195]
  v_pk_add_f32 v[212:213], v[212:213], v[196:197]
  v_pk_add_f32 v[214:215], v[214:215], v[198:199]
  v_pk_add_f32 v[216:217], v[216:217], v[200:201]
  v_pk_add_f32 v[218:219], v[218:219], v[202:203]
  v_pk_add_f32 v[220:221], v[220:221], v[204:205]
  v_pk_add_f32 v[222:223], v[222:223], v[206:207]
  s_waitcnt lgkmcnt(8)
  v_pk_add_f32 v[208:209], v[208:209], v[16:17]
  v_pk_add_f32 v[210:211], v[210:211], v[18:19]
  v_pk_add_f32 v[212:213], v[212:213], v[20:21]
  v_pk_add_f32 v[214:215], v[214:215], v[22:23]
  v_pk_add_f32 v[216:217], v[216:217], v[24:25]
  v_pk_add_f32 v[218:219], v[218:219], v[26:27]
  v_pk_add_f32 v[220:221], v[220:221], v[28:29]
  v_pk_add_f32 v[222:223], v[222:223], v[30:31]
  s_waitcnt lgkmcnt(4)
  v_pk_add_f32 v[208:209], v[208:209], v[32:33]
  v_pk_add_f32 v[210:211], v[210:211], v[34:35]
  v_pk_add_f32 v[212:213], v[212:213], v[36:37]
  v_pk_add_f32 v[214:215], v[214:215], v[38:39]
  v_pk_add_f32 v[216:217], v[216:217], v[40:41]
  v_pk_add_f32 v[218:219], v[218:219], v[42:43]
  v_pk_add_f32 v[220:221], v[220:221], v[44:45]
  v_pk_add_f32 v[222:223], v[222:223], v[46:47]
  s_waitcnt lgkmcnt(0)
  v_pk_add_f32 v[208:209], v[208:209], v[48:49]
  v_pk_add_f32 v[210:211], v[210:211], v[50:51]
  v_pk_add_f32 v[212:213], v[212:213], v[52:53]
  v_pk_add_f32 v[214:215], v[214:215], v[54:55]
  v_pk_add_f32 v[216:217], v[216:217], v[56:57]
  v_pk_add_f32 v[218:219], v[218:219], v[58:59]
  v_pk_add_f32 v[220:221], v[220:221], v[60:61]
  v_pk_add_f32 v[222:223], v[222:223], v[62:63]
  v_cvt_pk_bf16_f32 v8, v208, v209
  v_cvt_pk_bf16_f32 v9, v210, v211
  v_cvt_pk_bf16_f32 v10, v212, v213
  v_cvt_pk_bf16_f32 v11, v214, v215
  v_cvt_pk_bf16_f32 v12, v216, v217
  v_cvt_pk_bf16_f32 v13, v218, v219
  v_cvt_pk_bf16_f32 v14, v220, v221
  v_cvt_pk_bf16_f32 v15, v222, v223
  v_and_b32 v18, 31, v0
  v_lshrrev_b32_e64 v19, 5, v0
  v_mul_u32_u24 v4, 896, v18
  v_lshl_add_u32 v4, v19, 4, v4
  s_mul_i32 s86, s58, 28672
  s_lshl_b32 s87, s59, 6
  s_add_u32 s86, s86, s87
  buffer_store_dwordx4 v[8:11], v4, s[32:35], s86 offen
  buffer_store_dwordx4 v[12:15], v4, s[32:35], s86 offen offset:32
L_p4skip1:
L_done:
L_end:
  s_endpgm
Lc_1:
  s_nop 7
  s_nop 3
  v_mov_b32 v216, 0
  v_mov_b32 v217, 0
  v_mov_b32 v218, 0
  v_mov_b32_e64 v219, 0
  s_lshl_b32 s86, s2, 11
  s_waitcnt lgkmcnt(0)
  buffer_store_dwordx4 v[216:219], v1, s[4:7], s86 offen sc1
  buffer_store_dwordx4 v[216:219], v1, s[4:7], s86 offen offset:1024 sc1
  s_nop 4
  s_branch Lr_2
Lc_7:
  s_nop 7
  s_nop 3
Lpoll_9:
  s_sleep 1
  buffer_load_dword v254, v1, s[4:7], s74 offen offset:0 sc1
  s_sub_u32 s54, s54, 1
  s_max_i32 s54, s54, 0
  s_cselect_b64 s[92:93], exec, 0
  s_waitcnt vmcnt(0)
  v_cmp_eq_u32 vcc, 0, v254
  s_nop 0
  s_and_b64 exec, s[92:93], vcc
  s_cbranch_scc1 Lpoll_9
  s_mov_b64 exec, -1
  s_nop 4
  s_branch Lr_8
Lc_11:
  s_nop 7
  s_nop 3
  s_add_u32 m0, s65, 0
  s_nop 0
  buffer_load_dwordx4 v4, s[4:7], m0 offen offset:0 sc1 lds
  buffer_load_dwordx4 v4, s[4:7], m0 offen offset:1024 sc1 lds
  s_add_u32 m0, s65, 8192
  s_nop 0
  buffer_load_dwordx4 v4, s[4:7], m0 offen offset:0 sc1 lds
  buffer_load_dwordx4 v4, s[4:7], m0 offen offset:1024 sc1 lds
  s_add_u32 m0, s65, 16384
  s_nop 0
  buffer_load_dwordx4 v4, s[4:7], m0 offen offset:0 sc1 lds
  buffer_load_dwordx4 v4, s[4:7], m0 offen offset:1024 sc1 lds
  s_add_u32 m0, s65, 24576
  s_nop 0
  buffer_load_dwordx4 v4, s[4:7], m0 offen offset:0 sc1 lds
  buffer_load_dwordx4 v4, s[4:7], m0 offen offset:1024 sc1 lds
  s_add_u32 m0, s65, 32768
  s_nop 0
  buffer_load_dwordx4 v4, s[4:7], m0 offen offset:0 sc1 lds
  buffer_load_dwordx4 v4, s[4:7], m0 offen offset:1024 sc1 lds
  s_add_u32 m0, s65, 40960
  s_nop 0
  buffer_load_dwordx4 v4, s[4:7], m0 offen offset:0 sc1 lds
  buffer_load_dwordx4 v4, s[4:7], m0 offen offset:1024 sc1 lds
  s_add_u32 m0, s65, 49152
  s_nop 0
  buffer_load_dwordx4 v4, s[4:7], m0 offen offset:0 sc1 lds
  buffer_load_dwordx4 v4, s[4:7], m0 offen offset:1024 sc1 lds
  v_and_b32 v240, 15, v0
  v_min_u32 v240, 13, v240
  v_lshlrev_b32 v240, 5, v240
  s_lshl_b32 s88, s56, 9
  s_add_u32 s88, s88, 131072
  s_lshl_b32 s89, s56, 12
  s_add_u32 s89, s89, 262144
  s_mul_i32 s90, s56, 28672
  s_add_u32 s90, s90, 3145728
  s_add_u32 s86, s68, 0xe000
  v_add_u32 v229, s86, v1
  s_add_u32 s86, s68, 0xac00
  v_add_u32 v228, s86, v1
  v_add_u32 v243, s67, v1
  s_mul_i32 s73, s56, 114688
  s_mul_i32 s86, s50, 7168
  s_add_u32 s73, s73, s86
  s_add_u32 s73, s73, 7340032
  s_add_u32 s74, s73, 4096
  s_lshl_b32 s94, s56, 9
  s_lshl_b32 s86, s50, 2
  s_add_u32 s94, s94, s86
  s_add_u32 s94, s94, 196608
  s_waitcnt vmcnt(0)
  s_nop 4
  s_branch L_p2skip0
Lc_14:
  s_nop 7
  s_nop 3
Lpoll_16:
  buffer_load_dword v254, v1, s[40:43], s74 offen offset:0 sc1
  s_sub_u32 s54, s54, 1
  s_max_i32 s54, s54, 0
  s_cselect_b64 s[92:93], exec, 0
  s_waitcnt vmcnt(0)
  v_cmp_ne_u32 vcc, 1, v254
  s_nop 0
  s_and_b64 exec, s[92:93], vcc
  s_cbranch_scc1 Lpoll_16
  s_mov_b64 exec, -1
  s_nop 4
  s_branch Lr_15
Lc_20:
  s_nop 7
  s_nop 3
  v_mul_f32 v160, v160, v249
  v_mul_f32 v161, v161, v249
  v_mul_f32 v162, v162, v249
  v_mul_f32 v163, v163, v249
  v_mul_f32 v164, v164, v249
  v_mul_f32 v165, v165, v249
  v_mul_f32 v166, v166, v249
  v_mul_f32 v167, v167, v249
  v_exp_f32_e64 v160, -v160
  v_exp_f32_e64 v161, -v161
  v_exp_f32_e64 v162, -v162
  v_fma_f32 v160, v160, v250, v250
  v_exp_f32_e64 v163, -v163
  v_fma_f32 v161, v161, v250, v250
  v_exp_f32_e64 v164, -v164
  v_fma_f32 v162, v162, v250, v250
  v_exp_f32_e64 v165, -v165
  v_fma_f32 v163, v163, v250, v250
  v_exp_f32_e64 v166, -v166
  v_fma_f32 v164, v164, v250, v250
  v_exp_f32_e64 v167, -v167
  v_fma_f32 v165, v165, v250, v250
  v_fma_f32 v166, v166, v250, v250
  v_fma_f32 v167, v167, v250, v250
  v_rcp_f32 v160, v160
  v_rcp_f32 v161, v161
  v_rcp_f32 v162, v162
  v_mul_f32 v160, v160, v168
  v_rcp_f32 v163, v163
  v_mul_f32 v161, v161, v169
  v_rcp_f32 v164, v164
  v_mul_f32 v162, v162, v170
  v_rcp_f32 v165, v165
  v_mul_f32 v163, v163, v171
  v_rcp_f32 v166, v166
  v_mul_f32 v164, v164, v172
  v_rcp_f32 v167, v167
  v_mul_f32 v165, v165, v173
  v_mul_f32 v166, v166, v174
  v_mul_f32 v167, v167, v175
  v_cvt_pk_bf16_f32 v168, v160, v161
  v_cvt_pk_bf16_f32 v169, v162, v163
  v_cvt_pk_bf16_f32 v170, v164, v165
  v_cvt_pk_bf16_f32 v171, v166, v167
  buffer_store_dwordx4 v[168:171], v1, s[44:47], s74 offen offset:2048 sc1
  s_waitcnt vmcnt(7)
  v_mov_b32_e64 v254, 1
  s_mov_b64 exec, 1
  buffer_store_dword v254, off, s[40:43], s94 offset:128
  s_mov_b64 exec, -1
  s_barrier
  s_waitcnt vmcnt(0)
  v_mov_b32_e64 v254, 1
  s_mov_b64 exec, 1
  buffer_store_dword v254, off, s[40:43], s94 offset:192
  s_mov_b64 exec, -1
  s_add_u32 m0, s65, 0
  s_nop 0
  buffer_load_dwordx4 v243, s[4:7], m0 offen offset:0 sc1 lds
  buffer_load_dwordx4 v243, s[4:7], m0 offen offset:1024 sc1 lds
  s_add_u32 m0, s65, 8192
  s_nop 0
  buffer_load_dwordx4 v243, s[4:7], m0 offen offset:0 sc1 lds
  buffer_load_dwordx4 v243, s[4:7], m0 offen offset:1024 sc1 lds
  s_add_u32 m0, s65, 16384
  s_nop 0
  buffer_load_dwordx4 v243, s[4:7], m0 offen offset:0 sc1 lds
  buffer_load_dwordx4 v243, s[4:7], m0 offen offset:1024 sc1 lds
  s_add_u32 m0, s65, 24576
  s_nop 0
  buffer_load_dwordx4 v243, s[4:7], m0 offen offset:0 sc1 lds
  buffer_load_dwordx4 v243, s[4:7], m0 offen offset:1024 sc1 lds
  s_add_u32 m0, s65, 32768
  s_nop 0
  buffer_load_dwordx4 v243, s[4:7], m0 offen offset:0 sc1 lds
  buffer_load_dwordx4 v243, s[4:7], m0 offen offset:1024 sc1 lds
  s_add_u32 m0, s65, 40960
  s_nop 0
  buffer_load_dwordx4 v243, s[4:7], m0 offen offset:0 sc1 lds
  buffer_load_dwordx4 v243, s[4:7], m0 offen offset:1024 sc1 lds
  s_add_u32 m0, s65, 49152
  s_nop 0
  buffer_load_dwordx4 v243, s[4:7], m0 offen offset:0 sc1 lds
  buffer_load_dwordx4 v243, s[4:7], m0 offen offset:1024 sc1 lds
  s_add_u32 m0, s65, 57344
  s_nop 0
  buffer_load_dwordx4 v243, s[4:7], m0 offen offset:0 sc1 lds
  buffer_load_dwordx4 v243, s[4:7], m0 offen offset:1024 sc1 lds
  s_add_u32 m0, s65, 65536
  s_nop 0
  buffer_load_dwordx4 v243, s[4:7], m0 offen offset:0 sc1 lds
  buffer_load_dwordx4 v243, s[4:7], m0 offen offset:1024 sc1 lds
  s_add_u32 m0, s65, 73728
  s_nop 0
  buffer_load_dwordx4 v243, s[4:7], m0 offen offset:0 sc1 lds
  buffer_load_dwordx4 v243, s[4:7], m0 offen offset:1024 sc1 lds
  s_add_u32 m0, s65, 81920
  s_nop 0
  buffer_load_dwordx4 v243, s[4:7], m0 offen offset:0 sc1 lds
  buffer_load_dwordx4 v243, s[4:7], m0 offen offset:1024 sc1 lds
  v_and_b32 v240, 15, v0
  v_min_u32_e64 v240, 13, v240
  v_lshlrev_b32 v240, 5, v240
  s_lshl_b32 s88, s56, 9
  s_add_u32 s88, s88, 16941056
  s_lshl_b32 s89, s56, 12
  s_add_u32 s89, s89, 262144
  s_mul_i32 s90, s56, 28672
  s_add_u32 s90, s90, 3145728
  s_and_b32 s86, s64, 0x400
  v_add_u32 v206, s86, v1
  v_xor_b32 v207, 0x400, v206
  v_and_b32_e64 v210, 27, v0
  v_cmp_eq_u32 vcc, 26, v210
  s_nop 1
  v_cndmask_b32 v210, 0, 1.0, vcc
  v_mov_b32_e64 v211, v210
  s_add_u32 s86, s66, 90112
  v_and_b32_e64 v208, 31, v0
  v_lshl_add_u32 v208, v208, 2, s86
  v_lshrrev_b32_e64 v209, 5, v0
  v_lshl_add_u32 v209, v209, 4, s86
  s_add_u32 s86, s68, 0xfffe6000
  v_add_u32 v204, s86, v1
  s_waitcnt vmcnt(0)
  s_nop 4
  s_branch L_p4skip0
Lc_21:
  s_nop 7
  s_nop 3
  v_mul_f32 v176, v160, v249
  v_mul_f32 v177, v161, v249
  v_mul_f32 v178, v162, v249
  v_mul_f32 v179, v163, v249
  v_mul_f32 v180, v164, v249
  v_mul_f32 v181, v165, v249
  v_mul_f32 v182, v166, v249
  v_mul_f32 v183, v167, v249
  v_exp_f32_e64 v176, -v176
  v_exp_f32_e64 v177, -v177
  v_exp_f32_e64 v178, -v178
  v_fma_f32 v176, v176, v250, v250
  v_exp_f32_e64 v179, -v179
  v_fma_f32 v177, v177, v250, v250
  v_exp_f32_e64 v180, -v180
  v_fma_f32 v178, v178, v250, v250
  v_exp_f32_e64 v181, -v181
  v_fma_f32 v179, v179, v250, v250
  v_exp_f32_e64 v182, -v182
  v_fma_f32 v180, v180, v250, v250
  v_exp_f32_e64 v183, -v183
  v_fma_f32 v181, v181, v250, v250
  v_fma_f32 v182, v182, v250, v250
  v_fma_f32 v183, v183, v250, v250
  v_rcp_f32 v176, v176
  v_rcp_f32 v177, v177
  v_rcp_f32 v178, v178
  v_mul_f32 v176, v176, v168
  v_rcp_f32 v179, v179
  v_mul_f32 v177, v177, v169
  v_rcp_f32 v180, v180
  v_mul_f32 v178, v178, v170
  v_rcp_f32 v181, v181
  v_mul_f32 v179, v179, v171
  v_rcp_f32 v182, v182
  v_mul_f32 v180, v180, v172
  v_rcp_f32 v183, v183
  v_mul_f32 v181, v181, v173
  v_mul_f32 v182, v182, v174
  v_mul_f32 v183, v183, v175
  v_cvt_pk_bf16_f32 v184, v176, v177
  v_cvt_pk_bf16_f32 v185, v178, v179
  v_cvt_pk_bf16_f32 v186, v180, v181
  v_cvt_pk_bf16_f32 v187, v182, v183
  buffer_store_dwordx4 v[184:187], v1, s[44:47], s74 offen offset:2048 sc1
  s_waitcnt vmcnt(0)
  v_mov_b32_e64 v254, 1
  s_mov_b64 exec, 1
  buffer_store_dword v254, off, s[40:43], s94 offset:128
  s_mov_b64 exec, -1
  v_mov_b32_e64 v254, 1
  s_mov_b64 exec, 1
  buffer_store_dword v254, off, s[40:43], s94 offset:192
  s_mov_b64 exec, -1
Lpoll_23:
  buffer_load_dword v254, v244, s[40:43], 0 offen offset:64 sc1
  s_sub_u32 s54, s54, 1
  s_max_i32 s54, s54, 0
  s_cselect_b64 s[92:93], exec, 0
  s_waitcnt vmcnt(0)
  v_cmp_ne_u32 vcc, 1, v254
  s_nop 0
  s_and_b64 exec, s[92:93], vcc
  s_cbranch_scc1 Lpoll_23
  s_mov_b64 exec, -1
  s_mov_b32 s90, 0
  buffer_load_dwordx4 v[16:19], v245, s[44:47], s90 offen sc1
  buffer_load_dwordx4 v[20:23], v246, s[44:47], s90 offen sc1
  s_mov_b32 s90, 7168
  buffer_load_dwordx4 v[24:27], v245, s[44:47], s90 offen sc1
  buffer_load_dwordx4 v[28:31], v246, s[44:47], s90 offen sc1
  s_mov_b32 s90, 14336
  buffer_load_dwordx4 v[32:35], v245, s[44:47], s90 offen sc1
  buffer_load_dwordx4 v[36:39], v246, s[44:47], s90 offen sc1
  s_mov_b32 s90, 21504
  buffer_load_dwordx4 v[40:43], v245, s[44:47], s90 offen sc1
  buffer_load_dwordx4 v[44:47], v246, s[44:47], s90 offen sc1
  s_mov_b32 s90, 1024
  buffer_load_dwordx4 v[48:51], v245, s[44:47], s90 offen sc1
  buffer_load_dwordx4 v[52:55], v246, s[44:47], s90 offen sc1
  s_mov_b32 s90, 8192
  buffer_load_dwordx4 v[56:59], v245, s[44:47], s90 offen sc1
  buffer_load_dwordx4 v[60:63], v246, s[44:47], s90 offen sc1
  s_mov_b32 s90, 15360
  buffer_load_dwordx4 v[64:67], v245, s[44:47], s90 offen sc1
  buffer_load_dwordx4 v[68:71], v246, s[44:47], s90 offen sc1
  s_waitcnt vmcnt(0)
  s_nop 4
  s_branch Lr_22
Lc_25:
  s_nop 7
  s_nop 3
  s_waitcnt vmcnt(0)
  v_mov_b32_e64 v254, 1
  s_mov_b64 exec, 1
  buffer_store_dword v254, off, s[40:43], s94 offset:128
  s_mov_b64 exec, -1
  v_mov_b32_e64 v254, 1
  s_mov_b64 exec, 1
  buffer_store_dword v254, off, s[40:43], s94 offset:192
  s_mov_b64 exec, -1
Lpoll_27:
  buffer_load_dword v254, v244, s[40:43], 0 offen offset:256 sc1
  s_sub_u32 s54, s54, 1
  s_max_i32 s54, s54, 0
  s_cselect_b64 s[92:93], exec, 0
  s_waitcnt vmcnt(0)
  v_cmp_ne_u32 vcc, 1, v254
  s_nop 0
  s_and_b64 exec, s[92:93], vcc
  s_cbranch_scc1 Lpoll_27
  s_mov_b64 exec, -1
  s_nop 4
  s_branch Lr_26
Lc_29:
  s_nop 7
  s_nop 3
  s_waitcnt vmcnt(0)
  v_mov_b32_e64 v254, 1
  s_mov_b64 exec, 1
  buffer_store_dword v254, off, s[40:43], s94 offset:128
  s_mov_b64 exec, -1
  v_mov_b32_e64 v254, 1
  s_mov_b64 exec, 1
  buffer_store_dword v254, off, s[40:43], s94 offset:192
  s_mov_b64 exec, -1
Lpoll_31:
  buffer_load_dword v254, v244, s[40:43], 0 offen offset:128 sc1
  s_sub_u32 s54, s54, 1
  s_max_i32 s54, s54, 0
  s_cselect_b64 s[92:93], exec, 0
  s_waitcnt vmcnt(0)
  v_cmp_ne_u32 vcc, 1, v254
  s_nop 0
  s_and_b64 exec, s[92:93], vcc
  s_cbranch_scc1 Lpoll_31
  s_mov_b64 exec, -1
  s_nop 4
  s_branch Lr_30
Lc_33:
  s_nop 7
  s_nop 3
  s_waitcnt vmcnt(0)
  v_mov_b32_e64 v254, 1
  s_mov_b64 exec, 1
  buffer_store_dword v254, off, s[40:43], s94 offset:128
  s_mov_b64 exec, -1
  v_mov_b32_e64 v254, 1
  s_mov_b64 exec, 1
  buffer_store_dword v254, off, s[40:43], s94 offset:192
  s_mov_b64 exec, -1
Lpoll_35:
  buffer_load_dword v254, v244, s[40:43], 0 offen offset:192 sc1
  s_sub_u32 s54, s54, 1
  s_max_i32 s54, s54, 0
  s_cselect_b64 s[92:93], exec, 0
  s_waitcnt vmcnt(0)
  v_cmp_ne_u32 vcc, 1, v254
  s_nop 0
  s_and_b64 exec, s[92:93], vcc
  s_cbranch_scc1 Lpoll_35
  s_mov_b64 exec, -1
  s_nop 4
  s_branch Lr_34
Lc_39:
  s_nop 7
  s_nop 3
  s_add_u32 m0, s65, 0
  s_nop 0
  buffer_load_dwordx4 v4, s[4:7], m0 offen offset:0 sc1 lds
  buffer_load_dwordx4 v4, s[4:7], m0 offen offset:1024 sc1 lds
  s_add_u32 m0, s65, 8192
  s_nop 0
  buffer_load_dwordx4 v4, s[4:7], m0 offen offset:0 sc1 lds
  buffer_load_dwordx4 v4, s[4:7], m0 offen offset:1024 sc1 lds
  s_add_u32 m0, s65, 16384
  s_nop 0
  buffer_load_dwordx4 v4, s[4:7], m0 offen offset:0 sc1 lds
  buffer_load_dwordx4 v4, s[4:7], m0 offen offset:1024 sc1 lds
  s_add_u32 m0, s65, 24576
  s_nop 0
  buffer_load_dwordx4 v4, s[4:7], m0 offen offset:0 sc1 lds
  buffer_load_dwordx4 v4, s[4:7], m0 offen offset:1024 sc1 lds
  s_add_u32 m0, s65, 32768
  s_nop 0
  buffer_load_dwordx4 v4, s[4:7], m0 offen offset:0 sc1 lds
  buffer_load_dwordx4 v4, s[4:7], m0 offen offset:1024 sc1 lds
  s_add_u32 m0, s65, 40960
  s_nop 0
  buffer_load_dwordx4 v4, s[4:7], m0 offen offset:0 sc1 lds
  buffer_load_dwordx4 v4, s[4:7], m0 offen offset:1024 sc1 lds
  s_add_u32 m0, s65, 49152
  s_nop 0
  buffer_load_dwordx4 v4, s[4:7], m0 offen offset:0 sc1 lds
  buffer_load_dwordx4 v4, s[4:7], m0 offen offset:1024 sc1 lds
  v_and_b32 v240, 15, v0
  v_min_u32 v240, 13, v240
  v_lshlrev_b32 v240, 5, v240
  s_lshl_b32 s88, s56, 9
  s_add_u32 s88, s88, 131072
  s_lshl_b32 s89, s56, 12
  s_add_u32 s89, s89, 262144
  s_mul_i32 s90, s56, 28672
  s_add_u32 s90, s90, 3145728
  s_add_u32 s86, s68, 0xe000
  v_add_u32 v229, s86, v1
  s_add_u32 s86, s68, 0xac00
  v_add_u32_e64 v228, s86, v1
  s_mul_i32 s73, s56, 114688
  s_mul_i32 s86, s50, 7168
  s_add_u32 s73, s73, s86
  s_add_u32 s73, s73, 7340032
  s_add_u32 s74, s73, 4096
  s_lshl_b32 s94, s56, 9
  s_lshl_b32 s86, s50, 2
  s_add_u32 s94, s94, s86
  s_add_u32 s94, s94, 196608
  s_waitcnt vmcnt(0)
  s_nop 4
  s_branch L_p2skip1
Lc_42:
  s_nop 7
  s_nop 3
Lpoll_44:
  buffer_load_dword v254, v1, s[40:43], s74 offen offset:0 sc1
  s_sub_u32 s54, s54, 1
  s_max_i32 s54, s54, 0
  s_cselect_b64 s[92:93], exec, 0
  s_waitcnt vmcnt(0)
  v_cmp_ne_u32 vcc, 1, v254
  s_nop 0
  s_and_b64 exec, s[92:93], vcc
  s_cbranch_scc1 Lpoll_44
  s_mov_b64 exec, -1
  s_nop 4
  s_branch Lr_43
Lc_48:
  s_nop 7
  s_nop 3
  v_mul_f32 v160, v160, v249
  v_mul_f32 v161, v161, v249
  v_mul_f32 v162, v162, v249
  v_mul_f32 v163, v163, v249
  v_mul_f32 v164, v164, v249
  v_mul_f32 v165, v165, v249
  v_mul_f32 v166, v166, v249
  v_mul_f32 v167, v167, v249
  v_exp_f32_e64 v160, -v160
  v_exp_f32_e64 v161, -v161
  v_exp_f32_e64 v162, -v162
  v_fma_f32 v160, v160, v250, v250
  v_exp_f32_e64 v163, -v163
  v_fma_f32 v161, v161, v250, v250
  v_exp_f32_e64 v164, -v164
  v_fma_f32 v162, v162, v250, v250
  v_exp_f32_e64 v165, -v165
  v_fma_f32 v163, v163, v250, v250
  v_exp_f32_e64 v166, -v166
  v_fma_f32 v164, v164, v250, v250
  v_exp_f32_e64 v167, -v167
  v_fma_f32 v165, v165, v250, v250
  v_fma_f32 v166, v166, v250, v250
  v_fma_f32 v167, v167, v250, v250
  v_rcp_f32 v160, v160
  v_rcp_f32 v161, v161
  v_rcp_f32 v162, v162
  v_mul_f32 v160, v160, v168
  v_rcp_f32 v163, v163
  v_mul_f32 v161, v161, v169
  v_rcp_f32 v164, v164
  v_mul_f32 v162, v162, v170
  v_rcp_f32 v165, v165
  v_mul_f32 v163, v163, v171
  v_rcp_f32 v166, v166
  v_mul_f32 v164, v164, v172
  v_rcp_f32 v167, v167
  v_mul_f32 v165, v165, v173
  v_mul_f32 v166, v166, v174
  v_mul_f32 v167, v167, v175
  v_cvt_pk_bf16_f32 v168, v160, v161
  v_cvt_pk_bf16_f32 v169, v162, v163
  v_cvt_pk_bf16_f32 v170, v164, v165
  v_cvt_pk_bf16_f32 v171, v166, v167
  buffer_store_dwordx4 v[168:171], v1, s[44:47], s74 offen offset:2048 sc1
  s_waitcnt vmcnt(7)
  v_mov_b32_e64 v254, 1
  s_mov_b64 exec, 1
  buffer_store_dword v254, off, s[40:43], s94 offset:128
  s_mov_b64 exec, -1
  s_barrier
  s_waitcnt vmcnt(0)
  v_mov_b32_e64 v254, 1
  s_mov_b64 exec, 1
  buffer_store_dword v254, off, s[40:43], s94 offset:192
  s_mov_b64 exec, -1
  s_waitcnt vmcnt(0)
  s_nop 4
  s_branch L_p4skip1
Lc_49:
  s_nop 7
  s_nop 3
  v_mul_f32 v176, v160, v249
  v_mul_f32 v177, v161, v249
  v_mul_f32 v178, v162, v249
  v_mul_f32 v179, v163, v249
  v_mul_f32 v180, v164, v249
  v_mul_f32 v181, v165, v249
  v_mul_f32 v182, v166, v249
  v_mul_f32 v183, v167, v249
  v_exp_f32_e64 v176, -v176
  v_exp_f32_e64 v177, -v177
  v_exp_f32_e64 v178, -v178
  v_fma_f32 v176, v176, v250, v250
  v_exp_f32_e64 v179, -v179
  v_fma_f32 v177, v177, v250, v250
  v_exp_f32_e64 v180, -v180
  v_fma_f32 v178, v178, v250, v250
  v_exp_f32_e64 v181, -v181
  v_fma_f32 v179, v179, v250, v250
  v_exp_f32_e64 v182, -v182
  v_fma_f32 v180, v180, v250, v250
  v_exp_f32_e64 v183, -v183
  v_fma_f32 v181, v181, v250, v250
  v_fma_f32 v182, v182, v250, v250
  v_fma_f32 v183, v183, v250, v250
  v_rcp_f32 v176, v176
  v_rcp_f32 v177, v177
  v_rcp_f32 v178, v178
  v_mul_f32 v176, v176, v168
  v_rcp_f32 v179, v179
  v_mul_f32 v177, v177, v169
  v_rcp_f32 v180, v180
  v_mul_f32 v178, v178, v170
  v_rcp_f32 v181, v181
  v_mul_f32 v179, v179, v171
  v_rcp_f32 v182, v182
  v_mul_f32 v180, v180, v172
  v_rcp_f32 v183, v183
  v_mul_f32 v181, v181, v173
  v_mul_f32 v182, v182, v174
  v_mul_f32 v183, v183, v175
  v_cvt_pk_bf16_f32 v184, v176, v177
  v_cvt_pk_bf16_f32 v185, v178, v179
  v_cvt_pk_bf16_f32 v186, v180, v181
  v_cvt_pk_bf16_f32 v187, v182, v183
  buffer_store_dwordx4 v[184:187], v1, s[44:47], s74 offen offset:2048 sc1
  s_waitcnt vmcnt(0)
  v_mov_b32_e64 v254, 1
  s_mov_b64 exec, 1
  buffer_store_dword v254, off, s[40:43], s94 offset:128
  s_mov_b64 exec, -1
  v_mov_b32_e64 v254, 1
  s_mov_b64 exec, 1
  buffer_store_dword v254, off, s[40:43], s94 offset:192
  s_mov_b64 exec, -1
Lpoll_51:
  buffer_load_dword v254, v244, s[40:43], 0 offen offset:64 sc1
  s_sub_u32 s54, s54, 1
  s_max_i32 s54, s54, 0
  s_cselect_b64 s[92:93], exec, 0
  s_waitcnt vmcnt(0)
  v_cmp_ne_u32 vcc, 1, v254
  s_nop 0
  s_and_b64 exec, s[92:93], vcc
  s_cbranch_scc1 Lpoll_51
  s_mov_b64 exec, -1
  s_mov_b32 s90, 0
  buffer_load_dwordx4 v[16:19], v245, s[44:47], s90 offen sc1
  buffer_load_dwordx4 v[20:23], v246, s[44:47], s90 offen sc1
  s_mov_b32 s90, 7168
  buffer_load_dwordx4 v[24:27], v245, s[44:47], s90 offen sc1
  buffer_load_dwordx4 v[28:31], v246, s[44:47], s90 offen sc1
  s_mov_b32 s90, 14336
  buffer_load_dwordx4 v[32:35], v245, s[44:47], s90 offen sc1
  buffer_load_dwordx4 v[36:39], v246, s[44:47], s90 offen sc1
  s_mov_b32 s90, 21504
  buffer_load_dwordx4 v[40:43], v245, s[44:47], s90 offen sc1
  buffer_load_dwordx4 v[44:47], v246, s[44:47], s90 offen sc1
  s_mov_b32 s90, 1024
  buffer_load_dwordx4 v[48:51], v245, s[44:47], s90 offen sc1
  buffer_load_dwordx4 v[52:55], v246, s[44:47], s90 offen sc1
  s_mov_b32 s90, 8192
  buffer_load_dwordx4 v[56:59], v245, s[44:47], s90 offen sc1
  buffer_load_dwordx4 v[60:63], v246, s[44:47], s90 offen sc1
  s_mov_b32 s90, 15360
  buffer_load_dwordx4 v[64:67], v245, s[44:47], s90 offen sc1
  buffer_load_dwordx4 v[68:71], v246, s[44:47], s90 offen sc1
  s_waitcnt vmcnt(0)
  s_nop 4
  s_branch Lr_50
Lc_53:
  s_nop 7
  s_nop 3
  s_waitcnt vmcnt(0)
  v_mov_b32_e64 v254, 1
  s_mov_b64 exec, 1
  buffer_store_dword v254, off, s[40:43], s94 offset:128
  s_mov_b64 exec, -1
  v_mov_b32_e64 v254, 1
  s_mov_b64 exec, 1
  buffer_store_dword v254, off, s[40:43], s94 offset:192
  s_mov_b64 exec, -1
Lpoll_55:
  buffer_load_dword v254, v244, s[40:43], 0 offen offset:256 sc1
  s_sub_u32 s54, s54, 1
  s_max_i32 s54, s54, 0
  s_cselect_b64 s[92:93], exec, 0
  s_waitcnt vmcnt(0)
  v_cmp_ne_u32 vcc, 1, v254
  s_nop 0
  s_and_b64 exec, s[92:93], vcc
  s_cbranch_scc1 Lpoll_55
  s_mov_b64 exec, -1
  s_nop 4
  s_branch Lr_54
Lc_57:
  s_nop 7
  s_nop 3
  s_waitcnt vmcnt(0)
  v_mov_b32_e64 v254, 1
  s_mov_b64 exec, 1
  buffer_store_dword v254, off, s[40:43], s94 offset:128
  s_mov_b64 exec, -1
  v_mov_b32_e64 v254, 1
  s_mov_b64 exec, 1
  buffer_store_dword v254, off, s[40:43], s94 offset:192
  s_mov_b64 exec, -1
Lpoll_59:
  buffer_load_dword v254, v244, s[40:43], 0 offen offset:128 sc1
  s_sub_u32 s54, s54, 1
  s_max_i32 s54, s54, 0
  s_cselect_b64 s[92:93], exec, 0
  s_waitcnt vmcnt(0)
  v_cmp_ne_u32 vcc, 1, v254
  s_nop 0
  s_and_b64 exec, s[92:93], vcc
  s_cbranch_scc1 Lpoll_59
  s_mov_b64 exec, -1
  s_nop 4
  s_branch Lr_58
Lc_61:
  s_nop 7
  s_nop 3
  s_waitcnt vmcnt(0)
  v_mov_b32_e64 v254, 1
  s_mov_b64 exec, 1
  buffer_store_dword v254, off, s[40:43], s94 offset:128
  s_mov_b64 exec, -1
  v_mov_b32_e64 v254, 1
  s_mov_b64 exec, 1
  buffer_store_dword v254, off, s[40:43], s94 offset:192
  s_mov_b64 exec, -1
Lpoll_63:
  buffer_load_dword v254, v244, s[40:43], 0 offen offset:192 sc1
  s_sub_u32 s54, s54, 1
  s_max_i32 s54, s54, 0
  s_cselect_b64 s[92:93], exec, 0
  s_waitcnt vmcnt(0)
  v_cmp_ne_u32 vcc, 1, v254
  s_nop 0
  s_and_b64 exec, s[92:93], vcc
  s_cbranch_scc1 Lpoll_63
  s_mov_b64 exec, -1
  s_nop 4
  s_branch Lr_62
L_codeend:
L_slow:
  s_nop 7
  v_mfma_f32_32x32x16_bf16 v[160:175], v[188:191], v[28:31], v[160:175]
  ds_read_b128 v[180:183], v1 offset:23552
  s_add_u32 s91, s69, 0
  buffer_load_dwordx4 v[16:19], v206, s[4:7], s91 offen offset:0 sc1
  s_lshl_b32 s73, s50, 8
  s_lshl_b32 s87, s71, 4
  s_add_u32 s73, s73, s87
  s_add_u32 s73, s73, 65536
  v_mfma_f32_32x32x16_bf16 v[160:175], v[192:195], v[32:35], v[160:175]
  ds_read_b128 v[184:187], v1 offset:26624
  s_cmp_lg_u32 s48, 3
  s_cselect_b32 s73, 0x40000000, s73
  s_lshl_b32 s86, s56, 15
  s_lshl_b32 s87, s50, 11
  s_add_u32 s86, s86, s87
  s_add_u32 s86, s86, 1048576
  s_lshl_b32 s94, s56, 9
  v_mfma_f32_32x32x16_bf16 v[160:175], v[196:199], v[36:39], v[160:175]
  ds_read_b128 v[188:191], v1 offset:29696
  buffer_load_dwordx4 v[20:23], v207, s[4:7], s91 offen offset:0 sc1
  s_lshl_b32 s87, s50, 5
  s_add_u32 s94, s94, s87
  s_add_u32 s94, s94, 98304
  v_lshlrev_b32 v208, 12, v0
  v_mov_b32 v209, 1
  s_waitcnt lgkmcnt(3)
  v_mfma_f32_32x32x16_bf16 v[160:175], v[176:179], v[40:43], v[160:175]
  ds_read_b128 v[192:195], v1 offset:32768
  v_mov_b32_e64 v251, v249
  v_mov_b32 v135, 0
  s_waitcnt lgkmcnt(3)
  v_mfma_f32_32x32x16_bf16 v[160:175], v[180:183], v[44:47], v[160:175]
  ds_read_b128 v[196:199], v1 offset:35840
  buffer_load_dwordx4 v[24:27], v206, s[4:7], s91 offen offset:2048 sc1
  s_waitcnt lgkmcnt(3)
  v_mfma_f32_32x32x16_bf16 v[160:175], v[184:187], v[48:51], v[160:175]
  ds_read_b128 v[176:179], v1 offset:38912
  s_waitcnt lgkmcnt(3)
  v_mfma_f32_32x32x16_bf16 v[160:175], v[188:191], v[52:55], v[160:175]
  ds_read_b128 v[180:183], v1 offset:41984
  buffer_load_dwordx4 v[28:31], v207, s[4:7], s91 offen offset:2048 sc1
  s_waitcnt lgkmcnt(3)
  v_mfma_f32_32x32x16_bf16 v[160:175], v[192:195], v[56:59], v[160:175]
  ds_read_b128 v[184:187], v1 offset:45056
  s_waitcnt lgkmcnt(3)
  v_mfma_f32_32x32x16_bf16 v[160:175], v[196:199], v[60:63], v[160:175]
  ds_read_b128 v[188:191], v1 offset:48128
  s_add_u32 s91, s69, 4096
  buffer_load_dwordx4 v[32:35], v206, s[4:7], s91 offen offset:0 sc1
  s_waitcnt lgkmcnt(3)
  v_mfma_f32_32x32x16_bf16 v[160:175], v[176:179], v[64:67], v[160:175]
  ds_read_b128 v[192:195], v1 offset:51200
  s_waitcnt lgkmcnt(3)
  v_mfma_f32_32x32x16_bf16 v[160:175], v[180:183], v[68:71], v[160:175]
  ds_read_b128 v[196:199], v1 offset:54272
  buffer_load_dwordx4 v[36:39], v207, s[4:7], s91 offen offset:0 sc1
  s_waitcnt lgkmcnt(3)
  v_mfma_f32_32x32x16_bf16 v[160:175], v[184:187], v[72:75], v[160:175]
  ds_read_b128 v[176:179], v1 offset:57344
  s_waitcnt lgkmcnt(3)
  v_mfma_f32_32x32x16_bf16 v[160:175], v[188:191], v[76:79], v[160:175]
  ds_read_b128 v[180:183], v1 offset:60416
  buffer_load_dwordx4 v[40:43], v206, s[4:7], s91 offen offset:2048 sc1
  s_waitcnt lgkmcnt(3)
  v_mfma_f32_32x32x16_bf16 v[160:175], v[192:195], v[80:83], v[160:175]
  ds_read_b128 v[184:187], v1 offset:63488
  s_waitcnt lgkmcnt(3)
  v_mfma_f32_32x32x16_bf16 v[160:175], v[196:199], v[84:87], v[160:175]
  ds_read_b128 v[188:191], v2 offset:1024
  buffer_load_dwordx4 v[44:47], v207, s[4:7], s91 offen offset:2048 sc1
  s_waitcnt lgkmcnt(3)
  v_mfma_f32_32x32x16_bf16 v[160:175], v[176:179], v[88:91], v[160:175]
  ds_read_b128 v[192:195], v2 offset:4096
  s_waitcnt lgkmcnt(3)
  v_mfma_f32_32x32x16_bf16 v[160:175], v[180:183], v[92:95], v[160:175]
  ds_read_b128 v[196:199], v2 offset:7168
  s_add_u32 s91, s69, 8192
  buffer_load_dwordx4 v[48:51], v206, s[4:7], s91 offen offset:0 sc1
  s_waitcnt lgkmcnt(3)
  v_mfma_f32_32x32x16_bf16 v[160:175], v[184:187], v[96:99], v[160:175]
  ds_read_b128 v[176:179], v2 offset:10240
  s_waitcnt lgkmcnt(3)
  v_mfma_f32_32x32x16_bf16 v[160:175], v[188:191], v[100:103], v[160:175]
  ds_read_b128 v[180:183], v2 offset:13312
  buffer_load_dwordx4 v[52:55], v207, s[4:7], s91 offen offset:0 sc1
  s_waitcnt lgkmcnt(3)
  v_mfma_f32_32x32x16_bf16 v[160:175], v[192:195], v[104:107], v[160:175]
  ds_read_b128 v[184:187], v2 offset:16384
  s_waitcnt vmcnt(10)
  s_barrier
  s_mov_b64 exec, 15
  buffer_store_dword v209, v208, s[40:43], s73 offen sc1
  s_mov_b64 exec, -1
  s_waitcnt lgkmcnt(3)
  v_mfma_f32_32x32x16_bf16 v[160:175], v[196:199], v[108:111], v[160:175]
  ds_read_b128 v[188:191], v2 offset:19456
  buffer_load_dwordx4 v[56:59], v206, s[4:7], s91 offen offset:2048 sc1
  s_waitcnt lgkmcnt(3)
  v_mfma_f32_32x32x16_bf16 v[160:175], v[176:179], v[112:115], v[160:175]
  v_add_u32 v252, 0x15800, v5
  ds_read2_b32 v[192:193], v252 offset0:0 offset1:32
  ds_read2_b32 v[194:195], v252 offset0:64 offset1:96
  s_waitcnt lgkmcnt(4)
  v_mfma_f32_32x32x16_bf16 v[160:175], v[180:183], v[116:119], v[160:175]
  buffer_load_dwordx4 v[60:63], v207, s[4:7], s91 offen offset:2048 sc1
  s_waitcnt lgkmcnt(3)
  v_mfma_f32_32x32x16_bf16 v[160:175], v[184:187], v[120:123], v[160:175]
  s_waitcnt lgkmcnt(2)
  v_mfma_f32_32x32x16_bf16 v[160:175], v[188:191], v[124:127], v[160:175]
  s_add_u32 s91, s69, 12288
  buffer_load_dwordx4 v[64:67], v206, s[4:7], s91 offen offset:0 sc1
  s_waitcnt lgkmcnt(0)
  v_mfma_f32_32x32x16_bf16 v[160:175], v[192:195], v[200:203], v[160:175]
  s_nop 4
  s_nop 6
  v_pk_mul_f32 v[160:161], v[160:161], v[250:251] op_sel:[0,1] op_sel_hi:[1,1]
  v_pk_mul_f32 v[162:163], v[162:163], v[250:251] op_sel:[0,1] op_sel_hi:[1,1]
  v_pk_mul_f32 v[164:165], v[164:165], v[250:251] op_sel:[0,1] op_sel_hi:[1,1]
  v_pk_mul_f32 v[166:167], v[166:167], v[250:251] op_sel:[0,1] op_sel_hi:[1,1]
  v_pk_mul_f32 v[168:169], v[168:169], v[250:251] op_sel:[0,1] op_sel_hi:[1,1]
  v_pk_mul_f32 v[170:171], v[170:171], v[250:251] op_sel:[0,1] op_sel_hi:[1,1]
  v_pk_mul_f32 v[172:173], v[172:173], v[250:251] op_sel:[0,1] op_sel_hi:[1,1]
  v_exp_f32_e64 v216, v160 clamp
  v_max_f32 v160, 0, v160
  v_exp_f32_e64 v217, v161 clamp
  v_max_f32_e64 v161, 0, v161
  v_exp_f32_e64 v218, v162 clamp
  v_max_f32_e64 v162, 0, v162
  v_exp_f32_e64 v219, v163 clamp
  v_max_f32_e64 v163, 0, v163
  v_exp_f32_e64 v220, v164 clamp
  v_max_f32_e64 v164, 0, v164
  v_exp_f32_e64 v221, v165 clamp
  v_max_f32_e64 v165, 0, v165
  v_exp_f32_e64 v222, v166 clamp
  v_max_f32_e64 v166, 0, v166
  v_exp_f32_e64 v223, v167 clamp
  v_max_f32_e64 v167, 0, v167
  v_exp_f32_e64 v224, v168 clamp
  v_max_f32_e64 v168, 0, v168
  v_exp_f32_e64 v225, v169 clamp
  v_max_f32_e64 v169, 0, v169
  v_exp_f32_e64 v226, v170 clamp
  v_max_f32_e64 v170, 0, v170
  v_exp_f32_e64 v227, v171 clamp
  v_max_f32_e64 v171, 0, v171
  v_exp_f32_e64 v228, v172 clamp
  v_max_f32_e64 v172, 0, v172
  v_exp_f32_e64 v229, v173 clamp
  v_max_f32_e64 v173, 0, v173
  v_pk_fma_f32 v[216:217], v[160:161], s[60:61], v[216:217]
  v_pk_fma_f32 v[218:219], v[162:163], s[60:61], v[218:219]
  v_pk_fma_f32 v[220:221], v[164:165], s[60:61], v[220:221]
  v_pk_fma_f32 v[222:223], v[166:167], s[60:61], v[222:223]
  v_pk_fma_f32 v[224:225], v[168:169], s[60:61], v[224:225]
  v_pk_fma_f32 v[226:227], v[170:171], s[60:61], v[226:227]
  v_pk_fma_f32 v[228:229], v[172:173], s[60:61], v[228:229]
  v_pk_add_f32 v[216:217], v[216:217], s[62:63]
  v_pk_add_f32 v[218:219], v[218:219], s[62:63]
  v_pk_add_f32 v[220:221], v[220:221], s[62:63]
  v_pk_add_f32 v[222:223], v[222:223], s[62:63]
  v_pk_add_f32 v[224:225], v[224:225], s[62:63]
  v_pk_add_f32 v[226:227], v[226:227], s[62:63]
  v_pk_add_f32 v[228:229], v[228:229], s[62:63]
  v_cvt_pk_bf16_f32 v128, v216, v217
  v_cvt_pk_bf16_f32 v129, v218, v219
  v_cvt_pk_bf16_f32 v130, v220, v221
  v_cvt_pk_bf16_f32 v131, v222, v223
  v_cvt_pk_bf16_f32 v132, v224, v225
  v_cvt_pk_bf16_f32 v133, v226, v227
  v_cvt_pk_bf16_f32 v134, v228, v229
  buffer_store_dwordx4 v[128:131], v1, s[44:47], s86 offen sc1
  buffer_store_dwordx4 v[132:135], v1, s[44:47], s86 offen offset:1024 sc1
  buffer_load_dwordx4 v[68:71], v207, s[4:7], s91 offen offset:0 sc1
  buffer_load_dwordx4 v[72:75], v206, s[4:7], s91 offen offset:2048 sc1
  buffer_load_dwordx4 v[76:79], v207, s[4:7], s91 offen offset:2048 sc1
  s_add_u32 s75, s70, 0
  buffer_load_dwordx4 a[0:3], v206, s[4:7], s75 offen offset:0 sc1
  s_barrier
  s_waitcnt vmcnt(4)
  v_mov_b32_e64 v254, 1
  s_mov_b64 exec, 1
  buffer_store_dword v254, off, s[40:43], s94 offset:0 sc1
  s_mov_b64 exec, -1
  buffer_load_dwordx4 a[4:7], v207, s[4:7], s75 offen offset:0 sc1
  buffer_load_dwordx4 a[8:11], v206, s[4:7], s75 offen offset:2048 sc1
  buffer_load_dwordx4 a[12:15], v207, s[4:7], s75 offen offset:2048 sc1
  s_add_u32 s75, s70, 4096
  buffer_load_dwordx4 a[16:19], v206, s[4:7], s75 offen offset:0 sc1
  buffer_load_dwordx4 a[20:23], v207, s[4:7], s75 offen offset:0 sc1
  buffer_load_dwordx4 a[24:27], v206, s[4:7], s75 offen offset:2048 sc1
  buffer_load_dwordx4 a[28:31], v207, s[4:7], s75 offen offset:2048 sc1
  s_add_u32 s86, s68, 0xe000
  v_add_u32 v4, s86, v1
  v_and_b32 v240, 3, v0
  v_lshlrev_b32 v240, 5, v240
  v_bfe_u32 v241, v0, 2, 1
  v_lshl_add_u32 v240, v241, 9, v240
  s_lshl_b32 s88, s57, 9
  s_lshl_b32 s86, s48, 7
  s_add_u32 s88, s88, s86
  s_add_u32 s88, s88, 98304
  s_lshl_b32 s90, s58, 15
  s_lshl_b32 s86, s48, 13
  s_add_u32 s90, s90, s86
  s_add_u32 s90, s90, 1048576
  s_xor_b32 s91, s90, 0x8000
  s_add_u32 s74, s72, s64
  s_add_u32 s74, s74, 65536
  s_lshl_b32 s89, s48, 14
L_layer_s:
  s_nop 7
  s_cmp_ge_u32 s49, 28
  s_cbranch_scc1 Lc_65
  v_lshlrev_b32 v208, 16, v8
  v_and_b32 v209, 0xffff0000, v8
  v_lshlrev_b32_e64 v210, 16, v9
  v_and_b32 v211, 0xffff0000, v9
  v_lshlrev_b32_e64 v212, 16, v10
  v_and_b32 v213, 0xffff0000, v10
  v_lshlrev_b32_e64 v214, 16, v11
  v_and_b32 v215, 0xffff0000, v11
  v_lshlrev_b32_e64 v216, 16, v12
  v_and_b32 v217, 0xffff0000, v12
  v_lshlrev_b32_e64 v218, 16, v13
  v_and_b32 v219, 0xffff0000, v13
  v_lshlrev_b32_e64 v220, 16, v14
  v_and_b32 v221, 0xffff0000, v14
  v_lshlrev_b32_e64 v222, 16, v15
  v_and_b32 v223, 0xffff0000, v15
  s_xor_b32 s80, s48, 0
  s_mul_i32 s80, s80, 12288
  s_add_u32 s80, s80, 57344
  s_xor_b32 s81, s48, 1
  s_mul_i32 s81, s81, 12288
  s_add_u32 s81, s81, 57344
  s_xor_b32 s82, s48, 2
  s_mul_i32 s82, s82, 12288
  s_add_u32 s82, s82, 61440
  s_xor_b32 s83, s48, 3
  s_mul_i32 s83, s83, 12288
  s_add_u32 s83, s83, 65536
Lpoll_66:
  buffer_load_dword v254, v240, s[40:43], s88 offen offset:0 sc1
  s_sub_u32 s54, s54, 1
  s_max_i32 s54, s54, 0
  s_cselect_b64 s[92:93], exec, 0
  s_waitcnt vmcnt(0)
  v_cmp_ne_u32 vcc, 1, v254
  s_nop 0
  s_and_b64 exec, s[92:93], vcc
  s_cbranch_scc1 Lpoll_66
  s_mov_b64 exec, -1
  buffer_load_dwordx4 v[88:91], v1, s[44:47], s91 offen offset:0 sc1
  buffer_load_dwordx4 v[92:95], v1, s[44:47], s91 offen offset:1024 sc1
  buffer_load_dwordx4 v[104:107], v1, s[44:47], s91 offen offset:2048 sc1
  buffer_load_dwordx4 v[108:111], v1, s[44:47], s91 offen offset:3072 sc1
  s_add_u32 s91, s91, 4096
  buffer_load_dword v253, v1, s[40:43], s74 offen sc1
  buffer_load_dwordx4 v[120:123], v1, s[44:47], s91 offen offset:0 sc1
  buffer_load_dwordx4 v[124:127], v1, s[44:47], s91 offen offset:1024 sc1
  buffer_load_dwordx4 v[136:139], v1, s[44:47], s91 offen offset:2048 sc1
  buffer_load_dwordx4 v[140:143], v1, s[44:47], s91 offen offset:3072 sc1
  buffer_load_dwordx4 v[80:83], v1, s[44:47], s90 offen offset:0 sc1
  buffer_load_dwordx4 v[84:87], v1, s[44:47], s90 offen offset:1024 sc1
  buffer_load_dwordx4 v[96:99], v1, s[44:47], s90 offen offset:2048 sc1
  buffer_load_dwordx4 v[100:103], v1, s[44:47], s90 offen offset:3072 sc1
  s_add_u32 s90, s90, 4096
  s_waitcnt vmcnt(8)
  v_cmp_ne_u32 vcc, 1, v253
  s_nop 0
  s_cmp_eq_u64 vcc, 0
  s_cbranch_scc0 Lc_68
Lr_69:
  buffer_load_dwordx4 v[144:147], v1, s[40:43], s89 offen offset:0 sc1
  buffer_load_dwordx4 v[148:151], v1, s[40:43], s89 offen offset:1024 sc1
  buffer_load_dwordx4 v[152:155], v1, s[40:43], s89 offen offset:2048 sc1
  buffer_load_dwordx4 v[156:159], v1, s[40:43], s89 offen offset:3072 sc1
  s_add_u32 s89, s89, 4096
  buffer_load_dwordx4 v[160:163], v1, s[40:43], s89 offen offset:0 sc1
  buffer_load_dwordx4 v[164:167], v1, s[40:43], s89 offen offset:1024 sc1
  buffer_load_dwordx4 v[168:171], v1, s[40:43], s89 offen offset:2048 sc1
  buffer_load_dwordx4 v[172:175], v1, s[40:43], s89 offen offset:3072 sc1
  s_add_u32 s89, s89, 4096
  buffer_load_dwordx4 v[176:179], v1, s[40:43], s89 offen offset:0 sc1
  buffer_load_dwordx4 v[180:183], v1, s[40:43], s89 offen offset:1024 sc1
  buffer_load_dwordx4 v[184:187], v1, s[40:43], s89 offen offset:2048 sc1
  buffer_load_dwordx4 v[188:191], v1, s[40:43], s89 offen offset:3072 sc1
  s_add_u32 s89, s89, 4096
  buffer_load_dwordx4 v[192:195], v1, s[40:43], s89 offen offset:0 sc1
  buffer_load_dwordx4 v[196:199], v1, s[40:43], s89 offen offset:1024 sc1
  buffer_load_dwordx4 v[200:203], v1, s[40:43], s89 offen offset:2048 sc1
  buffer_load_dwordx4 v[204:207], v1, s[40:43], s89 offen offset:3072 sc1
  s_add_u32 s89, s89, 4096
  s_waitcnt vmcnt(12)
  v_cvt_pk_bf16_f32 v144, v144, v145
  v_cvt_pk_bf16_f32 v145, v146, v147
  v_cvt_pk_bf16_f32 v146, v148, v149
  v_cvt_pk_bf16_f32 v147, v150, v151
  v_cvt_pk_bf16_f32 v148, v152, v153
  v_cvt_pk_bf16_f32 v149, v154, v155
  v_cvt_pk_bf16_f32 v150, v156, v157
  v_cvt_pk_bf16_f32 v151, v158, v159
  v_mfma_f32_32x32x16_bf16 v[240:255], v[144:147], v[88:91], 0
  s_nop 0
  v_mfma_f32_32x32x16_bf16 v[240:255], v[148:151], v[92:95], v[240:255]
  s_waitcnt vmcnt(8)
  v_cvt_pk_bf16_f32 v152, v160, v161
  v_cvt_pk_bf16_f32 v153, v162, v163
  v_cvt_pk_bf16_f32 v154, v164, v165
  v_cvt_pk_bf16_f32 v155, v166, v167
  v_cvt_pk_bf16_f32 v156, v168, v169
  v_cvt_pk_bf16_f32 v157, v170, v171
  v_cvt_pk_bf16_f32 v158, v172, v173
  v_cvt_pk_bf16_f32 v159, v174, v175
  v_mfma_f32_32x32x16_bf16 v[160:175], v[152:155], v[104:107], 0
  s_nop 1
  v_add_f32 v254, s62, v254
  v_rcp_f32 v254, v254
  s_nop 0
  v_mul_f32 v240, v240, v254
  v_mul_f32_e64 v241, v241, v254
  v_cvt_pk_bf16_f32 v88, v240, v241
  v_mul_f32_e64 v242, v242, v254
  v_mfma_f32_32x32x16_bf16 v[160:175], v[156:159], v[108:111], v[160:175]
  v_mul_f32_e64 v243, v243, v254
  v_cvt_pk_bf16_f32 v89, v242, v243
  v_mul_f32 v244, v244, v254
  v_mul_f32 v245, v245, v254
  v_cvt_pk_bf16_f32 v90, v244, v245
  v_mul_f32 v246, v246, v254
  v_mul_f32 v247, v247, v254
  v_cvt_pk_bf16_f32 v91, v246, v247
  v_mul_f32 v248, v248, v254
  v_mul_f32 v249, v249, v254
  v_cvt_pk_bf16_f32 v92, v248, v249
  v_mul_f32 v250, v250, v254
  v_mul_f32 v251, v251, v254
  v_cvt_pk_bf16_f32 v93, v250, v251
  v_mul_f32 v252, v252, v254
  v_mul_f32 v253, v253, v254
  v_cvt_pk_bf16_f32 v94, v252, v253
  s_waitcnt vmcnt(4)
  v_mfma_f32_32x32x16_bf16 a[224:239], v[16:19], v[88:91], 0
  buffer_load_dwordx4 v[112:115], v1, s[44:47], s90 offen offset:0 sc1
  v_cvt_pk_bf16_f32 v176, v176, v177
  v_cvt_pk_bf16_f32 v177, v178, v179
  v_cvt_pk_bf16_f32 v178, v180, v181
  v_cvt_pk_bf16_f32 v179, v182, v183
  v_cvt_pk_bf16_f32 v180, v184, v185
  v_cvt_pk_bf16_f32 v181, v186, v187
  v_mfma_f32_32x32x16_bf16 a[224:239], v[24:27], v[92:95], a[224:239]
  v_cvt_pk_bf16_f32 v182, v188, v189
  v_cvt_pk_bf16_f32 v183, v190, v191
  v_add_f32 v174, s62, v174
  v_rcp_f32 v174, v174
  s_nop 0
  v_mul_f32 v160, v160, v174
  v_mul_f32 v161, v161, v174
  v_mfma_f32_32x32x16_bf16 v[240:255], v[176:179], v[120:123], 0
  buffer_load_dwordx4 v[116:119], v1, s[44:47], s90 offen offset:1024 sc1
  v_cvt_pk_bf16_f32 v104, v160, v161
  v_mul_f32 v162, v162, v174
  v_mul_f32 v163, v163, v174
  v_cvt_pk_bf16_f32 v105, v162, v163
  v_mul_f32 v164, v164, v174
  v_mul_f32 v165, v165, v174
  v_mfma_f32_32x32x16_bf16 v[240:255], v[180:183], v[124:127], v[240:255]
  v_cvt_pk_bf16_f32 v106, v164, v165
  v_mul_f32 v166, v166, v174
  v_mul_f32 v167, v167, v174
  v_cvt_pk_bf16_f32 v107, v166, v167
  v_mul_f32 v168, v168, v174
  v_mul_f32 v169, v169, v174
  v_cvt_pk_bf16_f32 v108, v168, v169
  v_mfma_f32_32x32x16_bf16 a[240:255], v[20:23], v[88:91], 0
  buffer_load_dwordx4 v[128:131], v1, s[44:47], s90 offen offset:2048 sc1
  v_mul_f32 v170, v170, v174
  v_mul_f32 v171, v171, v174
  v_cvt_pk_bf16_f32 v109, v170, v171
  v_mul_f32 v172, v172, v174
  v_mul_f32 v173, v173, v174
  v_cvt_pk_bf16_f32 v110, v172, v173
  v_mfma_f32_32x32x16_bf16 a[240:255], v[28:31], v[92:95], a[240:255]
  s_waitcnt vmcnt(3)
  v_mfma_f32_32x32x16_bf16 a[224:239], v[32:35], v[104:107], a[224:239]
  buffer_load_dwordx4 v[132:135], v1, s[44:47], s90 offen offset:3072 sc1
  v_cvt_pk_bf16_f32 v192, v192, v193
  v_cvt_pk_bf16_f32 v193, v194, v195
  v_cvt_pk_bf16_f32 v194, v196, v197
  v_cvt_pk_bf16_f32 v195, v198, v199
  v_cvt_pk_bf16_f32 v196, v200, v201
  v_cvt_pk_bf16_f32 v197, v202, v203
  v_mfma_f32_32x32x16_bf16 a[224:239], v[40:43], v[108:111], a[224:239]
  v_cvt_pk_bf16_f32 v198, v204, v205
  v_cvt_pk_bf16_f32 v199, v206, v207
  v_add_f32 v254, s62, v254
  v_rcp_f32 v254, v254
  s_nop 0
  v_mul_f32 v240, v240, v254
  v_mul_f32 v241, v241, v254
  v_mfma_f32_32x32x16_bf16 v[160:175], v[192:195], v[136:139], 0
  s_add_u32 m0, s65, 0
  s_nop 0
  buffer_load_dwordx4 v4, s[4:7], m0 offen offset:0 sc1 lds
  v_cvt_pk_bf16_f32 v120, v240, v241
  v_mul_f32 v242, v242, v254
  v_mul_f32 v243, v243, v254
  v_cvt_pk_bf16_f32 v121, v242, v243
  v_mfma_f32_32x32x16_bf16 v[160:175], v[196:199], v[140:143], v[160:175]
  v_mul_f32 v244, v244, v254
  v_mul_f32 v245, v245, v254
  v_cvt_pk_bf16_f32 v122, v244, v245
  v_mul_f32 v246, v246, v254
  v_mul_f32 v247, v247, v254
  v_cvt_pk_bf16_f32 v123, v246, v247
  v_mul_f32_e64 v248, v248, v254
  v_mfma_f32_32x32x16_bf16 a[240:255], v[36:39], v[104:107], a[240:255]
  buffer_load_dwordx4 v4, s[4:7], m0 offen offset:1024 sc1 lds
  v_mul_f32_e64 v249, v249, v254
  v_cvt_pk_bf16_f32 v124, v248, v249
  v_mul_f32 v250, v250, v254
  v_mul_f32 v251, v251, v254
  v_cvt_pk_bf16_f32 v125, v250, v251
  v_mul_f32_e64 v252, v252, v254
  v_mfma_f32_32x32x16_bf16 a[240:255], v[44:47], v[108:111], a[240:255]
  v_mul_f32_e64 v253, v253, v254
  v_cvt_pk_bf16_f32 v126, v252, v253
  v_mfma_f32_32x32x16_bf16 a[224:239], v[48:51], v[120:123], a[224:239]
  s_add_u32 m0, s65, 8192
  s_nop 0
  buffer_load_dwordx4 v4, s[4:7], m0 offen offset:0 sc1 lds
  v_add_f32 v174, s62, v174
  v_rcp_f32 v174, v174
  s_nop 0
  v_mul_f32_e64 v160, v160, v174
  v_mfma_f32_32x32x16_bf16 a[224:239], v[56:59], v[124:127], a[224:239]
  v_mul_f32_e64 v161, v161, v174
  v_cvt_pk_bf16_f32 v136, v160, v161
  v_mul_f32 v162, v162, v174
  v_mul_f32 v163, v163, v174
  v_cvt_pk_bf16_f32 v137, v162, v163
  v_mul_f32 v164, v164, v174
  v_mul_f32 v165, v165, v174
  v_mfma_f32_32x32x16_bf16 v[240:255], v[144:147], v[80:83], 0
  buffer_load_dwordx4 v4, s[4:7], m0 offen offset:1024 sc1 lds
  v_cvt_pk_bf16_f32 v138, v164, v165
  v_mul_f32 v166, v166, v174
  v_mul_f32 v167, v167, v174
  v_cvt_pk_bf16_f32 v139, v166, v167
  v_mul_f32 v168, v168, v174
  v_mul_f32 v169, v169, v174
  v_mfma_f32_32x32x16_bf16 v[240:255], v[148:151], v[84:87], v[240:255]
  v_cvt_pk_bf16_f32 v140, v168, v169
  v_mul_f32 v170, v170, v174
  v_mul_f32 v171, v171, v174
  v_cvt_pk_bf16_f32 v141, v170, v171
  v_mul_f32 v172, v172, v174
  v_mul_f32 v173, v173, v174
  v_cvt_pk_bf16_f32 v142, v172, v173
  v_mfma_f32_32x32x16_bf16 a[240:255], v[52:55], v[120:123], a[240:255]
  s_add_u32 m0, s65, 16384
  s_nop 0
  buffer_load_dwordx4 v4, s[4:7], m0 offen offset:0 sc1 lds
  v_add_u32 v184, s80, v1
  v_add_u32 v185, s81, v1
  v_add_u32 v186, s82, v1
  v_add_u32_e64 v187, s83, v1
  v_mfma_f32_32x32x16_bf16 a[240:255], v[60:63], v[124:127], a[240:255]
  v_mfma_f32_32x32x16_bf16 a[224:239], v[64:67], v[136:139], a[224:239]
  buffer_load_dwordx4 v4, s[4:7], m0 offen offset:1024 sc1 lds
  v_add_f32 v254, s62, v254
  v_rcp_f32 v254, v254
  s_nop 0
  v_mul_f32 v240, v240, v254
  v_mul_f32_e64 v241, v241, v254
  v_cvt_pk_bf16_f32 v80, v240, v241
  v_mfma_f32_32x32x16_bf16 a[224:239], v[72:75], v[140:143], a[224:239]
  v_mul_f32 v242, v242, v254
  v_mul_f32 v243, v243, v254
  v_cvt_pk_bf16_f32 v81, v242, v243
  v_mul_f32 v244, v244, v254
  v_mul_f32 v245, v245, v254
  v_cvt_pk_bf16_f32 v82, v244, v245
  v_mul_f32_e64 v246, v246, v254
  v_mfma_f32_32x32x16_bf16 v[160:175], v[152:155], v[96:99], 0
  s_add_u32 m0, s65, 24576
  s_nop 0
  buffer_load_dwordx4 v4, s[4:7], m0 offen offset:0 sc1 lds
  v_mul_f32 v247, v247, v254
  v_cvt_pk_bf16_f32 v83, v246, v247
  v_mul_f32 v248, v248, v254
  v_mul_f32 v249, v249, v254
  v_mfma_f32_32x32x16_bf16 v[160:175], v[156:159], v[100:103], v[160:175]
  v_cvt_pk_bf16_f32 v84, v248, v249
  v_mul_f32 v250, v250, v254
  v_mul_f32 v251, v251, v254
  v_cvt_pk_bf16_f32 v85, v250, v251
  v_mul_f32 v252, v252, v254
  v_mul_f32 v253, v253, v254
  v_cvt_pk_bf16_f32 v86, v252, v253
  v_mfma_f32_32x32x16_bf16 a[240:255], v[68:71], v[136:139], a[240:255]
  buffer_load_dwordx4 v4, s[4:7], m0 offen offset:1024 sc1 lds
  v_mfma_f32_32x32x16_bf16 a[240:255], v[76:79], v[140:143], a[240:255]
  v_mfma_f32_32x32x16_bf16 v[224:239], v[20:23], v[80:83], 0
  v_add_f32 v174, s62, v174
  v_rcp_f32 v174, v174
  s_nop 0
  v_mul_f32 v160, v160, v174
  v_mul_f32_e64 v161, v161, v174
  v_cvt_pk_bf16_f32 v96, v160, v161
  v_mul_f32_e64 v162, v162, v174
  v_mfma_f32_32x32x16_bf16 v[224:239], v[28:31], v[84:87], v[224:239]
  ds_write_b128 v186, a[224:227] offset:0
  v_mul_f32_e64 v163, v163, v174
  v_cvt_pk_bf16_f32 v97, v162, v163
  v_mul_f32 v164, v164, v174
  v_mul_f32 v165, v165, v174
  v_cvt_pk_bf16_f32 v98, v164, v165
  v_mul_f32 v166, v166, v174
  s_waitcnt vmcnt(10)
  v_mfma_f32_32x32x16_bf16 v[240:255], v[176:179], v[112:115], 0
  v_mul_f32_e64 v167, v167, v174
  v_cvt_pk_bf16_f32 v99, v166, v167
  v_mul_f32 v168, v168, v174
  v_mul_f32 v169, v169, v174
  v_cvt_pk_bf16_f32 v100, v168, v169
  v_mul_f32 v170, v170, v174
  v_mul_f32 v171, v171, v174
  v_mfma_f32_32x32x16_bf16 v[240:255], v[180:183], v[116:119], v[240:255]
  ds_write_b128 v186, a[228:231] offset:1024
  v_cvt_pk_bf16_f32 v101, v170, v171
  v_mul_f32 v172, v172, v174
  v_mul_f32 v173, v173, v174
  v_cvt_pk_bf16_f32 v102, v172, v173
  v_mfma_f32_32x32x16_bf16 v[224:239], v[36:39], v[96:99], v[224:239]
  s_nop 3
  v_add_f32 v254, s62, v254
  v_rcp_f32 v254, v254
  s_nop 0
  v_mul_f32 v240, v240, v254
  v_mul_f32 v241, v241, v254
  v_cvt_pk_bf16_f32 v112, v240, v241
  v_mul_f32_e64 v242, v242, v254
  v_mfma_f32_32x32x16_bf16 v[224:239], v[44:47], v[100:103], v[224:239]
  ds_write_b128 v186, a[232:235] offset:2048
  v_mul_f32_e64 v243, v243, v254
  v_cvt_pk_bf16_f32 v113, v242, v243
  v_mul_f32 v244, v244, v254
  v_mul_f32 v245, v245, v254
  v_cvt_pk_bf16_f32 v114, v244, v245
  v_mul_f32 v246, v246, v254
  s_waitcnt vmcnt(8)
  v_mfma_f32_32x32x16_bf16 v[160:175], v[192:195], v[128:131], 0
  v_mul_f32_e64 v247, v247, v254
  v_cvt_pk_bf16_f32 v115, v246, v247
  v_mul_f32 v248, v248, v254
  v_mul_f32 v249, v249, v254
  v_cvt_pk_bf16_f32 v116, v248, v249
  v_mul_f32 v250, v250, v254
  v_mul_f32 v251, v251, v254
  v_mfma_f32_32x32x16_bf16 v[160:175], v[196:199], v[132:135], v[160:175]
  ds_write_b128 v186, a[236:239] offset:3072
  v_cvt_pk_bf16_f32 v117, v250, v251
  v_mul_f32 v252, v252, v254
  v_mul_f32 v253, v253, v254
  v_cvt_pk_bf16_f32 v118, v252, v253
  v_mfma_f32_32x32x16_bf16 v[224:239], v[52:55], v[112:115], v[224:239]
  s_nop 3
  v_add_f32 v174, s62, v174
  v_rcp_f32 v174, v174
  s_nop 0
  v_mul_f32 v160, v160, v174
  v_mul_f32 v161, v161, v174
  v_cvt_pk_bf16_f32 v128, v160, v161
  v_mul_f32_e64 v162, v162, v174
  v_mfma_f32_32x32x16_bf16 v[224:239], v[60:63], v[116:119], v[224:239]
  ds_write_b128 v187, a[240:243] offset:0
  v_mul_f32_e64 v163, v163, v174
  v_cvt_pk_bf16_f32 v129, v162, v163
  v_mul_f32 v164, v164, v174
  v_mul_f32 v165, v165, v174
  v_cvt_pk_bf16_f32 v130, v164, v165
  v_mul_f32_e64 v166, v166, v174
  v_mfma_f32_32x32x16_bf16 v[208:223], v[16:19], v[80:83], v[208:223]
  v_mul_f32_e64 v167, v167, v174
  v_cvt_pk_bf16_f32 v131, v166, v167
  v_mul_f32 v168, v168, v174
  v_mul_f32 v169, v169, v174
  v_cvt_pk_bf16_f32 v132, v168, v169
  v_mul_f32 v170, v170, v174
  v_mul_f32 v171, v171, v174
  v_mfma_f32_32x32x16_bf16 v[208:223], v[24:27], v[84:87], v[208:223]
  ds_write_b128 v187, a[244:247] offset:1024
  v_cvt_pk_bf16_f32 v133, v170, v171
  v_mul_f32 v172, v172, v174
  v_mul_f32 v173, v173, v174
  v_cvt_pk_bf16_f32 v134, v172, v173
  v_mfma_f32_32x32x16_bf16 v[224:239], v[68:71], v[128:131], v[224:239]
  s_nop 0
  v_mfma_f32_32x32x16_bf16 v[224:239], v[76:79], v[132:135], v[224:239]
  ds_write_b128 v187, a[248:251] offset:2048
  v_mfma_f32_32x32x16_bf16 v[208:223], v[32:35], v[96:99], v[208:223]
  v_mfma_f32_32x32x16_bf16 v[208:223], v[40:43], v[100:103], v[208:223]
  ds_write_b128 v187, a[252:255] offset:3072
  v_mfma_f32_32x32x16_bf16 v[208:223], v[48:51], v[112:115], v[208:223]
  v_mfma_f32_32x32x16_bf16 v[208:223], v[56:59], v[116:119], v[208:223]
  ds_write_b128 v185, v[224:227] offset:0
  v_mfma_f32_32x32x16_bf16 v[208:223], v[64:67], v[128:131], v[208:223]
  ds_write_b128 v185, v[228:231] offset:1024
  v_mfma_f32_32x32x16_bf16 v[208:223], v[72:75], v[132:135], v[208:223]
  ds_write_b128 v185, v[232:235] offset:2048
  ds_write_b128 v185, v[236:239] offset:3072
  s_add_u32 m0, s65, 32768
  s_nop 0
  buffer_load_dwordx4 v4, s[4:7], m0 offen offset:0 sc1 lds
  buffer_load_dwordx4 v4, s[4:7], m0 offen offset:1024 sc1 lds
  s_add_u32 m0, s65, 40960
  s_nop 0
  buffer_load_dwordx4 v4, s[4:7], m0 offen offset:0 sc1 lds
  buffer_load_dwordx4 v4, s[4:7], m0 offen offset:1024 sc1 lds
  s_add_u32 m0, s65, 49152
  s_nop 0
  buffer_load_dwordx4 v4, s[4:7], m0 offen offset:0 sc1 lds
  buffer_load_dwordx4 v4, s[4:7], m0 offen offset:1024 sc1 lds
  s_waitcnt lgkmcnt(0)
  s_barrier
  ds_read_b128 v[80:83], v184 offset:0
  ds_read_b128 v[84:87], v184 offset:1024
  ds_read_b128 v[88:91], v184 offset:2048
  ds_read_b128 v[92:95], v184 offset:3072
  ds_read_b128 v[96:99], v184 offset:4096
  ds_read_b128 v[100:103], v184 offset:5120
  ds_read_b128 v[104:107], v184 offset:6144
  ds_read_b128 v[108:111], v184 offset:7168
  ds_read_b128 v[112:115], v184 offset:8192
  ds_read_b128 v[116:119], v184 offset:9216
  ds_read_b128 v[120:123], v184 offset:10240
  ds_read_b128 v[124:127], v184 offset:11264
  s_add_u32 s86, s97, 3145728
  s_add_u32 s87, s98, 262144
  s_add_u32 s96, s99, 131072
  v_mov_b32_e64 v160, 0
  v_mov_b32 v161, 0
  s_waitcnt lgkmcnt(8)
  v_pk_add_f32 v[208:209], v[208:209], v[80:81]
  v_pk_add_f32 v[210:211], v[210:211], v[82:83]
  v_pk_add_f32 v[212:213], v[212:213], v[84:85]
  v_pk_add_f32 v[214:215], v[214:215], v[86:87]
  v_pk_add_f32 v[216:217], v[216:217], v[88:89]
  v_pk_add_f32 v[218:219], v[218:219], v[90:91]
  v_pk_add_f32 v[220:221], v[220:221], v[92:93]
  v_pk_add_f32 v[222:223], v[222:223], v[94:95]
  s_waitcnt lgkmcnt(4)
  v_pk_add_f32 v[208:209], v[208:209], v[96:97]
  v_pk_add_f32 v[210:211], v[210:211], v[98:99]
  v_pk_add_f32 v[212:213], v[212:213], v[100:101]
  v_pk_add_f32 v[214:215], v[214:215], v[102:103]
  v_pk_add_f32 v[216:217], v[216:217], v[104:105]
  v_pk_add_f32 v[218:219], v[218:219], v[106:107]
  v_pk_add_f32 v[220:221], v[220:221], v[108:109]
  v_pk_add_f32 v[222:223], v[222:223], v[110:111]
  s_waitcnt lgkmcnt(0)
  v_pk_add_f32 v[208:209], v[208:209], v[112:113]
  v_pk_add_f32 v[210:211], v[210:211], v[114:115]
  v_pk_add_f32 v[212:213], v[212:213], v[116:117]
  v_pk_add_f32 v[214:215], v[214:215], v[118:119]
  v_pk_add_f32 v[216:217], v[216:217], v[120:121]
  v_pk_add_f32 v[218:219], v[218:219], v[122:123]
  v_pk_add_f32 v[220:221], v[220:221], v[124:125]
  v_pk_add_f32 v[222:223], v[222:223], v[126:127]
  v_cvt_pk_bf16_f32 v8, v208, v209
  v_cvt_pk_bf16_f32 v9, v210, v211
  v_cvt_pk_bf16_f32 v10, v212, v213
  v_cvt_pk_bf16_f32 v11, v214, v215
  v_cvt_pk_bf16_f32 v12, v216, v217
  v_cvt_pk_bf16_f32 v13, v218, v219
  v_cvt_pk_bf16_f32 v14, v220, v221
  v_cvt_pk_bf16_f32 v15, v222, v223
  buffer_store_dwordx4 v[8:11], v1, s[44:47], s86 offen sc1
  buffer_store_dwordx4 v[12:15], v1, s[44:47], s86 offen offset:1024 sc1
  v_dot2c_f32_bf16 v160, s84, v8
  v_dot2c_f32_bf16 v161, v8, v8
  v_dot2c_f32_bf16 v160, s84, v9
  v_dot2c_f32_bf16 v161, v9, v9
  v_dot2c_f32_bf16 v160, s84, v10
  v_dot2c_f32_bf16 v161, v10, v10
  v_dot2c_f32_bf16 v160, s84, v11
  v_dot2c_f32_bf16 v161, v11, v11
  v_dot2c_f32_bf16 v160, s84, v12
  v_dot2c_f32_bf16 v161, v12, v12
  v_dot2c_f32_bf16 v160, s84, v13
  v_dot2c_f32_bf16 v161, v13, v13
  v_dot2c_f32_bf16 v160, s84, v14
  v_dot2c_f32_bf16 v161, v14, v14
  v_dot2c_f32_bf16 v160, s84, v15
  v_dot2c_f32_bf16 v161, v15, v15
  s_nop 1
  v_mov_b32 v162, v160
  v_mov_b32 v163, v161
  s_nop 0
  v_permlane32_swap_b32 v160, v162
  v_permlane32_swap_b32 v161, v163
  v_pk_add_f32 v[160:161], v[160:161], v[162:163]
  s_mov_b32 exec_hi, 0
  buffer_store_dwordx2 v[160:161], v1, s[44:47], s87 offen sc1
  s_mov_b64 exec, -1
  v_and_b32 v240, 15, v0
  v_min_u32 v240, 13, v240
  v_lshlrev_b32 v240, 5, v240
  s_lshl_b32 s88, s56, 9
  s_add_u32 s88, s88, 131072
  s_lshl_b32 s89, s56, 12
  s_add_u32 s89, s89, 262144
  s_mul_i32 s90, s56, 28672
  s_add_u32 s90, s90, 3145728
  s_add_u32 s86, s68, 0xe000
  v_add_u32 v229, s86, v1
  s_add_u32 s86, s68, 0xac00
  v_add_u32 v228, s86, v1
  s_cmp_lg_u32 s53, 0
  s_cselect_b32 s86, 0x40000000, s67
  v_add_u32 v243, s86, v1
  s_mul_i32 s73, s56, 114688
  s_mul_i32 s86, s50, 7168
  s_add_u32 s73, s73, s86
  s_add_u32 s73, s73, 7340032
  s_add_u32 s74, s73, 4096
  s_lshl_b32 s94, s56, 9
  s_lshl_b32 s86, s50, 2
  s_add_u32 s94, s94, s86
  s_add_u32 s94, s94, 196608
  s_waitcnt vmcnt(0)
  v_mov_b32_e64 v254, 1
  s_mov_b64 exec, 1
  buffer_store_dword v254, off, s[40:43], s96 offset:0 sc1
  s_mov_b64 exec, -1
L_p2skipNone_s:
  s_waitcnt lgkmcnt(0)
  s_barrier
  ds_read_b128 v[192:195], v2 offset:40960
  ds_read_b128 v[196:199], v2 offset:41984
  ds_read_b128 v[200:203], v2 offset:43008
  ds_read_b128 v[204:207], v2 offset:44032
  ds_read_b128 v[208:211], v2 offset:45056
  ds_read_b128 v[212:215], v2 offset:46080
Lpoll_72:
  buffer_load_dword v254, v240, s[40:43], s88 offen offset:0 sc1
  s_sub_u32 s54, s54, 1
  s_max_i32 s54, s54, 0
  s_cselect_b64 s[92:93], exec, 0
  s_waitcnt vmcnt(0)
  v_cmp_ne_u32 vcc, 1, v254
  s_nop 0
  s_and_b64 exec, s[92:93], vcc
  s_cbranch_scc1 Lpoll_72
  s_mov_b64 exec, -1
  buffer_load_dwordx4 v[16:19], v1, s[44:47], s90 offen offset:0 sc1
  buffer_load_dwordx4 v[20:23], v1, s[44:47], s90 offen offset:1024 sc1
  buffer_load_dwordx4 v[24:27], v1, s[44:47], s90 offen offset:2048 sc1
  buffer_load_dwordx4 v[28:31], v1, s[44:47], s90 offen offset:3072 sc1
  s_add_u32 s90, s90, 4096
  buffer_load_dwordx4 v[32:35], v1, s[44:47], s90 offen offset:0 sc1
  buffer_load_dwordx4 v[36:39], v1, s[44:47], s90 offen offset:1024 sc1
  buffer_load_dwordx4 v[40:43], v1, s[44:47], s90 offen offset:2048 sc1
  buffer_load_dwordx4 v[44:47], v1, s[44:47], s90 offen offset:3072 sc1
  s_waitcnt vmcnt(7) lgkmcnt(4)
  v_mfma_f32_32x32x16_bf16 v[128:143], v[192:195], v[16:19], 0
  ds_read_b128 v[216:219], v2 offset:47104
  s_add_u32 s90, s90, 4096
  buffer_load_dwordx4 v[48:51], v1, s[44:47], s90 offen offset:0 sc1
  v_mfma_f32_32x32x16_bf16 v[144:159], v[196:199], v[16:19], 0
  ds_read_b128 v[220:223], v2 offset:48128
  s_waitcnt vmcnt(7) lgkmcnt(4)
  v_mfma_f32_32x32x16_bf16 v[160:175], v[200:203], v[16:19], 0
  ds_read_b128 v[192:195], v2 offset:49152
  buffer_load_dwordx4 v[176:179], v1, s[44:47], s89 offen offset:0 sc1
  v_mfma_f32_32x32x16_bf16 v[128:143], v[204:207], v[20:23], v[128:143]
  ds_read_b128 v[196:199], v2 offset:50176
  buffer_load_dwordx4 v[52:55], v1, s[44:47], s90 offen offset:1024 sc1
  s_waitcnt lgkmcnt(4)
  v_mfma_f32_32x32x16_bf16 v[144:159], v[208:211], v[20:23], v[144:159]
  ds_read_b128 v[200:203], v2 offset:51200
  v_mfma_f32_32x32x16_bf16 v[160:175], v[212:215], v[20:23], v[160:175]
  ds_read_b128 v[204:207], v2 offset:52224
  s_waitcnt vmcnt(8) lgkmcnt(4)
  v_mfma_f32_32x32x16_bf16 v[128:143], v[216:219], v[24:27], v[128:143]
  ds_read_b128 v[208:211], v2 offset:53248
  buffer_load_dwordx4 v[56:59], v1, s[44:47], s90 offen offset:2048 sc1
  v_mfma_f32_32x32x16_bf16 v[144:159], v[220:223], v[24:27], v[144:159]
  ds_read_b128 v[212:215], v2 offset:54272
  s_waitcnt vmcnt(8) lgkmcnt(4)
  v_mfma_f32_32x32x16_bf16 v[160:175], v[192:195], v[24:27], v[160:175]
  ds_read_b128 v[216:219], v2 offset:55296
  buffer_load_dwordx4 v[180:183], v1, s[44:47], s89 offen offset:1024 sc1
  v_mfma_f32_32x32x16_bf16 v[128:143], v[196:199], v[28:31], v[128:143]
  ds_read_b128 v[220:223], v2 offset:56320
  buffer_load_dwordx4 v[60:63], v1, s[44:47], s90 offen offset:3072 sc1
  s_waitcnt lgkmcnt(4)
  v_mfma_f32_32x32x16_bf16 v[144:159], v[200:203], v[28:31], v[144:159]
  ds_read_b128 v[192:195], v2 offset:57344
  v_mfma_f32_32x32x16_bf16 v[160:175], v[204:207], v[28:31], v[160:175]
  ds_read_b128 v[196:199], v2 offset:58368
  s_waitcnt vmcnt(9) lgkmcnt(4)
  v_mfma_f32_32x32x16_bf16 v[128:143], v[208:211], v[32:35], v[128:143]
  ds_read_b128 v[200:203], v2 offset:59392
  s_add_u32 s90, s90, 4096
  buffer_load_dwordx4 v[64:67], v1, s[44:47], s90 offen offset:0 sc1
  v_mfma_f32_32x32x16_bf16 v[144:159], v[212:215], v[32:35], v[144:159]
  ds_read_b128 v[204:207], v2 offset:60416
  s_waitcnt vmcnt(9) lgkmcnt(4)
  v_mfma_f32_32x32x16_bf16 v[160:175], v[216:219], v[32:35], v[160:175]
  ds_read_b128 v[208:211], v2 offset:61440
  buffer_load_dwordx4 v[184:187], v1, s[44:47], s89 offen offset:2048 sc1
  v_mfma_f32_32x32x16_bf16 v[128:143], v[220:223], v[36:39], v[128:143]
  ds_read_b128 v[212:215], v2 offset:62464
  buffer_load_dwordx4 v[68:71], v1, s[44:47], s90 offen offset:1024 sc1
  s_waitcnt lgkmcnt(4)
  v_mfma_f32_32x32x16_bf16 v[144:159], v[192:195], v[36:39], v[144:159]
  ds_read_b128 v[216:219], v2 offset:63488
  v_mfma_f32_32x32x16_bf16 v[160:175], v[196:199], v[36:39], v[160:175]
  ds_read_b128 v[220:223], v2 offset:64512
  s_waitcnt vmcnt(10) lgkmcnt(4)
  v_mfma_f32_32x32x16_bf16 v[128:143], v[200:203], v[40:43], v[128:143]
  ds_read_b128 v[192:195], v3 offset:0
  buffer_load_dwordx4 v[72:75], v1, s[44:47], s90 offen offset:2048 sc1
  v_mfma_f32_32x32x16_bf16 v[144:159], v[204:207], v[40:43], v[144:159]
  ds_read_b128 v[196:199], v3 offset:1024
  s_waitcnt vmcnt(10) lgkmcnt(4)
  v_mfma_f32_32x32x16_bf16 v[160:175], v[208:211], v[40:43], v[160:175]
  ds_read_b128 v[200:203], v3 offset:2048
  buffer_load_dwordx4 v[188:191], v1, s[44:47], s89 offen offset:3072 sc1
  v_mfma_f32_32x32x16_bf16 v[128:143], v[212:215], v[44:47], v[128:143]
  ds_read_b128 v[204:207], v3 offset:3072
  buffer_load_dwordx4 v[76:79], v1, s[44:47], s90 offen offset:3072 sc1
  s_waitcnt lgkmcnt(4)
  v_mfma_f32_32x32x16_bf16 v[144:159], v[216:219], v[44:47], v[144:159]
  ds_read_b128 v[208:211], v3 offset:4096
  v_mfma_f32_32x32x16_bf16 v[160:175], v[220:223], v[44:47], v[160:175]
  ds_read_b128 v[212:215], v3 offset:5120
  s_waitcnt vmcnt(11) lgkmcnt(4)
  v_mfma_f32_32x32x16_bf16 v[128:143], v[192:195], v[48:51], v[128:143]
  ds_read_b128 v[216:219], v3 offset:6144
  s_add_u32 s90, s90, 4096
  buffer_load_dwordx4 v[80:83], v1, s[44:47], s90 offen offset:0 sc1
  v_mfma_f32_32x32x16_bf16 v[144:159], v[196:199], v[48:51], v[144:159]
  ds_read_b128 v[220:223], v3 offset:7168
  s_waitcnt vmcnt(10) lgkmcnt(4)
  v_mfma_f32_32x32x16_bf16 v[160:175], v[200:203], v[48:51], v[160:175]
  s_add_u32 m0, s64, 57344
  ds_read_b128 v[192:195], v3 offset:8192
  buffer_load_dwordx4 v229, s[4:7], m0 offen offset:0 sc1 lds
  v_mfma_f32_32x32x16_bf16 v[128:143], v[204:207], v[52:55], v[128:143]
  ds_read_b128 v[196:199], v3 offset:9216
  buffer_load_dwordx4 v[84:87], v1, s[44:47], s90 offen offset:1024 sc1
  s_waitcnt lgkmcnt(4)
  v_mfma_f32_32x32x16_bf16 v[144:159], v[208:211], v[52:55], v[144:159]
  ds_read_b128 v[200:203], v3 offset:10240
  v_mfma_f32_32x32x16_bf16 v[160:175], v[212:215], v[52:55], v[160:175]
  ds_read_b128 v[204:207], v3 offset:11264
  s_waitcnt vmcnt(11) lgkmcnt(4)
  v_mfma_f32_32x32x16_bf16 v[128:143], v[216:219], v[56:59], v[128:143]
  ds_read_b128 v[208:211], v3 offset:12288
  buffer_load_dwordx4 v[88:91], v1, s[44:47], s90 offen offset:2048 sc1
  v_mfma_f32_32x32x16_bf16 v[144:159], v[220:223], v[56:59], v[144:159]
  ds_read_b128 v[212:215], v3 offset:13312
  s_waitcnt vmcnt(10) lgkmcnt(4)
  v_mfma_f32_32x32x16_bf16 v[160:175], v[192:195], v[56:59], v[160:175]
  s_add_u32 m0, s64, 61440
  ds_read_b128 v[216:219], v3 offset:14336
  buffer_load_dwordx4 v229, s[4:7], m0 offen offset:0 sc1 lds
  v_mfma_f32_32x32x16_bf16 v[128:143], v[196:199], v[60:63], v[128:143]
  ds_read_b128 v[220:223], v3 offset:15360
  buffer_load_dwordx4 v[92:95], v1, s[44:47], s90 offen offset:3072 sc1
  s_waitcnt lgkmcnt(4)
  v_mfma_f32_32x32x16_bf16 v[144:159], v[200:203], v[60:63], v[144:159]
  ds_read_b128 v[192:195], v3 offset:16384
  v_mfma_f32_32x32x16_bf16 v[160:175], v[204:207], v[60:63], v[160:175]
  ds_read_b128 v[196:199], v3 offset:17408
  s_waitcnt vmcnt(11) lgkmcnt(4)
  v_mfma_f32_32x32x16_bf16 v[128:143], v[208:211], v[64:67], v[128:143]
  ds_read_b128 v[200:203], v3 offset:18432
  s_add_u32 s90, s90, 4096
  buffer_load_dwordx4 v[96:99], v1, s[44:47], s90 offen offset:0 sc1
  v_mfma_f32_32x32x16_bf16 v[144:159], v[212:215], v[64:67], v[144:159]
  ds_read_b128 v[204:207], v3 offset:19456
  s_waitcnt vmcnt(10) lgkmcnt(4)
  v_mfma_f32_32x32x16_bf16 v[160:175], v[216:219], v[64:67], v[160:175]
  s_add_u32 m0, s64, 65536
  ds_read_b128 v[208:211], v3 offset:20480
  buffer_load_dwordx4 v229, s[4:7], m0 offen offset:0 sc1 lds
  v_mfma_f32_32x32x16_bf16 v[128:143], v[220:223], v[68:71], v[128:143]
  ds_read_b128 v[212:215], v3 offset:21504
  buffer_load_dwordx4 v[100:103], v1, s[44:47], s90 offen offset:1024 sc1
  s_waitcnt lgkmcnt(4)
  v_mfma_f32_32x32x16_bf16 v[144:159], v[192:195], v[68:71], v[144:159]
  ds_read_b128 v[216:219], v3 offset:22528
  v_mfma_f32_32x32x16_bf16 v[160:175], v[196:199], v[68:71], v[160:175]
  ds_read_b128 v[220:223], v3 offset:23552
  s_waitcnt vmcnt(11) lgkmcnt(4)
  v_mfma_f32_32x32x16_bf16 v[128:143], v[200:203], v[72:75], v[128:143]
  ds_read_b128 v[192:195], v3 offset:24576
  buffer_load_dwordx4 v[104:107], v1, s[44:47], s90 offen offset:2048 sc1
  v_mfma_f32_32x32x16_bf16 v[144:159], v[204:207], v[72:75], v[144:159]
  ds_read_b128 v[196:199], v3 offset:25600
  s_waitcnt vmcnt(10) lgkmcnt(4)
  v_mfma_f32_32x32x16_bf16 v[160:175], v[208:211], v[72:75], v[160:175]
  s_add_u32 m0, s64, 69632
  ds_read_b128 v[200:203], v3 offset:26624
  buffer_load_dwordx4 v229, s[4:7], m0 offen offset:0 sc1 lds
  v_mfma_f32_32x32x16_bf16 v[128:143], v[212:215], v[76:79], v[128:143]
  ds_read_b128 v[204:207], v3 offset:27648
  buffer_load_dwordx4 v[108:111], v1, s[44:47], s90 offen offset:3072 sc1
  s_and_b32 s86, s64, 0x400
  v_add_u32 v240, s86, v1
  v_xor_b32 v241, 0x400, v240
  v_add_f32 v176, v176, v178
  s_waitcnt lgkmcnt(4)
  v_mfma_f32_32x32x16_bf16 v[144:159], v[216:219], v[76:79], v[144:159]
  ds_read_b128 v[208:211], v3 offset:28672
  v_add_f32 v177, v177, v179
  v_add_f32 v176, v176, v180
  v_add_f32 v177, v177, v181
  v_add_f32 v176, v176, v182
  v_add_f32 v177, v177, v183
  v_add_f32 v176, v176, v184
  v_mfma_f32_32x32x16_bf16 v[160:175], v[220:223], v[76:79], v[160:175]
  ds_read_b128 v[212:215], v3 offset:29696
  v_add_f32 v177, v177, v185
  v_add_f32 v176, v176, v186
  v_add_f32 v177, v177, v187
  v_add_f32 v176, v176, v188
  v_add_f32 v177, v177, v189
  s_waitcnt vmcnt(11) lgkmcnt(4)
  v_mfma_f32_32x32x16_bf16 v[128:143], v[192:195], v[80:83], v[128:143]
  ds_read_b128 v[216:219], v3 offset:30720
  s_add_u32 s90, s90, 4096
  buffer_load_dwordx4 v[112:115], v1, s[44:47], s90 offen offset:0 sc1
  v_mov_b32_e64 v178, v176
  v_mov_b32 v179, v177
  s_nop 0
  v_permlane32_swap_b32 v176, v178
  v_permlane32_swap_b32 v177, v179
  v_mfma_f32_32x32x16_bf16 v[144:159], v[196:199], v[80:83], v[144:159]
  ds_read_b128 v[220:223], v3 offset:31744
  v_add_f32 v176, v176, v178
  v_add_f32 v177, v177, v179
  v_mul_f32 v176, 0x3b124925, v176
  v_mul_f32 v177, 0x3b124925, v177
  v_fma_f32 v177, -v176, v176, v177
  s_waitcnt vmcnt(10) lgkmcnt(4)
  v_mfma_f32_32x32x16_bf16 v[160:175], v[200:203], v[80:83], v[160:175]
  s_add_u32 m0, s64, 73728
  ds_read_b128 v[192:195], v1 offset:0
  buffer_load_dwordx4 v229, s[4:7], m0 offen offset:0 sc1 lds
  v_max_f32 v177, 0, v177
  v_add_f32 v177, 0x3727c5ac, v177
  v_rsq_f32_e64 v248, v177
  v_mfma_f32_32x32x16_bf16 v[128:143], v[204:207], v[84:87], v[128:143]
  ds_read_b128 v[196:199], v1 offset:1024
  buffer_load_dwordx4 v[116:119], v1, s[44:47], s90 offen offset:1024 sc1
  v_cvt_pk_bf16_f32 v224, -v176, -v176
  v_mul_f32_e64 v250, v177, v248
  v_mul_f32 v249, 0x3fb8aa3b, v248
  v_mov_b32 v225, v224
  s_waitcnt lgkmcnt(4)
  v_mfma_f32_32x32x16_bf16 v[144:159], v[208:211], v[84:87], v[144:159]
  ds_read_b128 v[200:203], v1 offset:2048
  v_mov_b32 v226, v224
  v_mov_b32 v227, v224
  v_and_b32 v244, 3, v0
  v_lshlrev_b32 v244, 2, v244
  v_bfe_u32 v245, v0, 2, 1
  v_lshl_add_u32 v244, v245, 9, v244
  v_mfma_f32_32x32x16_bf16 v[160:175], v[212:215], v[84:87], v[160:175]
  ds_read_b128 v[204:207], v1 offset:3072
  s_lshl_b32 s86, s57, 9
  s_lshl_b32 s87, s48, 4
  s_add_u32 s86, s86, s87
  s_add_u32 s85, s86, 196608
  v_add_u32_e64 v244, s85, v244
  s_waitcnt vmcnt(11) lgkmcnt(4)
  v_mfma_f32_32x32x16_bf16 v[128:143], v[216:219], v[88:91], v[128:143]
  ds_read_b128 v[208:211], v1 offset:4096
  buffer_load_dwordx4 v[120:123], v1, s[44:47], s90 offen offset:2048 sc1
  s_mul_i32 s87, s48, 28672
  s_add_u32 s87, s87, 7340032
  s_mul_i32 s86, s58, 114688
  s_add_u32 s86, s86, s87
  v_add_u32 v245, s86, v1
  v_mfma_f32_32x32x16_bf16 v[144:159], v[220:223], v[88:91], v[144:159]
  ds_read_b128 v[212:215], v1 offset:5120
  s_xor_b32 s86, s58, 1
  s_mul_i32 s86, s86, 114688
  s_add_u32 s86, s86, s87
  v_add_u32_e64 v246, s86, v1
  s_waitcnt vmcnt(10) lgkmcnt(4)
  s_barrier
  v_mfma_f32_32x32x16_bf16 v[160:175], v[192:195], v[88:91], v[160:175]
  s_add_u32 m0, s64, 77824
  ds_read_b128 v[216:219], v1 offset:6144
  buffer_load_dwordx4 v229, s[4:7], m0 offen offset:0 sc1 lds
  v_mfma_f32_32x32x16_bf16 v[128:143], v[196:199], v[92:95], v[128:143]
  ds_read_b128 v[220:223], v1 offset:7168
  buffer_load_dwordx4 v[124:127], v1, s[44:47], s90 offen offset:3072 sc1
  s_waitcnt lgkmcnt(4)
  v_mfma_f32_32x32x16_bf16 v[144:159], v[200:203], v[92:95], v[144:159]
  ds_read_b128 v[192:195], v1 offset:8192
  v_mfma_f32_32x32x16_bf16 v[160:175], v[204:207], v[92:95], v[160:175]
  ds_read_b128 v[196:199], v1 offset:9216
  s_waitcnt vmcnt(11) lgkmcnt(4)
  v_mfma_f32_32x32x16_bf16 v[128:143], v[208:211], v[96:99], v[128:143]
  s_add_u32 m0, s64, 81920
  ds_read_b128 v[200:203], v1 offset:10240
  buffer_load_dwordx4 v229, s[4:7], m0 offen offset:0 sc1 lds
  v_mfma_f32_32x32x16_bf16 v[144:159], v[212:215], v[96:99], v[144:159]
  ds_read_b128 v[204:207], v1 offset:11264
  s_waitcnt vmcnt(10) lgkmcnt(4)
  v_mfma_f32_32x32x16_bf16 v[160:175], v[216:219], v[96:99], v[160:175]
  s_add_u32 m0, s64, 86016
  ds_read_b128 v[208:211], v1 offset:12288
  buffer_load_dwordx4 v229, s[4:7], m0 offen offset:0 sc1 lds
  v_mfma_f32_32x32x16_bf16 v[128:143], v[220:223], v[100:103], v[128:143]
  ds_read_b128 v[212:215], v1 offset:13312
  s_waitcnt lgkmcnt(4)
  v_mfma_f32_32x32x16_bf16 v[144:159], v[192:195], v[100:103], v[144:159]
  s_add_u32 m0, s64, 90112
  ds_read_b128 v[216:219], v1 offset:14336
  buffer_load_dwordx4 v229, s[4:7], m0 offen offset:0 sc1 lds
  v_mfma_f32_32x32x16_bf16 v[160:175], v[196:199], v[100:103], v[160:175]
  ds_read_b128 v[220:223], v1 offset:15360
  s_waitcnt vmcnt(11) lgkmcnt(4)
  v_mfma_f32_32x32x16_bf16 v[128:143], v[200:203], v[104:107], v[128:143]
  s_add_u32 m0, s65, 106496
  ds_read_b128 v[192:195], v1 offset:16384
  buffer_load_dwordx4 v228, s[4:7], m0 offen offset:0 sc1 lds
  v_mfma_f32_32x32x16_bf16 v[144:159], v[204:207], v[104:107], v[144:159]
  ds_read_b128 v[196:199], v1 offset:17408
  s_waitcnt vmcnt(10) lgkmcnt(4)
  v_mfma_f32_32x32x16_bf16 v[160:175], v[208:211], v[104:107], v[160:175]
  ds_read_b128 v[200:203], v1 offset:18432
  buffer_load_dwordx4 v228, s[4:7], m0 offen offset:1024 sc1 lds
  v_mfma_f32_32x32x16_bf16 v[128:143], v[212:215], v[108:111], v[128:143]
  ds_read_b128 v[204:207], v1 offset:19456
  s_waitcnt lgkmcnt(4)
  v_mfma_f32_32x32x16_bf16 v[144:159], v[216:219], v[108:111], v[144:159]
  s_add_u32 m0, s65, 114688
  ds_read_b128 v[208:211], v1 offset:20480
  buffer_load_dwordx4 v228, s[4:7], m0 offen offset:0 sc1 lds
  v_mfma_f32_32x32x16_bf16 v[160:175], v[220:223], v[108:111], v[160:175]
  ds_read_b128 v[212:215], v1 offset:21504
  s_waitcnt vmcnt(11) lgkmcnt(4)
  v_mfma_f32_32x32x16_bf16 v[128:143], v[192:195], v[112:115], v[128:143]
  ds_read_b128 v[216:219], v1 offset:22528
  buffer_load_dwordx4 v228, s[4:7], m0 offen offset:1024 sc1 lds
  v_mfma_f32_32x32x16_bf16 v[144:159], v[196:199], v[112:115], v[144:159]
  ds_read_b128 v[220:223], v1 offset:23552
  s_waitcnt vmcnt(10) lgkmcnt(4)
  v_mfma_f32_32x32x16_bf16 v[160:175], v[200:203], v[112:115], v[160:175]
  s_add_u32 m0, s65, 122880
  ds_read_b128 v[192:195], v1 offset:24576
  buffer_load_dwordx4 v228, s[4:7], m0 offen offset:0 sc1 lds
  v_mfma_f32_32x32x16_bf16 v[128:143], v[204:207], v[116:119], v[128:143]
  ds_read_b128 v[196:199], v1 offset:25600
  s_waitcnt lgkmcnt(4)
  v_mfma_f32_32x32x16_bf16 v[144:159], v[208:211], v[116:119], v[144:159]
  ds_read_b128 v[200:203], v1 offset:26624
  buffer_load_dwordx4 v228, s[4:7], m0 offen offset:1024 sc1 lds
  v_mfma_f32_32x32x16_bf16 v[160:175], v[212:215], v[116:119], v[160:175]
  ds_read_b128 v[204:207], v1 offset:27648
  s_waitcnt vmcnt(11) lgkmcnt(4)
  v_mfma_f32_32x32x16_bf16 v[128:143], v[216:219], v[120:123], v[128:143]
  s_add_u32 m0, s65, 131072
  v_add_u32 v251, 0x7000, v5
  ds_read2_b32 v[208:209], v251 offset0:0 offset1:32
  ds_read2_b32 v[210:211], v251 offset0:64 offset1:96
  buffer_load_dwordx4 v228, s[4:7], m0 offen offset:0 sc1 lds
  v_mfma_f32_32x32x16_bf16 v[144:159], v[220:223], v[120:123], v[144:159]
  v_add_u32 v252, 0x7400, v5
  ds_read2_b32 v[212:213], v252 offset0:0 offset1:32
  ds_read2_b32 v[214:215], v252 offset0:64 offset1:96
  s_waitcnt vmcnt(10) lgkmcnt(6)
  v_mfma_f32_32x32x16_bf16 v[160:175], v[192:195], v[120:123], v[160:175]
  v_add_u32 v253, 0x7800, v5
  ds_read2_b32 v[216:217], v253 offset0:0 offset1:32
  ds_read2_b32 v[218:219], v253 offset0:64 offset1:96
  buffer_load_dwordx4 v228, s[4:7], m0 offen offset:1024 sc1 lds
  v_mfma_f32_32x32x16_bf16 v[128:143], v[196:199], v[124:127], v[128:143]
  ds_read_b128 v[220:223], v1 offset:31744
  s_waitcnt lgkmcnt(7)
  v_mfma_f32_32x32x16_bf16 v[144:159], v[200:203], v[124:127], v[144:159]
  s_add_u32 m0, s65, 139264
  ds_read_b128 v[192:195], v1 offset:32768
  buffer_load_dwordx4 v228, s[4:7], m0 offen offset:0 sc1 lds
  v_mfma_f32_32x32x16_bf16 v[160:175], v[204:207], v[124:127], v[160:175]
  ds_read_b128 v[196:199], v1 offset:33792
  s_waitcnt lgkmcnt(5)
  v_mfma_f32_32x32x16_bf16 v[128:143], v[208:211], v[224:227], v[128:143]
  ds_read_b128 v[200:203], v1 offset:34816
  buffer_load_dwordx4 v228, s[4:7], m0 offen offset:1024 sc1 lds
  v_mfma_f32_32x32x16_bf16 v[144:159], v[212:215], v[224:227], v[144:159]
  ds_read_b128 v[204:207], v1 offset:35840
  s_waitcnt lgkmcnt(4)
  v_mfma_f32_32x32x16_bf16 v[160:175], v[216:219], v[224:227], v[160:175]
  s_add_u32 m0, s65, 147456
  ds_read_b128 v[208:211], v1 offset:36864
  buffer_load_dwordx4 v228, s[4:7], m0 offen offset:0 sc1 lds
  v_mul_f32 v128, v128, v249
  v_mul_f32 v129, v129, v249
  v_mul_f32 v130, v130, v249
  v_mul_f32_e64 v131, v131, v249
  v_mfma_f32_32x32x16_bf16 v[176:191], v[220:223], v[16:19], 0
  ds_read_b128 v[212:215], v1 offset:37888
  v_mul_f32 v132, v132, v249
  v_mul_f32 v133, v133, v249
  v_mul_f32_e64 v134, v134, v249
  v_mul_f32 v135, v135, v249
  s_waitcnt lgkmcnt(4)
  v_mfma_f32_32x32x16_bf16 v[176:191], v[192:195], v[20:23], v[176:191]
  ds_read_b128 v[216:219], v1 offset:38912
  buffer_load_dwordx4 v228, s[4:7], m0 offen offset:1024 sc1 lds
  v_exp_f32_e64 v128, -v128
  v_exp_f32_e64 v129, -v129
  v_mfma_f32_32x32x16_bf16 v[176:191], v[196:199], v[24:27], v[176:191]
  ds_read_b128 v[220:223], v1 offset:39936
  v_exp_f32_e64 v130, -v130
  v_fma_f32 v128, v128, v250, v250
  v_exp_f32_e64 v131, -v131
  s_waitcnt lgkmcnt(4)
  v_mfma_f32_32x32x16_bf16 v[176:191], v[200:203], v[28:31], v[176:191]
  s_add_u32 m0, s65, 155648
  ds_read_b128 v[192:195], v1 offset:40960
  buffer_load_dwordx4 v228, s[4:7], m0 offen offset:0 sc1 lds
  v_fma_f32 v129, v129, v250, v250
  v_exp_f32_e64 v132, -v132
  v_fma_f32 v130, v130, v250, v250
  v_mfma_f32_32x32x16_bf16 v[176:191], v[204:207], v[32:35], v[176:191]
  ds_read_b128 v[196:199], v1 offset:41984
  v_exp_f32_e64 v133, -v133
  v_fma_f32 v131, v131, v250, v250
  v_exp_f32_e64 v134, -v134
  s_waitcnt lgkmcnt(4)
  v_mfma_f32_32x32x16_bf16 v[176:191], v[208:211], v[36:39], v[176:191]
  ds_read_b128 v[200:203], v1 offset:43008
  buffer_load_dwordx4 v228, s[4:7], m0 offen offset:1024 sc1 lds
  v_fma_f32 v132, v132, v250, v250
  v_exp_f32_e64 v135, -v135
  v_fma_f32 v133, v133, v250, v250
  v_fma_f32 v134, v134, v250, v250
  v_mfma_f32_32x32x16_bf16 v[176:191], v[212:215], v[40:43], v[176:191]
  ds_read_b128 v[204:207], v1 offset:44032
  v_fma_f32 v135, v135, v250, v250
  v_rcp_f32_e64 v128, v128
  v_rcp_f32 v129, v129
  s_waitcnt lgkmcnt(4)
  v_mfma_f32_32x32x16_bf16 v[176:191], v[216:219], v[44:47], v[176:191]
  v_and_b32 v232, 3, v0
  v_lshlrev_b32 v232, 7, v232
  ds_read_b128 v[208:211], v1 offset:45056
  global_load_dword v233, v232, s[100:101]
  v_rcp_f32 v130, v130
  v_mul_f32 v128, v128, v136
  v_mfma_f32_32x32x16_bf16 v[176:191], v[220:223], v[48:51], v[176:191]
  ds_read_b128 v[212:215], v1 offset:46080
  v_rcp_f32 v131, v131
  v_mul_f32 v129, v129, v137
  v_rcp_f32 v132, v132
  s_waitcnt lgkmcnt(4)
  v_mfma_f32_32x32x16_bf16 v[176:191], v[192:195], v[52:55], v[176:191]
  s_add_u32 s91, s70, 8192
  ds_read_b128 v[216:219], v1 offset:47104
  buffer_load_dwordx4 a[32:35], v240, s[4:7], s91 offen offset:0 sc1
  v_mul_f32 v130, v130, v138
  v_rcp_f32 v133, v133
  v_mul_f32_e64 v131, v131, v139
  v_mfma_f32_32x32x16_bf16 v[176:191], v[196:199], v[56:59], v[176:191]
  ds_read_b128 v[220:223], v1 offset:48128
  v_rcp_f32 v134, v134
  v_mul_f32 v132, v132, v140
  v_rcp_f32 v135, v135
  s_waitcnt lgkmcnt(4)
  v_mfma_f32_32x32x16_bf16 v[176:191], v[200:203], v[60:63], v[176:191]
  ds_read_b128 v[192:195], v1 offset:49152
  buffer_load_dwordx4 a[36:39], v241, s[4:7], s91 offen offset:0 sc1
  v_mul_f32 v133, v133, v141
  v_mul_f32 v134, v134, v142
  v_mul_f32_e64 v135, v135, v143
  v_cvt_pk_bf16_f32 v136, v128, v129
  v_cvt_pk_bf16_f32 v137, v130, v131
  v_mfma_f32_32x32x16_bf16 v[176:191], v[204:207], v[64:67], v[176:191]
  ds_read_b128 v[196:199], v1 offset:50176
  v_cvt_pk_bf16_f32 v138, v132, v133
  v_cvt_pk_bf16_f32 v139, v134, v135
  s_waitcnt lgkmcnt(4)
  v_mfma_f32_32x32x16_bf16 v[176:191], v[208:211], v[68:71], v[176:191]
  ds_read_b128 v[200:203], v1 offset:51200
  buffer_load_dwordx4 a[40:43], v240, s[4:7], s91 offen offset:2048 sc1
  buffer_store_dwordx4 v[136:139], v1, s[44:47], s73 offen offset:0 sc1
  v_mul_f32 v144, v144, v249
  v_mul_f32 v145, v145, v249
  v_mul_f32 v146, v146, v249
  v_mul_f32_e64 v147, v147, v249
  v_mfma_f32_32x32x16_bf16 v[176:191], v[212:215], v[72:75], v[176:191]
  ds_read_b128 v[204:207], v1 offset:52224
  v_mul_f32 v148, v148, v249
  v_mul_f32 v149, v149, v249
  v_mul_f32_e64 v150, v150, v249
  v_mul_f32 v151, v151, v249
  s_waitcnt lgkmcnt(4)
  v_mfma_f32_32x32x16_bf16 v[176:191], v[216:219], v[76:79], v[176:191]
  ds_read_b128 v[208:211], v1 offset:53248
  buffer_load_dwordx4 a[44:47], v241, s[4:7], s91 offen offset:2048 sc1
  v_exp_f32_e64 v144, -v144
  v_exp_f32_e64 v145, -v145
  v_mfma_f32_32x32x16_bf16 v[176:191], v[220:223], v[80:83], v[176:191]
  ds_read_b128 v[212:215], v1 offset:54272
  v_exp_f32_e64 v146, -v146
  v_fma_f32 v144, v144, v250, v250
  v_exp_f32_e64 v147, -v147
  s_waitcnt lgkmcnt(4)
  v_mfma_f32_32x32x16_bf16 v[176:191], v[192:195], v[84:87], v[176:191]
  s_add_u32 s91, s70, 12288
  ds_read_b128 v[216:219], v1 offset:55296
  buffer_load_dwordx4 a[48:51], v240, s[4:7], s91 offen offset:0 sc1
  v_fma_f32 v145, v145, v250, v250
  v_exp_f32_e64 v148, -v148
  v_fma_f32 v146, v146, v250, v250
  v_mfma_f32_32x32x16_bf16 v[176:191], v[196:199], v[88:91], v[176:191]
  ds_read_b128 v[220:223], v1 offset:56320
  v_exp_f32_e64 v149, -v149
  v_fma_f32 v147, v147, v250, v250
  v_exp_f32_e64 v150, -v150
  s_waitcnt lgkmcnt(4)
  s_waitcnt vmcnt(21)
  s_barrier
  v_mfma_f32_32x32x16_bf16 v[176:191], v[200:203], v[92:95], v[176:191]
  ds_read_b128 v[192:195], v1 offset:57344
  buffer_load_dwordx4 a[52:55], v241, s[4:7], s91 offen offset:0 sc1
  v_fma_f32 v148, v148, v250, v250
  v_exp_f32_e64 v151, -v151
  v_fma_f32 v149, v149, v250, v250
  v_fma_f32 v150, v150, v250, v250
  v_mfma_f32_32x32x16_bf16 v[176:191], v[204:207], v[96:99], v[176:191]
  ds_read_b128 v[196:199], v1 offset:58368
  v_fma_f32 v151, v151, v250, v250
  v_rcp_f32_e64 v144, v144
  v_rcp_f32 v145, v145
  s_waitcnt lgkmcnt(4)
  v_mfma_f32_32x32x16_bf16 v[176:191], v[208:211], v[100:103], v[176:191]
  ds_read_b128 v[200:203], v1 offset:59392
  buffer_load_dwordx4 a[56:59], v240, s[4:7], s91 offen offset:2048 sc1
  v_rcp_f32 v146, v146
  v_mul_f32 v144, v144, v152
  v_rcp_f32_e64 v147, v147
  v_mfma_f32_32x32x16_bf16 v[176:191], v[212:215], v[104:107], v[176:191]
  v_add_u32 v252, 0xec00, v5
  ds_read2_b32 v[204:205], v252 offset0:0 offset1:32
  ds_read2_b32 v[206:207], v252 offset0:64 offset1:96
  v_mul_f32_e64 v145, v145, v153
  v_rcp_f32 v148, v148
  s_waitcnt lgkmcnt(5)
  v_mfma_f32_32x32x16_bf16 v[176:191], v[216:219], v[108:111], v[176:191]
  ds_read_b128 v[208:211], v1 offset:61440
  buffer_load_dwordx4 a[60:63], v241, s[4:7], s91 offen offset:2048 sc1
  v_mul_f32 v146, v146, v154
  v_rcp_f32 v149, v149
  v_mul_f32_e64 v147, v147, v155
  v_mfma_f32_32x32x16_bf16 v[176:191], v[220:223], v[112:115], v[176:191]
  ds_read_b128 v[212:215], v1 offset:62464
  v_rcp_f32 v150, v150
  v_mul_f32 v148, v148, v156
  v_rcp_f32 v151, v151
  s_waitcnt lgkmcnt(5)
  v_mfma_f32_32x32x16_bf16 v[176:191], v[192:195], v[116:119], v[176:191]
  s_add_u32 s91, s70, 16384
  ds_read_b128 v[216:219], v1 offset:63488
  buffer_load_dwordx4 a[64:67], v240, s[4:7], s91 offen offset:0 sc1
  v_mul_f32 v149, v149, v157
  v_mul_f32 v150, v150, v158
  v_mul_f32_e64 v151, v151, v159
  v_cvt_pk_bf16_f32 v152, v144, v145
  v_mfma_f32_32x32x16_bf16 v[176:191], v[196:199], v[120:123], v[176:191]
  ds_read_b128 v[220:223], v1 offset:64512
  v_cvt_pk_bf16_f32 v153, v146, v147
  v_cvt_pk_bf16_f32 v154, v148, v149
  v_cvt_pk_bf16_f32 v155, v150, v151
  s_waitcnt lgkmcnt(4)
  v_mfma_f32_32x32x16_bf16 v[176:191], v[200:203], v[124:127], v[176:191]
  ds_read_b128 v[192:195], v2 offset:0
  buffer_load_dwordx4 a[68:71], v241, s[4:7], s91 offen offset:0 sc1
  buffer_store_dwordx4 v[152:155], v1, s[44:47], s73 offen offset:1024 sc1
  v_mul_f32 v160, v160, v249
  v_mul_f32 v161, v161, v249
  v_mul_f32 v162, v162, v249
  v_mul_f32_e64 v163, v163, v249
  v_mfma_f32_32x32x16_bf16 v[176:191], v[204:207], v[224:227], v[176:191]
  ds_read_b128 v[196:199], v2 offset:1024
  v_mul_f32 v164, v164, v249
  v_mul_f32 v165, v165, v249
  v_mul_f32_e64 v166, v166, v249
  v_mul_f32 v167, v167, v249
  s_waitcnt lgkmcnt(4)
  v_mfma_f32_32x32x16_bf16 v[128:143], v[208:211], v[16:19], 0
  ds_read_b128 v[200:203], v2 offset:2048
  buffer_load_dwordx4 a[72:75], v240, s[4:7], s91 offen offset:2048 sc1
  v_exp_f32_e64 v160, -v160
  v_exp_f32_e64 v161, -v161
  v_mfma_f32_32x32x16_bf16 v[128:143], v[212:215], v[20:23], v[128:143]
  ds_read_b128 v[204:207], v2 offset:3072
  v_exp_f32_e64 v162, -v162
  v_fma_f32 v160, v160, v250, v250
  v_exp_f32_e64 v163, -v163
  s_waitcnt lgkmcnt(4)
  v_mfma_f32_32x32x16_bf16 v[128:143], v[216:219], v[24:27], v[128:143]
  ds_read_b128 v[208:211], v2 offset:4096
  buffer_load_dwordx4 a[76:79], v241, s[4:7], s91 offen offset:2048 sc1
  v_fma_f32 v161, v161, v250, v250
  v_exp_f32_e64 v164, -v164
  v_fma_f32 v162, v162, v250, v250
  v_mfma_f32_32x32x16_bf16 v[128:143], v[220:223], v[28:31], v[128:143]
  ds_read_b128 v[212:215], v2 offset:5120
  v_exp_f32_e64 v165, -v165
  v_fma_f32 v163, v163, v250, v250
  v_exp_f32_e64 v166, -v166
  s_waitcnt lgkmcnt(4)
  v_mfma_f32_32x32x16_bf16 v[128:143], v[192:195], v[32:35], v[128:143]
  s_add_u32 s91, s70, 20480
  ds_read_b128 v[216:219], v2 offset:6144
  buffer_load_dwordx4 a[80:83], v240, s[4:7], s91 offen offset:0 sc1
  v_fma_f32 v164, v164, v250, v250
  v_exp_f32_e64 v167, -v167
  v_fma_f32 v165, v165, v250, v250
  v_mfma_f32_32x32x16_bf16 v[128:143], v[196:199], v[36:39], v[128:143]
  ds_read_b128 v[220:223], v2 offset:7168
  v_fma_f32 v166, v166, v250, v250
  v_fma_f32 v167, v167, v250, v250
  v_rcp_f32 v160, v160
  s_waitcnt lgkmcnt(4)
  v_mfma_f32_32x32x16_bf16 v[128:143], v[200:203], v[40:43], v[128:143]
  ds_read_b128 v[192:195], v2 offset:8192
  buffer_load_dwordx4 a[84:87], v241, s[4:7], s91 offen offset:0 sc1
  v_rcp_f32 v161, v161
  v_rcp_f32 v162, v162
  v_mul_f32_e64 v160, v160, v168
  v_mfma_f32_32x32x16_bf16 v[128:143], v[204:207], v[44:47], v[128:143]
  ds_read_b128 v[196:199], v2 offset:9216
  v_rcp_f32 v163, v163
  v_mul_f32 v161, v161, v169
  v_rcp_f32 v164, v164
  s_waitcnt lgkmcnt(4)
  v_mfma_f32_32x32x16_bf16 v[128:143], v[208:211], v[48:51], v[128:143]
  ds_read_b128 v[200:203], v2 offset:10240
  buffer_load_dwordx4 a[88:91], v240, s[4:7], s91 offen offset:2048 sc1
  v_mul_f32 v162, v162, v170
  v_rcp_f32 v165, v165
  v_mul_f32_e64 v163, v163, v171
  v_mfma_f32_32x32x16_bf16 v[128:143], v[212:215], v[52:55], v[128:143]
  ds_read_b128 v[204:207], v2 offset:11264
  v_rcp_f32 v166, v166
  v_mul_f32 v164, v164, v172
  v_rcp_f32 v167, v167
  s_waitcnt lgkmcnt(4)
  v_mfma_f32_32x32x16_bf16 v[128:143], v[216:219], v[56:59], v[128:143]
  ds_read_b128 v[208:211], v2 offset:12288
  buffer_load_dwordx4 a[92:95], v241, s[4:7], s91 offen offset:2048 sc1
  v_mul_f32 v165, v165, v173
  v_mul_f32 v166, v166, v174
  v_mul_f32_e64 v167, v167, v175
  v_cvt_pk_bf16_f32 v168, v160, v161
  v_cvt_pk_bf16_f32 v169, v162, v163
  v_mfma_f32_32x32x16_bf16 v[128:143], v[220:223], v[60:63], v[128:143]
  ds_read_b128 v[212:215], v2 offset:13312
  v_cvt_pk_bf16_f32 v170, v164, v165
  v_cvt_pk_bf16_f32 v171, v166, v167
  s_waitcnt lgkmcnt(4)
  v_mfma_f32_32x32x16_bf16 v[128:143], v[192:195], v[64:67], v[128:143]
  s_add_u32 s91, s70, 24576
  ds_read_b128 v[216:219], v2 offset:14336
  buffer_load_dwordx4 a[96:99], v240, s[4:7], s91 offen offset:0 sc1
  buffer_store_dwordx4 v[168:171], v1, s[44:47], s73 offen offset:2048 sc1
  v_mul_f32 v176, v176, v249
  v_mul_f32 v177, v177, v249
  v_mul_f32 v178, v178, v249
  v_mfma_f32_32x32x16_bf16 v[128:143], v[196:199], v[68:71], v[128:143]
  ds_read_b128 v[220:223], v2 offset:15360
  v_mul_f32 v179, v179, v249
  v_mul_f32 v180, v180, v249
  v_mul_f32 v181, v181, v249
  v_mul_f32 v182, v182, v249
  v_mul_f32 v183, v183, v249
  s_waitcnt lgkmcnt(4)
  v_mfma_f32_32x32x16_bf16 v[128:143], v[200:203], v[72:75], v[128:143]
  ds_read_b128 v[192:195], v2 offset:16384
  buffer_load_dwordx4 a[100:103], v241, s[4:7], s91 offen offset:0 sc1
  v_exp_f32_e64 v176, -v176
  v_exp_f32_e64 v177, -v177
  v_mfma_f32_32x32x16_bf16 v[128:143], v[204:207], v[76:79], v[128:143]
  ds_read_b128 v[196:199], v2 offset:17408
  v_exp_f32_e64 v178, -v178
  v_fma_f32 v176, v176, v250, v250
  v_exp_f32_e64 v179, -v179
  s_waitcnt lgkmcnt(4)
  v_mfma_f32_32x32x16_bf16 v[128:143], v[208:211], v[80:83], v[128:143]
  ds_read_b128 v[200:203], v2 offset:18432
  buffer_load_dwordx4 a[104:107], v240, s[4:7], s91 offen offset:2048 sc1
  v_fma_f32 v177, v177, v250, v250
  v_exp_f32_e64 v180, -v180
  v_fma_f32 v178, v178, v250, v250
  v_mfma_f32_32x32x16_bf16 v[128:143], v[212:215], v[84:87], v[128:143]
  ds_read_b128 v[204:207], v2 offset:19456
  v_exp_f32_e64 v181, -v181
  v_fma_f32 v179, v179, v250, v250
  v_exp_f32_e64 v182, -v182
  s_waitcnt lgkmcnt(4)
  v_mfma_f32_32x32x16_bf16 v[128:143], v[216:219], v[88:91], v[128:143]
  ds_read_b128 v[208:211], v2 offset:20480
  buffer_load_dwordx4 a[108:111], v241, s[4:7], s91 offen offset:2048 sc1
  v_fma_f32 v180, v180, v250, v250
  v_exp_f32_e64 v183, -v183
  v_fma_f32 v181, v181, v250, v250
  v_fma_f32 v182, v182, v250, v250
  v_mfma_f32_32x32x16_bf16 v[128:143], v[220:223], v[92:95], v[128:143]
  ds_read_b128 v[212:215], v2 offset:21504
  s_waitcnt vmcnt(11)
  v_mov_b32_e64 v254, 1
  s_mov_b64 exec, 1
  buffer_store_dword v254, off, s[40:43], s94 offset:0 sc1
  s_mov_b64 exec, -1
  s_waitcnt lgkmcnt(4)
  v_mfma_f32_32x32x16_bf16 v[128:143], v[192:195], v[96:99], v[128:143]
  s_add_u32 s91, s70, 28672
  ds_read_b128 v[216:219], v2 offset:22528
  buffer_load_dwordx4 a[112:115], v240, s[4:7], s91 offen offset:0 sc1
  v_fma_f32 v183, v183, v250, v250
  v_rcp_f32_e64 v176, v176
  v_mfma_f32_32x32x16_bf16 v[128:143], v[196:199], v[100:103], v[128:143]
  ds_read_b128 v[220:223], v2 offset:23552
  v_rcp_f32 v177, v177
  v_rcp_f32 v178, v178
  v_mul_f32 v176, v176, v184
  s_waitcnt lgkmcnt(4)
  v_mfma_f32_32x32x16_bf16 v[128:143], v[200:203], v[104:107], v[128:143]
  v_add_u32 v251, 0x16000, v5
  ds_read2_b32 v[192:193], v251 offset0:0 offset1:32
  ds_read2_b32 v[194:195], v251 offset0:64 offset1:96
  buffer_load_dwordx4 a[116:119], v241, s[4:7], s91 offen offset:0 sc1
  v_rcp_f32_e64 v179, v179
  v_mul_f32 v177, v177, v185
  s_barrier
  v_mfma_f32_32x32x16_bf16 v[128:143], v[204:207], v[108:111], v[128:143]
  ds_read_b128 v[196:199], v2 offset:40960
  v_rcp_f32 v180, v180
  v_mul_f32 v178, v178, v186
  v_rcp_f32 v181, v181
  s_waitcnt lgkmcnt(5)
  v_mfma_f32_32x32x16_bf16 v[128:143], v[208:211], v[112:115], v[128:143]
  v_and_b32 v232, 3, v0
  v_lshlrev_b32 v232, 7, v232
  ds_read_b128 v[200:203], v2 offset:41984
  global_load_dword v233, v232, s[100:101]
  v_mul_f32 v179, v179, v187
  v_rcp_f32 v182, v182
  v_mfma_f32_32x32x16_bf16 v[128:143], v[212:215], v[116:119], v[128:143]
  ds_read_b128 v[204:207], v2 offset:43008
  v_mul_f32 v180, v180, v188
  v_rcp_f32 v183, v183
  v_mul_f32_e64 v181, v181, v189
  v_mul_f32 v182, v182, v190
  s_waitcnt lgkmcnt(5)
  v_mfma_f32_32x32x16_bf16 v[128:143], v[216:219], v[120:123], v[128:143]
  ds_read_b128 v[208:211], v2 offset:44032
  buffer_load_dwordx4 a[120:123], v240, s[4:7], s91 offen offset:2048 sc1
  v_mul_f32_e64 v183, v183, v191
  v_cvt_pk_bf16_f32 v184, v176, v177
  v_cvt_pk_bf16_f32 v185, v178, v179
  v_cvt_pk_bf16_f32 v186, v180, v181
  v_cvt_pk_bf16_f32 v187, v182, v183
  v_mfma_f32_32x32x16_bf16 v[128:143], v[220:223], v[124:127], v[128:143]
  ds_read_b128 v[212:215], v2 offset:45056
  buffer_store_dwordx4 v[184:187], v1, s[44:47], s73 offen offset:3072 sc1
  s_waitcnt lgkmcnt(4)
  v_mfma_f32_32x32x16_bf16 v[128:143], v[192:195], v[224:227], v[128:143]
  ds_read_b128 v[216:219], v2 offset:46080
  buffer_load_dwordx4 a[124:127], v241, s[4:7], s91 offen offset:2048 sc1
  v_mfma_f32_32x32x16_bf16 v[144:159], v[196:199], v[16:19], 0
  ds_read_b128 v[220:223], v2 offset:47104
  s_waitcnt lgkmcnt(4)
  v_mfma_f32_32x32x16_bf16 v[144:159], v[200:203], v[20:23], v[144:159]
  s_add_u32 s91, s70, 32768
  ds_read_b128 v[192:195], v2 offset:48128
  buffer_load_dwordx4 a[128:131], v240, s[4:7], s91 offen offset:0 sc1
  v_mul_f32 v128, v128, v249
  v_mul_f32 v129, v129, v249
  v_mul_f32 v130, v130, v249
  v_mul_f32 v131, v131, v249
  v_mfma_f32_32x32x16_bf16 v[144:159], v[204:207], v[24:27], v[144:159]
  ds_read_b128 v[196:199], v2 offset:49152
  v_mul_f32 v132, v132, v249
  v_mul_f32 v133, v133, v249
  v_mul_f32_e64 v134, v134, v249
  v_mul_f32 v135, v135, v249
  s_waitcnt lgkmcnt(4)
  v_mfma_f32_32x32x16_bf16 v[144:159], v[208:211], v[28:31], v[144:159]
  ds_read_b128 v[200:203], v2 offset:50176
  buffer_load_dwordx4 a[132:135], v241, s[4:7], s91 offen offset:0 sc1
  v_exp_f32_e64 v128, -v128
  v_exp_f32_e64 v129, -v129
  v_mfma_f32_32x32x16_bf16 v[144:159], v[212:215], v[32:35], v[144:159]
  ds_read_b128 v[204:207], v2 offset:51200
  v_exp_f32_e64 v130, -v130
  v_fma_f32 v128, v128, v250, v250
  v_exp_f32_e64 v131, -v131
  s_waitcnt lgkmcnt(4)
  v_mfma_f32_32x32x16_bf16 v[144:159], v[216:219], v[36:39], v[144:159]
  ds_read_b128 v[208:211], v2 offset:52224
  buffer_load_dwordx4 a[136:139], v240, s[4:7], s91 offen offset:2048 sc1
  v_fma_f32 v129, v129, v250, v250
  v_exp_f32_e64 v132, -v132
  v_fma_f32 v130, v130, v250, v250
  v_mfma_f32_32x32x16_bf16 v[144:159], v[220:223], v[40:43], v[144:159]
  ds_read_b128 v[212:215], v2 offset:53248
  v_exp_f32_e64 v133, -v133
  v_fma_f32 v131, v131, v250, v250
  v_exp_f32_e64 v134, -v134
  s_waitcnt lgkmcnt(4)
  v_mfma_f32_32x32x16_bf16 v[144:159], v[192:195], v[44:47], v[144:159]
  ds_read_b128 v[216:219], v2 offset:54272
  buffer_load_dwordx4 a[140:143], v241, s[4:7], s91 offen offset:2048 sc1
  v_fma_f32 v132, v132, v250, v250
  v_exp_f32_e64 v135, -v135
  v_fma_f32 v133, v133, v250, v250
  v_fma_f32 v134, v134, v250, v250
  v_mfma_f32_32x32x16_bf16 v[144:159], v[196:199], v[48:51], v[144:159]
  ds_read_b128 v[220:223], v2 offset:55296
  v_fma_f32 v135, v135, v250, v250
  v_rcp_f32_e64 v128, v128
  v_rcp_f32 v129, v129
  s_waitcnt lgkmcnt(4)
  v_mfma_f32_32x32x16_bf16 v[144:159], v[200:203], v[52:55], v[144:159]
  s_add_u32 s91, s70, 36864
  ds_read_b128 v[192:195], v2 offset:56320
  buffer_load_dwordx4 a[144:147], v240, s[4:7], s91 offen offset:0 sc1
  v_rcp_f32 v130, v130
  v_mul_f32 v128, v128, v136
  v_mfma_f32_32x32x16_bf16 v[144:159], v[204:207], v[56:59], v[144:159]
  ds_read_b128 v[196:199], v2 offset:57344
  v_rcp_f32 v131, v131
  v_mul_f32 v129, v129, v137
  v_rcp_f32 v132, v132
  s_waitcnt lgkmcnt(4)
  v_mfma_f32_32x32x16_bf16 v[144:159], v[208:211], v[60:63], v[144:159]
  ds_read_b128 v[200:203], v2 offset:58368
  buffer_load_dwordx4 a[148:151], v241, s[4:7], s91 offen offset:0 sc1
  v_mul_f32 v130, v130, v138
  v_rcp_f32 v133, v133
  v_mul_f32_e64 v131, v131, v139
  v_mfma_f32_32x32x16_bf16 v[144:159], v[212:215], v[64:67], v[144:159]
  ds_read_b128 v[204:207], v2 offset:59392
  buffer_load_dword v247, v244, s[40:43], 0 offen offset:0 sc1
  v_rcp_f32_e64 v134, v134
  v_mul_f32 v132, v132, v140
  s_waitcnt lgkmcnt(4)
  v_mfma_f32_32x32x16_bf16 v[144:159], v[216:219], v[68:71], v[144:159]
  ds_read_b128 v[208:211], v2 offset:60416
  buffer_load_dwordx4 a[152:155], v240, s[4:7], s91 offen offset:2048 sc1
  v_rcp_f32 v135, v135
  v_mul_f32 v133, v133, v141
  v_mul_f32 v134, v134, v142
  v_mul_f32 v135, v135, v143
  v_mfma_f32_32x32x16_bf16 v[144:159], v[220:223], v[72:75], v[144:159]
  ds_read_b128 v[212:215], v2 offset:61440
  v_cvt_pk_bf16_f32 v136, v128, v129
  v_cvt_pk_bf16_f32 v137, v130, v131
  v_cvt_pk_bf16_f32 v138, v132, v133
  v_cvt_pk_bf16_f32 v139, v134, v135
  s_waitcnt lgkmcnt(4)
  v_mfma_f32_32x32x16_bf16 v[144:159], v[192:195], v[76:79], v[144:159]
  ds_read_b128 v[216:219], v2 offset:62464
  buffer_load_dwordx4 a[156:159], v241, s[4:7], s91 offen offset:2048 sc1
  buffer_store_dwordx4 v[136:139], v1, s[44:47], s74 offen offset:0 sc1
  v_mfma_f32_32x32x16_bf16 v[144:159], v[196:199], v[80:83], v[144:159]
  ds_read_b128 v[220:223], v2 offset:63488
  s_waitcnt lgkmcnt(4)
  v_mfma_f32_32x32x16_bf16 v[144:159], v[200:203], v[84:87], v[144:159]
  s_add_u32 s91, s70, 40960
  ds_read_b128 v[192:195], v2 offset:64512
  buffer_load_dwordx4 a[160:163], v240, s[4:7], s91 offen offset:0 sc1
  v_mfma_f32_32x32x16_bf16 v[144:159], v[204:207], v[88:91], v[144:159]
  ds_read_b128 v[196:199], v3 offset:0
  s_waitcnt vmcnt(12)
  v_mov_b32_e64 v254, 1
  s_mov_b64 exec, 1
  buffer_store_dword v254, off, s[40:43], s94 offset:64 sc1
  s_mov_b64 exec, -1
  s_waitcnt lgkmcnt(4)
  v_mfma_f32_32x32x16_bf16 v[144:159], v[208:211], v[92:95], v[144:159]
  ds_read_b128 v[200:203], v3 offset:1024
  buffer_load_dwordx4 a[164:167], v241, s[4:7], s91 offen offset:0 sc1
  v_mfma_f32_32x32x16_bf16 v[144:159], v[212:215], v[96:99], v[144:159]
  ds_read_b128 v[204:207], v3 offset:2048
  s_waitcnt lgkmcnt(4)
  v_mfma_f32_32x32x16_bf16 v[144:159], v[216:219], v[100:103], v[144:159]
  ds_read_b128 v[208:211], v3 offset:3072
  buffer_load_dwordx4 a[168:171], v240, s[4:7], s91 offen offset:2048 sc1
  v_mfma_f32_32x32x16_bf16 v[144:159], v[220:223], v[104:107], v[144:159]
  v_add_u32 v253, 0x21000, v5
  ds_read2_b32 v[212:213], v253 offset0:0 offset1:32
  ds_read2_b32 v[214:215], v253 offset0:64 offset1:96
  s_waitcnt lgkmcnt(5)
  v_mfma_f32_32x32x16_bf16 v[144:159], v[192:195], v[108:111], v[144:159]
  ds_read_b128 v[216:219], v3 offset:5120
  buffer_load_dwordx4 a[172:175], v241, s[4:7], s91 offen offset:2048 sc1
  v_mfma_f32_32x32x16_bf16 v[144:159], v[196:199], v[112:115], v[144:159]
  ds_read_b128 v[220:223], v3 offset:6144
  s_waitcnt lgkmcnt(5)
  v_mfma_f32_32x32x16_bf16 v[144:159], v[200:203], v[116:119], v[144:159]
  ds_read_b128 v[192:195], v3 offset:7168
  v_mfma_f32_32x32x16_bf16 v[144:159], v[204:207], v[120:123], v[144:159]
  ds_read_b128 v[196:199], v3 offset:8192
  s_waitcnt lgkmcnt(4)
  v_mfma_f32_32x32x16_bf16 v[144:159], v[208:211], v[124:127], v[144:159]
  ds_read_b128 v[200:203], v3 offset:9216
  v_mfma_f32_32x32x16_bf16 v[144:159], v[212:215], v[224:227], v[144:159]
  ds_read_b128 v[204:207], v3 offset:10240
  s_waitcnt lgkmcnt(4)
  v_mfma_f32_32x32x16_bf16 v[160:175], v[216:219], v[16:19], 0
  ds_read_b128 v[208:211], v3 offset:11264
  s_waitcnt vmcnt(8)
  v_mfma_f32_32x32x16_bf16 v[160:175], v[220:223], v[20:23], v[160:175]
  ds_read_b128 v[212:215], v3 offset:12288
  s_mov_b32 s90, 0
  buffer_load_dwordx4 v[16:19], v245, s[44:47], s90 offen sc1
  v_mul_f32 v144, v144, v249
  v_mul_f32_e64 v145, v145, v249
  v_mul_f32 v146, v146, v249
  s_waitcnt lgkmcnt(4)
  v_mfma_f32_32x32x16_bf16 v[160:175], v[192:195], v[24:27], v[160:175]
  ds_read_b128 v[216:219], v3 offset:13312
  v_mul_f32 v147, v147, v249
  v_mul_f32 v148, v148, v249
  v_mul_f32 v149, v149, v249
  v_mul_f32 v150, v150, v249
  v_mul_f32_e64 v151, v151, v249
  v_mfma_f32_32x32x16_bf16 v[160:175], v[196:199], v[28:31], v[160:175]
  ds_read_b128 v[220:223], v3 offset:14336
  buffer_load_dwordx4 v[20:23], v246, s[44:47], s90 offen sc1
  v_exp_f32_e64 v144, -v144
  v_exp_f32_e64 v145, -v145
  s_waitcnt lgkmcnt(4)
  v_mfma_f32_32x32x16_bf16 v[160:175], v[200:203], v[32:35], v[160:175]
  ds_read_b128 v[192:195], v3 offset:15360
  v_exp_f32_e64 v146, -v146
  v_fma_f32 v144, v144, v250, v250
  v_exp_f32_e64 v147, -v147
  v_fma_f32 v145, v145, v250, v250
  v_mfma_f32_32x32x16_bf16 v[160:175], v[204:207], v[36:39], v[160:175]
  ds_read_b128 v[196:199], v3 offset:16384
  s_mov_b32 s90, 7168
  buffer_load_dwordx4 v[24:27], v245, s[44:47], s90 offen sc1
  v_exp_f32_e64 v148, -v148
  v_fma_f32 v146, v146, v250, v250
  s_waitcnt lgkmcnt(4)
  v_mfma_f32_32x32x16_bf16 v[160:175], v[208:211], v[40:43], v[160:175]
  ds_read_b128 v[200:203], v3 offset:17408
  v_exp_f32_e64 v149, -v149
  v_fma_f32 v147, v147, v250, v250
  v_exp_f32_e64 v150, -v150
  v_fma_f32 v148, v148, v250, v250
  v_mfma_f32_32x32x16_bf16 v[160:175], v[212:215], v[44:47], v[160:175]
  ds_read_b128 v[204:207], v3 offset:18432
  buffer_load_dwordx4 v[28:31], v246, s[44:47], s90 offen sc1
  s_waitcnt vmcnt(9)
  v_mov_b32_e64 v254, 1
  s_mov_b64 exec, 1
  buffer_store_dword v254, off, s[40:43], s94 offset:256 sc1
  s_mov_b64 exec, -1
  s_waitcnt lgkmcnt(4)
  v_mfma_f32_32x32x16_bf16 v[160:175], v[216:219], v[48:51], v[160:175]
  ds_read_b128 v[208:211], v3 offset:19456
  v_exp_f32_e64 v151, -v151
  v_fma_f32 v149, v149, v250, v250
  v_fma_f32 v150, v150, v250, v250
  v_fma_f32 v151, v151, v250, v250
  v_mfma_f32_32x32x16_bf16 v[160:175], v[220:223], v[52:55], v[160:175]
  ds_read_b128 v[212:215], v3 offset:20480
  s_mov_b32 s90, 14336
  buffer_load_dwordx4 v[32:35], v245, s[44:47], s90 offen sc1
  v_rcp_f32 v144, v144
  s_waitcnt lgkmcnt(4)
  v_mfma_f32_32x32x16_bf16 v[160:175], v[192:195], v[56:59], v[160:175]
  ds_read_b128 v[216:219], v3 offset:21504
  v_rcp_f32 v145, v145
  v_rcp_f32 v146, v146
  v_mul_f32_e64 v144, v144, v152
  v_mfma_f32_32x32x16_bf16 v[160:175], v[196:199], v[60:63], v[160:175]
  ds_read_b128 v[220:223], v3 offset:22528
  buffer_load_dwordx4 v[36:39], v246, s[44:47], s90 offen sc1
  v_rcp_f32_e64 v147, v147
  v_mul_f32 v145, v145, v153
  s_waitcnt lgkmcnt(4)
  v_mfma_f32_32x32x16_bf16 v[160:175], v[200:203], v[64:67], v[160:175]
  ds_read_b128 v[192:195], v3 offset:23552
  buffer_load_dword v242, v244, s[40:43], 0 offen offset:64 sc1
  v_rcp_f32 v148, v148
  v_mul_f32 v146, v146, v154
  v_rcp_f32_e64 v149, v149
  v_mfma_f32_32x32x16_bf16 v[160:175], v[204:207], v[68:71], v[160:175]
  ds_read_b128 v[196:199], v3 offset:24576
  s_mov_b32 s90, 21504
  buffer_load_dwordx4 v[40:43], v245, s[44:47], s90 offen sc1
  v_mul_f32_e64 v147, v147, v155
  v_rcp_f32 v150, v150
  s_waitcnt lgkmcnt(4)
  v_mfma_f32_32x32x16_bf16 v[160:175], v[208:211], v[72:75], v[160:175]
  ds_read_b128 v[200:203], v3 offset:25600
  v_mul_f32 v148, v148, v156
  v_rcp_f32 v151, v151
  v_mul_f32 v149, v149, v157
  v_mul_f32 v150, v150, v158
  v_mul_f32_e64 v151, v151, v159
  v_mfma_f32_32x32x16_bf16 v[160:175], v[212:215], v[76:79], v[160:175]
  ds_read_b128 v[204:207], v3 offset:26624
  buffer_load_dwordx4 v[44:47], v246, s[44:47], s90 offen sc1
  v_cvt_pk_bf16_f32 v152, v144, v145
  v_cvt_pk_bf16_f32 v153, v146, v147
  v_cvt_pk_bf16_f32 v154, v148, v149
  v_cvt_pk_bf16_f32 v155, v150, v151
  s_waitcnt lgkmcnt(4)
  v_mfma_f32_32x32x16_bf16 v[160:175], v[216:219], v[80:83], v[160:175]
  ds_read_b128 v[208:211], v3 offset:27648
  buffer_store_dwordx4 v[152:155], v1, s[44:47], s74 offen offset:1024 sc1
  v_mfma_f32_32x32x16_bf16 v[160:175], v[220:223], v[84:87], v[160:175]
  ds_read_b128 v[212:215], v3 offset:28672
  s_mov_b32 s90, 1024
  buffer_load_dwordx4 v[48:51], v245, s[44:47], s90 offen sc1
  s_waitcnt lgkmcnt(4)
  v_mfma_f32_32x32x16_bf16 v[160:175], v[192:195], v[88:91], v[160:175]
  ds_read_b128 v[216:219], v3 offset:29696
  v_mfma_f32_32x32x16_bf16 v[160:175], v[196:199], v[92:95], v[160:175]
  ds_read_b128 v[220:223], v3 offset:30720
  buffer_load_dwordx4 v[52:55], v246, s[44:47], s90 offen sc1
  s_waitcnt lgkmcnt(4)
  v_mfma_f32_32x32x16_bf16 v[160:175], v[200:203], v[96:99], v[160:175]
  ds_read_b128 v[192:195], v3 offset:31744
  v_mfma_f32_32x32x16_bf16 v[160:175], v[204:207], v[100:103], v[160:175]
  ds_read_b128 v[196:199], v2 offset:25600
  s_mov_b32 s90, 8192
  buffer_load_dwordx4 v[56:59], v245, s[44:47], s90 offen sc1
  s_waitcnt lgkmcnt(4)
  v_mfma_f32_32x32x16_bf16 v[160:175], v[208:211], v[104:107], v[160:175]
  v_add_u32 v252, 0x16800, v5
  ds_read2_b32 v[200:201], v252 offset0:0 offset1:32
  ds_read2_b32 v[202:203], v252 offset0:64 offset1:96
  v_mfma_f32_32x32x16_bf16 v[160:175], v[212:215], v[108:111], v[160:175]
  buffer_load_dwordx4 v[60:63], v246, s[44:47], s90 offen sc1
  s_waitcnt lgkmcnt(4)
  v_mfma_f32_32x32x16_bf16 v[160:175], v[216:219], v[112:115], v[160:175]
  v_mfma_f32_32x32x16_bf16 v[160:175], v[220:223], v[116:119], v[160:175]
  s_mov_b32 s90, 15360
  buffer_load_dwordx4 v[64:67], v245, s[44:47], s90 offen sc1
  s_waitcnt lgkmcnt(2)
  v_mfma_f32_32x32x16_bf16 v[160:175], v[192:195], v[120:123], v[160:175]
  v_mfma_f32_32x32x16_bf16 v[160:175], v[196:199], v[124:127], v[160:175]
  buffer_load_dwordx4 v[68:71], v246, s[44:47], s90 offen sc1
  s_waitcnt lgkmcnt(0)
  v_mfma_f32_32x32x16_bf16 v[160:175], v[200:203], v[224:227], v[160:175]
  s_cmp_ge_u32 s49, 28
  s_cbranch_scc1 Lc_74
  s_waitcnt vmcnt(9)
  v_and_b32_e64 v247, v247, v242
  v_cmp_ne_u32 vcc, 1, v247
  s_nop 0
  s_cmp_eq_u64 vcc, 0
  s_cbranch_scc0 Lc_75
Lr_76:
  v_mfma_f32_32x32x16_bf16 v[208:223], a[0:3], v[16:19], 0
  s_mov_b32 s90, 22528
  buffer_load_dwordx4 v[72:75], v245, s[44:47], s90 offen sc1
  v_mfma_f32_32x32x16_bf16 v[224:239], a[4:7], v[16:19], 0
  s_add_u32 s91, s70, 45056
  buffer_load_dwordx4 a[176:179], v240, s[4:7], s91 offen offset:0 sc1
  v_mul_f32 v160, v160, v249
  v_mul_f32 v161, v161, v249
  v_mul_f32 v162, v162, v249
  v_mul_f32 v163, v163, v249
  v_mul_f32_e64 v164, v164, v249
  v_mfma_f32_32x32x16_bf16 a[224:239], a[0:3], v[20:23], 0
  buffer_load_dwordx4 v[76:79], v246, s[44:47], s90 offen sc1
  v_mul_f32 v165, v165, v249
  v_mul_f32 v166, v166, v249
  v_mul_f32_e64 v167, v167, v249
  v_exp_f32_e64 v160, -v160
  v_mfma_f32_32x32x16_bf16 a[240:255], a[4:7], v[20:23], 0
  buffer_load_dwordx4 a[180:183], v241, s[4:7], s91 offen offset:0 sc1
  v_exp_f32_e64 v161, -v161
  v_exp_f32_e64 v162, -v162
  v_fma_f32 v160, v160, v250, v250
  s_barrier
  v_mfma_f32_32x32x16_bf16 v[208:223], a[8:11], v[24:27], v[208:223]
  s_mov_b32 s90, 2048
  buffer_load_dwordx4 v[80:83], v245, s[44:47], s90 offen sc1
  v_exp_f32_e64 v163, -v163
  v_fma_f32 v161, v161, v250, v250
  v_exp_f32_e64 v164, -v164
  v_mfma_f32_32x32x16_bf16 v[224:239], a[12:15], v[24:27], v[224:239]
  buffer_load_dwordx4 a[184:187], v240, s[4:7], s91 offen offset:2048 sc1
  v_fma_f32 v162, v162, v250, v250
  v_exp_f32_e64 v165, -v165
  v_fma_f32 v163, v163, v250, v250
  v_exp_f32_e64 v166, -v166
  v_mfma_f32_32x32x16_bf16 a[224:239], a[8:11], v[28:31], a[224:239]
  buffer_load_dwordx4 v[84:87], v246, s[44:47], s90 offen sc1
  v_fma_f32 v164, v164, v250, v250
  v_exp_f32_e64 v167, -v167
  v_fma_f32 v165, v165, v250, v250
  v_fma_f32 v166, v166, v250, v250
  v_fma_f32 v167, v167, v250, v250
  v_mfma_f32_32x32x16_bf16 a[240:255], a[12:15], v[28:31], a[240:255]
  buffer_load_dwordx4 a[188:191], v241, s[4:7], s91 offen offset:2048 sc1
  v_rcp_f32 v160, v160
  v_rcp_f32 v161, v161
  v_rcp_f32 v162, v162
  v_mfma_f32_32x32x16_bf16 v[208:223], a[16:19], v[32:35], v[208:223]
  s_mov_b32 s90, 9216
  buffer_load_dwordx4 v[88:91], v245, s[44:47], s90 offen sc1
  v_mul_f32 v160, v160, v168
  v_rcp_f32 v163, v163
  v_mul_f32_e64 v161, v161, v169
  v_mfma_f32_32x32x16_bf16 v[224:239], a[20:23], v[32:35], v[224:239]
  s_add_u32 s91, s70, 49152
  buffer_load_dwordx4 a[192:195], v240, s[4:7], s91 offen offset:0 sc1
  v_rcp_f32 v164, v164
  v_mul_f32 v162, v162, v170
  v_rcp_f32_e64 v165, v165
  v_mfma_f32_32x32x16_bf16 a[224:239], a[16:19], v[36:39], a[224:239]
  buffer_load_dwordx4 v[92:95], v246, s[44:47], s90 offen sc1
  v_mul_f32 v163, v163, v171
  v_rcp_f32 v166, v166
  v_mul_f32 v164, v164, v172
  v_rcp_f32 v167, v167
  v_mfma_f32_32x32x16_bf16 a[240:255], a[20:23], v[36:39], a[240:255]
  buffer_load_dwordx4 a[196:199], v241, s[4:7], s91 offen offset:0 sc1
  v_mul_f32 v165, v165, v173
  v_mul_f32 v166, v166, v174
  v_mul_f32_e64 v167, v167, v175
  v_cvt_pk_bf16_f32 v168, v160, v161
  v_cvt_pk_bf16_f32 v169, v162, v163
  v_cvt_pk_bf16_f32 v170, v164, v165
  s_waitcnt vmcnt(20)
  v_mfma_f32_32x32x16_bf16 v[208:223], a[24:27], v[40:43], v[208:223]
  s_mov_b32 s90, 16384
  buffer_load_dwordx4 v[96:99], v245, s[44:47], s90 offen sc1
  v_cvt_pk_bf16_f32 v171, v166, v167
  v_mfma_f32_32x32x16_bf16 v[224:239], a[28:31], v[40:43], v[224:239]
  s_waitcnt vmcnt(19)
  v_mov_b32 v254, 1
  s_mov_b64 exec, 1
  buffer_store_dword v254, off, s[40:43], s94 offset:128 sc1
  s_mov_b64 exec, -1
  buffer_store_dwordx4 v[168:171], v1, s[44:47], s74 offen offset:2048 sc1
  v_mfma_f32_32x32x16_bf16 a[224:239], a[24:27], v[44:47], a[224:239]
  buffer_load_dwordx4 v[100:103], v246, s[44:47], s90 offen sc1
  v_mfma_f32_32x32x16_bf16 a[240:255], a[28:31], v[44:47], a[240:255]
  buffer_load_dwordx4 a[200:203], v240, s[4:7], s91 offen offset:2048 sc1
  s_waitcnt vmcnt(22)
  v_mfma_f32_32x32x16_bf16 v[208:223], a[32:35], v[48:51], v[208:223]
  s_mov_b32 s90, 23552
  buffer_load_dwordx4 v[104:107], v245, s[44:47], s90 offen sc1
  v_mfma_f32_32x32x16_bf16 v[224:239], a[36:39], v[48:51], v[224:239]
  buffer_load_dwordx4 a[204:207], v241, s[4:7], s91 offen offset:2048 sc1
  s_waitcnt vmcnt(23)
  v_mfma_f32_32x32x16_bf16 a[224:239], a[32:35], v[52:55], a[224:239]
  buffer_load_dwordx4 v[108:111], v246, s[44:47], s90 offen sc1
  v_mfma_f32_32x32x16_bf16 a[240:255], a[36:39], v[52:55], a[240:255]
  s_add_u32 s91, s70, 53248
  buffer_load_dwordx4 a[208:211], v240, s[4:7], s91 offen offset:0 sc1
  s_waitcnt vmcnt(24)
  v_mfma_f32_32x32x16_bf16 v[208:223], a[40:43], v[56:59], v[208:223]
  s_mov_b32 s90, 3072
  buffer_load_dwordx4 v[112:115], v245, s[44:47], s90 offen sc1
  v_mfma_f32_32x32x16_bf16 v[224:239], a[44:47], v[56:59], v[224:239]
  buffer_load_dwordx4 a[212:215], v241, s[4:7], s91 offen offset:0 sc1
  s_waitcnt vmcnt(25)
  v_mfma_f32_32x32x16_bf16 a[224:239], a[40:43], v[60:63], a[224:239]
  buffer_load_dwordx4 v[116:119], v246, s[44:47], s90 offen sc1
  v_mfma_f32_32x32x16_bf16 a[240:255], a[44:47], v[60:63], a[240:255]
  buffer_load_dwordx4 a[216:219], v240, s[4:7], s91 offen offset:2048 sc1
  s_waitcnt vmcnt(26)
  v_mfma_f32_32x32x16_bf16 v[208:223], a[48:51], v[64:67], v[208:223]
  s_mov_b32 s90, 10240
  buffer_load_dwordx4 v[120:123], v245, s[44:47], s90 offen sc1
  v_mfma_f32_32x32x16_bf16 v[224:239], a[52:55], v[64:67], v[224:239]
  buffer_load_dwordx4 a[220:223], v241, s[4:7], s91 offen offset:2048 sc1
  s_waitcnt vmcnt(27)
  v_mfma_f32_32x32x16_bf16 a[224:239], a[48:51], v[68:71], a[224:239]
  buffer_load_dwordx4 v[124:127], v246, s[44:47], s90 offen sc1
  v_mfma_f32_32x32x16_bf16 a[240:255], a[52:55], v[68:71], a[240:255]
  s_waitcnt vmcnt(27)
  v_mfma_f32_32x32x16_bf16 v[208:223], a[56:59], v[72:75], v[208:223]
  buffer_load_dword v247, v244, s[40:43], 0 offen offset:256 sc1
  s_mov_b32 s90, 17408
  buffer_load_dwordx4 v[16:19], v245, s[44:47], s90 offen sc1
  v_mfma_f32_32x32x16_bf16 v[224:239], a[60:63], v[72:75], v[224:239]
  s_waitcnt vmcnt(27)
  v_mfma_f32_32x32x16_bf16 a[224:239], a[56:59], v[76:79], a[224:239]
  buffer_load_dwordx4 v[20:23], v246, s[44:47], s90 offen sc1
  v_mfma_f32_32x32x16_bf16 a[240:255], a[60:63], v[76:79], a[240:255]
  s_waitcnt vmcnt(26)
  v_mfma_f32_32x32x16_bf16 v[208:223], a[64:67], v[80:83], v[208:223]
  s_mov_b32 s90, 24576
  buffer_load_dwordx4 v[24:27], v245, s[44:47], s90 offen sc1
  v_mfma_f32_32x32x16_bf16 v[224:239], a[68:71], v[80:83], v[224:239]
  s_waitcnt vmcnt(25)
  v_mfma_f32_32x32x16_bf16 a[224:239], a[64:67], v[84:87], a[224:239]
  buffer_load_dwordx4 v[28:31], v246, s[44:47], s90 offen sc1
  v_mfma_f32_32x32x16_bf16 a[240:255], a[68:71], v[84:87], a[240:255]
  s_waitcnt vmcnt(18)
  v_mov_b32 v254, 1
  s_mov_b64 exec, 1
  buffer_store_dword v254, off, s[40:43], s94 offset:192 sc1
  s_mov_b64 exec, -1
  s_xor_b32 s86, s48, 1
  s_mul_i32 s86, s86, 12288
  v_mfma_f32_32x32x16_bf16 v[208:223], a[72:75], v[88:91], v[208:223]
  s_waitcnt vmcnt(5)
  v_cmp_ne_u32 vcc, 1, v247
  s_nop 0
  s_cmp_eq_u64 vcc, 0
  s_cbranch_scc0 Lc_79
Lr_80:
  s_mov_b32 s90, 4096
  buffer_load_dwordx4 v[32:35], v245, s[44:47], s90 offen sc1
  v_mfma_f32_32x32x16_bf16 v[224:239], a[76:79], v[88:91], v[224:239]
  s_add_u32 s86, s86, 106496
  v_add_u32_e64 v129, s86, v1
  s_xor_b32 s86, s48, 2
  s_mul_i32 s86, s86, 12288
  s_add_u32 s86, s86, 110592
  v_add_u32 v130, s86, v1
  s_xor_b32 s86, s48, 3
  v_mfma_f32_32x32x16_bf16 a[224:239], a[72:75], v[92:95], a[224:239]
  buffer_load_dwordx4 v[36:39], v246, s[44:47], s90 offen sc1
  s_mul_i32 s86, s86, 12288
  s_add_u32 s86, s86, 114688
  v_add_u32_e64 v131, s86, v1
  s_mul_i32 s86, s48, 12288
  s_add_u32 s86, s86, 106496
  v_add_u32_e64 v128, s86, v1
  v_mfma_f32_32x32x16_bf16 a[240:255], a[76:79], v[92:95], a[240:255]
  v_lshlrev_b32_e64 v192, 16, v8
  v_and_b32 v193, 0xffff0000, v8
  v_lshlrev_b32_e64 v194, 16, v9
  v_and_b32 v195, 0xffff0000, v9
  v_lshlrev_b32_e64 v196, 16, v10
  v_and_b32 v197, 0xffff0000, v10
  v_lshlrev_b32_e64 v198, 16, v11
  v_mfma_f32_32x32x16_bf16 v[208:223], a[80:83], v[96:99], v[208:223]
  s_mov_b32 s90, 11264
  buffer_load_dwordx4 v[40:43], v245, s[44:47], s90 offen sc1
  v_and_b32 v199, 0xffff0000, v11
  v_lshlrev_b32_e64 v200, 16, v12
  v_and_b32 v201, 0xffff0000, v12
  v_lshlrev_b32_e64 v202, 16, v13
  v_and_b32 v203, 0xffff0000, v13
  v_mfma_f32_32x32x16_bf16 v[224:239], a[84:87], v[96:99], v[224:239]
  v_lshlrev_b32_e64 v204, 16, v14
  v_and_b32 v205, 0xffff0000, v14
  v_lshlrev_b32_e64 v206, 16, v15
  v_and_b32 v207, 0xffff0000, v15
  v_mfma_f32_32x32x16_bf16 a[224:239], a[80:83], v[100:103], a[224:239]
  buffer_load_dwordx4 v[44:47], v246, s[44:47], s90 offen sc1
  v_mfma_f32_32x32x16_bf16 a[240:255], a[84:87], v[100:103], a[240:255]
  buffer_load_dword v247, v244, s[40:43], 0 offen offset:128 sc1
  s_mov_b32 s90, 18432
  buffer_load_dwordx4 v[48:51], v245, s[44:47], s90 offen sc1
  v_mfma_f32_32x32x16_bf16 v[208:223], a[88:91], v[104:107], v[208:223]
  buffer_load_dwordx4 v[52:55], v246, s[44:47], s90 offen sc1
  v_mfma_f32_32x32x16_bf16 v[224:239], a[92:95], v[104:107], v[224:239]
  v_mfma_f32_32x32x16_bf16 a[224:239], a[88:91], v[108:111], a[224:239]
  s_mov_b32 s90, 25600
  buffer_load_dwordx4 v[56:59], v245, s[44:47], s90 offen sc1
  v_mfma_f32_32x32x16_bf16 a[240:255], a[92:95], v[108:111], a[240:255]
  buffer_load_dwordx4 v[60:63], v246, s[44:47], s90 offen sc1
  v_mfma_f32_32x32x16_bf16 v[208:223], a[96:99], v[112:115], v[208:223]
  s_waitcnt vmcnt(4)
  v_cmp_ne_u32 vcc, 1, v247
  s_nop 0
  s_cmp_eq_u64 vcc, 0
  s_cbranch_scc0 Lc_83
Lr_84:
  s_mov_b32 s90, 5120
  buffer_load_dwordx4 v[64:67], v245, s[44:47], s90 offen sc1
  v_mfma_f32_32x32x16_bf16 v[224:239], a[100:103], v[112:115], v[224:239]
  v_mfma_f32_32x32x16_bf16 a[224:239], a[96:99], v[116:119], a[224:239]
  buffer_load_dwordx4 v[68:71], v246, s[44:47], s90 offen sc1
  v_mfma_f32_32x32x16_bf16 a[240:255], a[100:103], v[116:119], a[240:255]
  s_mov_b32 s90, 12288
  buffer_load_dwordx4 v[72:75], v245, s[44:47], s90 offen sc1
  v_mfma_f32_32x32x16_bf16 v[208:223], a[104:107], v[120:123], v[208:223]
  buffer_load_dwordx4 v[76:79], v246, s[44:47], s90 offen sc1
  v_mfma_f32_32x32x16_bf16 v[224:239], a[108:111], v[120:123], v[224:239]
  v_mfma_f32_32x32x16_bf16 a[224:239], a[104:107], v[124:127], a[224:239]
  buffer_load_dword v247, v244, s[40:43], 0 offen offset:192 sc1
  s_mov_b32 s90, 19456
  buffer_load_dwordx4 v[80:83], v245, s[44:47], s90 offen sc1
  v_mfma_f32_32x32x16_bf16 a[240:255], a[108:111], v[124:127], a[240:255]
  buffer_load_dwordx4 v[84:87], v246, s[44:47], s90 offen sc1
  v_mfma_f32_32x32x16_bf16 v[208:223], a[112:115], v[16:19], v[208:223]
  s_mov_b32 s90, 26624
  buffer_load_dwordx4 v[88:91], v245, s[44:47], s90 offen sc1
  v_mfma_f32_32x32x16_bf16 v[224:239], a[116:119], v[16:19], v[224:239]
  v_mfma_f32_32x32x16_bf16 a[224:239], a[112:115], v[20:23], a[224:239]
  buffer_load_dwordx4 v[92:95], v246, s[44:47], s90 offen sc1
  v_mfma_f32_32x32x16_bf16 a[240:255], a[116:119], v[20:23], a[240:255]
  s_waitcnt vmcnt(4)
  v_cmp_ne_u32 vcc, 1, v247
  s_nop 0
  s_cmp_eq_u64 vcc, 0
  s_cbranch_scc0 Lc_87
Lr_88:
  s_mov_b32 s90, 6144
  buffer_load_dwordx4 v[96:99], v245, s[44:47], s90 offen sc1
  v_mfma_f32_32x32x16_bf16 v[208:223], a[120:123], v[24:27], v[208:223]
  buffer_load_dwordx4 v[100:103], v246, s[44:47], s90 offen sc1
  v_mfma_f32_32x32x16_bf16 v[224:239], a[124:127], v[24:27], v[224:239]
  v_mfma_f32_32x32x16_bf16 a[224:239], a[120:123], v[28:31], a[224:239]
  s_mov_b32 s90, 13312
  buffer_load_dwordx4 v[104:107], v245, s[44:47], s90 offen sc1
  v_mfma_f32_32x32x16_bf16 a[240:255], a[124:127], v[28:31], a[240:255]
  buffer_load_dwordx4 v[108:111], v246, s[44:47], s90 offen sc1
  v_mfma_f32_32x32x16_bf16 v[208:223], a[128:131], v[32:35], v[208:223]
  s_mov_b32 s90, 20480
  buffer_load_dwordx4 v[112:115], v245, s[44:47], s90 offen sc1
  v_mfma_f32_32x32x16_bf16 v[224:239], a[132:135], v[32:35], v[224:239]
  v_mfma_f32_32x32x16_bf16 a[224:239], a[128:131], v[36:39], a[224:239]
  buffer_load_dwordx4 v[116:119], v246, s[44:47], s90 offen sc1
  v_mfma_f32_32x32x16_bf16 a[240:255], a[132:135], v[36:39], a[240:255]
  v_mfma_f32_32x32x16_bf16 v[208:223], a[136:139], v[40:43], v[208:223]
  s_mov_b32 s90, 27648
  buffer_load_dwordx4 v[120:123], v245, s[44:47], s90 offen sc1
  v_mfma_f32_32x32x16_bf16 v[224:239], a[140:143], v[40:43], v[224:239]
  v_mfma_f32_32x32x16_bf16 a[224:239], a[136:139], v[44:47], a[224:239]
  buffer_load_dwordx4 v[124:127], v246, s[44:47], s90 offen sc1
  v_mfma_f32_32x32x16_bf16 a[240:255], a[140:143], v[44:47], a[240:255]
  v_mfma_f32_32x32x16_bf16 v[208:223], a[144:147], v[48:51], v[208:223]
  s_add_u32 m0, s65, 0
  s_nop 0
  buffer_load_dwordx4 v243, s[4:7], m0 offen offset:0 sc1 lds
  v_mfma_f32_32x32x16_bf16 v[224:239], a[148:151], v[48:51], v[224:239]
  v_mfma_f32_32x32x16_bf16 a[224:239], a[144:147], v[52:55], a[224:239]
  buffer_load_dwordx4 v243, s[4:7], m0 offen offset:1024 sc1 lds
  v_mfma_f32_32x32x16_bf16 a[240:255], a[148:151], v[52:55], a[240:255]
  v_mfma_f32_32x32x16_bf16 v[208:223], a[152:155], v[56:59], v[208:223]
  s_add_u32 m0, s65, 8192
  s_nop 0
  buffer_load_dwordx4 v243, s[4:7], m0 offen offset:0 sc1 lds
  v_mfma_f32_32x32x16_bf16 v[224:239], a[156:159], v[56:59], v[224:239]
  v_mfma_f32_32x32x16_bf16 a[224:239], a[152:155], v[60:63], a[224:239]
  buffer_load_dwordx4 v243, s[4:7], m0 offen offset:1024 sc1 lds
  v_mfma_f32_32x32x16_bf16 a[240:255], a[156:159], v[60:63], a[240:255]
  v_mfma_f32_32x32x16_bf16 a[240:255], a[164:167], v[68:71], a[240:255]
  s_add_u32 m0, s65, 16384
  s_nop 0
  buffer_load_dwordx4 v243, s[4:7], m0 offen offset:0 sc1 lds
  v_mfma_f32_32x32x16_bf16 a[240:255], a[172:175], v[76:79], a[240:255]
  s_waitcnt vmcnt(15)
  v_mfma_f32_32x32x16_bf16 a[240:255], a[180:183], v[84:87], a[240:255]
  buffer_load_dwordx4 v243, s[4:7], m0 offen offset:1024 sc1 lds
  s_waitcnt vmcnt(14)
  v_mfma_f32_32x32x16_bf16 a[240:255], a[188:191], v[92:95], a[240:255]
  s_waitcnt vmcnt(12)
  v_mfma_f32_32x32x16_bf16 a[240:255], a[196:199], v[100:103], a[240:255]
  s_add_u32 m0, s65, 24576
  s_nop 0
  buffer_load_dwordx4 v243, s[4:7], m0 offen offset:0 sc1 lds
  s_waitcnt vmcnt(11)
  v_mfma_f32_32x32x16_bf16 a[240:255], a[204:207], v[108:111], a[240:255]
  s_waitcnt vmcnt(9)
  v_mfma_f32_32x32x16_bf16 a[240:255], a[212:215], v[116:119], a[240:255]
  buffer_load_dwordx4 v243, s[4:7], m0 offen offset:1024 sc1 lds
  s_waitcnt vmcnt(8)
  v_mfma_f32_32x32x16_bf16 a[240:255], a[220:223], v[124:127], a[240:255]
  v_mfma_f32_32x32x16_bf16 a[224:239], a[160:163], v[68:71], a[224:239]
  s_add_u32 m0, s65, 32768
  s_nop 0
  buffer_load_dwordx4 v243, s[4:7], m0 offen offset:0 sc1 lds
  v_mfma_f32_32x32x16_bf16 a[224:239], a[168:171], v[76:79], a[224:239]
  ds_write_b128 v131, a[240:243] offset:0
  v_mfma_f32_32x32x16_bf16 a[224:239], a[176:179], v[84:87], a[224:239]
  buffer_load_dwordx4 v243, s[4:7], m0 offen offset:1024 sc1 lds
  v_mfma_f32_32x32x16_bf16 a[224:239], a[184:187], v[92:95], a[224:239]
  ds_write_b128 v131, a[244:247] offset:1024
  v_mfma_f32_32x32x16_bf16 a[224:239], a[192:195], v[100:103], a[224:239]
  s_add_u32 m0, s65, 40960
  s_nop 0
  buffer_load_dwordx4 v243, s[4:7], m0 offen offset:0 sc1 lds
  v_mfma_f32_32x32x16_bf16 a[224:239], a[200:203], v[108:111], a[224:239]
  ds_write_b128 v131, a[248:251] offset:2048
  v_mfma_f32_32x32x16_bf16 a[224:239], a[208:211], v[116:119], a[224:239]
  buffer_load_dwordx4 v243, s[4:7], m0 offen offset:1024 sc1 lds
  v_mfma_f32_32x32x16_bf16 a[224:239], a[216:219], v[124:127], a[224:239]
  ds_write_b128 v131, a[252:255] offset:3072
  v_mfma_f32_32x32x16_bf16 v[224:239], a[164:167], v[64:67], v[224:239]
  s_add_u32 m0, s65, 49152
  s_nop 0
  buffer_load_dwordx4 v243, s[4:7], m0 offen offset:0 sc1 lds
  v_mfma_f32_32x32x16_bf16 v[224:239], a[172:175], v[72:75], v[224:239]
  ds_write_b128 v130, a[224:227] offset:0
  v_mfma_f32_32x32x16_bf16 v[224:239], a[180:183], v[80:83], v[224:239]
  buffer_load_dwordx4 v243, s[4:7], m0 offen offset:1024 sc1 lds
  v_mfma_f32_32x32x16_bf16 v[224:239], a[188:191], v[88:91], v[224:239]
  ds_write_b128 v130, a[228:231] offset:1024
  v_mfma_f32_32x32x16_bf16 v[224:239], a[196:199], v[96:99], v[224:239]
  s_add_u32 m0, s65, 57344
  s_nop 0
  buffer_load_dwordx4 v243, s[4:7], m0 offen offset:0 sc1 lds
  v_mfma_f32_32x32x16_bf16 v[224:239], a[204:207], v[104:107], v[224:239]
  ds_write_b128 v130, a[232:235] offset:2048
  v_mfma_f32_32x32x16_bf16 v[224:239], a[212:215], v[112:115], v[224:239]
  buffer_load_dwordx4 v243, s[4:7], m0 offen offset:1024 sc1 lds
  v_mfma_f32_32x32x16_bf16 v[224:239], a[220:223], v[120:123], v[224:239]
  ds_write_b128 v130, a[236:239] offset:3072
  v_mfma_f32_32x32x16_bf16 v[208:223], a[160:163], v[64:67], v[208:223]
  s_add_u32 m0, s65, 65536
  s_nop 0
  buffer_load_dwordx4 v243, s[4:7], m0 offen offset:0 sc1 lds
  v_mfma_f32_32x32x16_bf16 v[208:223], a[168:171], v[72:75], v[208:223]
  ds_write_b128 v129, v[224:227] offset:0
  v_mfma_f32_32x32x16_bf16 v[208:223], a[176:179], v[80:83], v[208:223]
  buffer_load_dwordx4 v243, s[4:7], m0 offen offset:1024 sc1 lds
  v_mfma_f32_32x32x16_bf16 v[208:223], a[184:187], v[88:91], v[208:223]
  ds_write_b128 v129, v[228:231] offset:1024
  v_mfma_f32_32x32x16_bf16 v[208:223], a[192:195], v[96:99], v[208:223]
  s_add_u32 m0, s65, 73728
  s_nop 0
  buffer_load_dwordx4 v243, s[4:7], m0 offen offset:0 sc1 lds
  v_mfma_f32_32x32x16_bf16 v[208:223], a[200:203], v[104:107], v[208:223]
  ds_write_b128 v129, v[232:235] offset:2048
  v_mfma_f32_32x32x16_bf16 v[208:223], a[208:211], v[112:115], v[208:223]
  buffer_load_dwordx4 v243, s[4:7], m0 offen offset:1024 sc1 lds
  v_mfma_f32_32x32x16_bf16 v[208:223], a[216:219], v[120:123], v[208:223]
  ds_write_b128 v129, v[236:239] offset:3072
  s_waitcnt lgkmcnt(0)
  s_barrier
  ds_read_b128 v[16:19], v128 offset:0
  ds_read_b128 v[20:23], v128 offset:1024
  ds_read_b128 v[24:27], v128 offset:2048
  ds_read_b128 v[28:31], v128 offset:3072
  ds_read_b128 v[32:35], v128 offset:4096
  ds_read_b128 v[36:39], v128 offset:5120
  ds_read_b128 v[40:43], v128 offset:6144
  ds_read_b128 v[44:47], v128 offset:7168
  ds_read_b128 v[48:51], v128 offset:8192
  ds_read_b128 v[52:55], v128 offset:9216
  ds_read_b128 v[56:59], v128 offset:10240
  ds_read_b128 v[60:63], v128 offset:11264
  s_add_u32 s86, s97, 22020096
  s_add_u32 s87, s98, 17301504
  s_add_u32 s96, s99, 16941056
  v_pk_add_f32 v[208:209], v[208:209], v[192:193]
  v_pk_add_f32 v[210:211], v[210:211], v[194:195]
  v_pk_add_f32 v[212:213], v[212:213], v[196:197]
  v_pk_add_f32 v[214:215], v[214:215], v[198:199]
  v_pk_add_f32 v[216:217], v[216:217], v[200:201]
  v_pk_add_f32 v[218:219], v[218:219], v[202:203]
  v_pk_add_f32 v[220:221], v[220:221], v[204:205]
  v_pk_add_f32 v[222:223], v[222:223], v[206:207]
  v_mov_b32 v192, 0
  v_mov_b32 v193, 0
  s_waitcnt lgkmcnt(8)
  v_pk_add_f32 v[208:209], v[208:209], v[16:17]
  v_pk_add_f32 v[210:211], v[210:211], v[18:19]
  v_pk_add_f32 v[212:213], v[212:213], v[20:21]
  v_pk_add_f32 v[214:215], v[214:215], v[22:23]
  v_pk_add_f32 v[216:217], v[216:217], v[24:25]
  v_pk_add_f32 v[218:219], v[218:219], v[26:27]
  v_pk_add_f32 v[220:221], v[220:221], v[28:29]
  v_pk_add_f32 v[222:223], v[222:223], v[30:31]
  s_waitcnt lgkmcnt(4)
  v_pk_add_f32 v[208:209], v[208:209], v[32:33]
  v_pk_add_f32 v[210:211], v[210:211], v[34:35]
  v_pk_add_f32 v[212:213], v[212:213], v[36:37]
  v_pk_add_f32 v[214:215], v[214:215], v[38:39]
  v_pk_add_f32 v[216:217], v[216:217], v[40:41]
  v_pk_add_f32 v[218:219], v[218:219], v[42:43]
  v_pk_add_f32 v[220:221], v[220:221], v[44:45]
  v_pk_add_f32 v[222:223], v[222:223], v[46:47]
  s_waitcnt lgkmcnt(0)
  v_pk_add_f32 v[208:209], v[208:209], v[48:49]
  v_pk_add_f32 v[210:211], v[210:211], v[50:51]
  v_pk_add_f32 v[212:213], v[212:213], v[52:53]
  v_pk_add_f32 v[214:215], v[214:215], v[54:55]
  v_pk_add_f32 v[216:217], v[216:217], v[56:57]
  v_pk_add_f32 v[218:219], v[218:219], v[58:59]
  v_pk_add_f32 v[220:221], v[220:221], v[60:61]
  v_pk_add_f32 v[222:223], v[222:223], v[62:63]
  v_cvt_pk_bf16_f32 v8, v208, v209
  v_cvt_pk_bf16_f32 v9, v210, v211
  v_cvt_pk_bf16_f32 v10, v212, v213
  v_cvt_pk_bf16_f32 v11, v214, v215
  v_cvt_pk_bf16_f32 v12, v216, v217
  v_cvt_pk_bf16_f32 v13, v218, v219
  v_cvt_pk_bf16_f32 v14, v220, v221
  v_cvt_pk_bf16_f32 v15, v222, v223
  s_cmp_lg_u32 s53, 0
  s_cbranch_scc1 L_final_s
  buffer_store_dwordx4 v[8:11], v1, s[44:47], s86 offen sc1
  buffer_store_dwordx4 v[12:15], v1, s[44:47], s86 offen offset:1024 sc1
  v_dot2c_f32_bf16 v192, s84, v8
  v_dot2c_f32_bf16 v193, v8, v8
  v_dot2c_f32_bf16 v192, s84, v9
  v_dot2c_f32_bf16 v193, v9, v9
  v_dot2c_f32_bf16 v192, s84, v10
  v_dot2c_f32_bf16 v193, v10, v10
  v_dot2c_f32_bf16 v192, s84, v11
  v_dot2c_f32_bf16 v193, v11, v11
  v_dot2c_f32_bf16 v192, s84, v12
  v_dot2c_f32_bf16 v193, v12, v12
  v_dot2c_f32_bf16 v192, s84, v13
  v_dot2c_f32_bf16 v193, v13, v13
  v_dot2c_f32_bf16 v192, s84, v14
  v_dot2c_f32_bf16 v193, v14, v14
  v_dot2c_f32_bf16 v192, s84, v15
  v_dot2c_f32_bf16 v193, v15, v15
  s_nop 1
  v_mov_b32 v194, v192
  v_mov_b32 v195, v193
  s_nop 0
  v_permlane32_swap_b32 v192, v194
  v_permlane32_swap_b32 v193, v195
  v_pk_add_f32 v[192:193], v[192:193], v[194:195]
  s_mov_b32 exec_hi, 0
  buffer_store_dwordx2 v[192:193], v1, s[44:47], s87 offen sc1
  s_mov_b64 exec, -1
  s_add_u32 m0, s65, 81920
  s_nop 0
  buffer_load_dwordx4 v243, s[4:7], m0 offen offset:0 sc1 lds
  buffer_load_dwordx4 v243, s[4:7], m0 offen offset:1024 sc1 lds
  v_and_b32 v240, 15, v0
  v_min_u32_e64 v240, 13, v240
  v_lshlrev_b32 v240, 5, v240
  s_lshl_b32 s88, s56, 9
  s_add_u32 s88, s88, 16941056
  s_lshl_b32 s89, s56, 12
  s_add_u32 s89, s89, 17301504
  s_mul_i32 s90, s56, 28672
  s_add_u32 s90, s90, 22020096
  s_and_b32 s86, s64, 0x400
  v_add_u32 v206, s86, v1
  v_xor_b32 v207, 0x400, v206
  v_and_b32_e64 v210, 27, v0
  v_cmp_eq_u32 vcc, 26, v210
  s_nop 1
  v_cndmask_b32 v210, 0, 1.0, vcc
  v_mov_b32_e64 v211, v210
  s_add_u32 s86, s66, 90112
  v_and_b32_e64 v208, 31, v0
  v_lshl_add_u32 v208, v208, 2, s86
  v_lshrrev_b32_e64 v209, 5, v0
  v_lshl_add_u32 v209, v209, 4, s86
  s_add_u32 s86, s68, 0xfffe6000
  v_add_u32 v204, s86, v1
  s_waitcnt vmcnt(2)
  v_mov_b32 v254, 1
  s_mov_b64 exec, 1
  buffer_store_dword v254, off, s[40:43], s96 offset:0 sc1
  s_mov_b64 exec, -1
L_p4skipNone_s:
  s_cmp_lg_u32 s53, 0
  s_cbranch_scc1 L_done
  s_mov_b32 s53, 1
Lpoll_91:
  buffer_load_dword v254, v240, s[40:43], s88 offen offset:0 sc1
  s_sub_u32 s54, s54, 1
  s_max_i32 s54, s54, 0
  s_cselect_b64 s[92:93], exec, 0
  s_waitcnt vmcnt(0)
  v_cmp_ne_u32 vcc, 1, v254
  s_nop 0
  s_and_b64 exec, s[92:93], vcc
  s_cbranch_scc1 Lpoll_91
  s_mov_b64 exec, -1
  buffer_load_dwordx4 v[16:19], v1, s[44:47], s90 offen offset:0 sc1
  buffer_load_dwordx4 v[20:23], v1, s[44:47], s90 offen offset:1024 sc1
  buffer_load_dwordx4 v[24:27], v1, s[44:47], s90 offen offset:2048 sc1
  buffer_load_dwordx4 v[28:31], v1, s[44:47], s90 offen offset:3072 sc1
  s_add_u32 s40, s40, 16777216
  s_addc_u32 s41, s41, 0
  s_barrier
  ds_read_b128 v[176:179], v1 offset:0
  ds_read_b128 v[180:183], v1 offset:1024
  ds_read_b128 v[184:187], v1 offset:3072
  ds_read_b128 v[188:191], v1 offset:4096
  s_add_u32 s90, s90, 4096
  buffer_load_dwordx4 v[32:35], v1, s[44:47], s90 offen offset:0 sc1
  buffer_load_dwordx4 v[36:39], v1, s[44:47], s90 offen offset:1024 sc1
  buffer_load_dwordx4 v[40:43], v1, s[44:47], s90 offen offset:2048 sc1
  buffer_load_dwordx4 v[44:47], v1, s[44:47], s90 offen offset:3072 sc1
  s_waitcnt vmcnt(7) lgkmcnt(2)
  v_mfma_f32_32x32x16_bf16 v[128:143], v[16:19], v[176:179], 0
  ds_read_b128 v[192:195], v1 offset:6144
  s_add_u32 s90, s90, 4096
  buffer_load_dwordx4 v[48:51], v1, s[44:47], s90 offen offset:0 sc1
  v_mfma_f32_32x32x16_bf16 v[144:159], v[16:19], v[180:183], 0
  ds_read_b128 v[196:199], v1 offset:7168
  buffer_load_dwordx4 v[216:219], v1, s[44:47], s89 offen offset:0 sc1
  s_waitcnt vmcnt(8) lgkmcnt(2)
  v_mfma_f32_32x32x16_bf16 v[128:143], v[20:23], v[184:187], v[128:143]
  ds_read_b128 v[176:179], v1 offset:9216
  buffer_load_dwordx4 v[52:55], v1, s[44:47], s90 offen offset:1024 sc1
  v_mfma_f32_32x32x16_bf16 v[144:159], v[20:23], v[188:191], v[144:159]
  ds_read_b128 v[180:183], v1 offset:10240
  s_waitcnt vmcnt(8) lgkmcnt(2)
  v_mfma_f32_32x32x16_bf16 v[128:143], v[24:27], v[192:195], v[128:143]
  ds_read_b128 v[184:187], v1 offset:12288
  buffer_load_dwordx4 v[56:59], v1, s[44:47], s90 offen offset:2048 sc1
  v_mfma_f32_32x32x16_bf16 v[144:159], v[24:27], v[196:199], v[144:159]
  ds_read_b128 v[188:191], v1 offset:13312
  buffer_load_dwordx4 v[220:223], v1, s[44:47], s89 offen offset:1024 sc1
  s_waitcnt vmcnt(9) lgkmcnt(2)
  v_mfma_f32_32x32x16_bf16 v[128:143], v[28:31], v[176:179], v[128:143]
  ds_read_b128 v[192:195], v1 offset:15360
  buffer_load_dwordx4 v[60:63], v1, s[44:47], s90 offen offset:3072 sc1
  v_mfma_f32_32x32x16_bf16 v[144:159], v[28:31], v[180:183], v[144:159]
  ds_read_b128 v[196:199], v1 offset:16384
  s_waitcnt vmcnt(9) lgkmcnt(2)
  v_mfma_f32_32x32x16_bf16 v[128:143], v[32:35], v[184:187], v[128:143]
  ds_read_b128 v[176:179], v1 offset:18432
  s_add_u32 s90, s90, 4096
  buffer_load_dwordx4 v[64:67], v1, s[44:47], s90 offen offset:0 sc1
  v_mfma_f32_32x32x16_bf16 v[144:159], v[32:35], v[188:191], v[144:159]
  ds_read_b128 v[180:183], v1 offset:19456
  buffer_load_dwordx4 v[224:227], v1, s[44:47], s89 offen offset:2048 sc1
  s_waitcnt vmcnt(10) lgkmcnt(2)
  v_mfma_f32_32x32x16_bf16 v[128:143], v[36:39], v[192:195], v[128:143]
  ds_read_b128 v[184:187], v1 offset:21504
  buffer_load_dwordx4 v[68:71], v1, s[44:47], s90 offen offset:1024 sc1
  v_mfma_f32_32x32x16_bf16 v[144:159], v[36:39], v[196:199], v[144:159]
  ds_read_b128 v[188:191], v1 offset:22528
  s_waitcnt vmcnt(10) lgkmcnt(2)
  v_mfma_f32_32x32x16_bf16 v[128:143], v[40:43], v[176:179], v[128:143]
  ds_read_b128 v[192:195], v1 offset:24576
  buffer_load_dwordx4 v[72:75], v1, s[44:47], s90 offen offset:2048 sc1
  v_mfma_f32_32x32x16_bf16 v[144:159], v[40:43], v[180:183], v[144:159]
  ds_read_b128 v[196:199], v1 offset:25600
  buffer_load_dwordx4 v[228:231], v1, s[44:47], s89 offen offset:3072 sc1
  s_waitcnt vmcnt(11) lgkmcnt(2)
  v_mfma_f32_32x32x16_bf16 v[128:143], v[44:47], v[184:187], v[128:143]
  ds_read_b128 v[176:179], v1 offset:27648
  buffer_load_dwordx4 v[76:79], v1, s[44:47], s90 offen offset:3072 sc1
  v_mfma_f32_32x32x16_bf16 v[144:159], v[44:47], v[188:191], v[144:159]
  ds_read_b128 v[180:183], v1 offset:28672
  s_waitcnt vmcnt(11) lgkmcnt(2)
  v_mfma_f32_32x32x16_bf16 v[128:143], v[48:51], v[192:195], v[128:143]
  ds_read_b128 v[184:187], v1 offset:30720
  s_add_u32 s90, s90, 4096
  buffer_load_dwordx4 v[80:83], v1, s[44:47], s90 offen offset:0 sc1
  v_mfma_f32_32x32x16_bf16 v[144:159], v[48:51], v[196:199], v[144:159]
  ds_read_b128 v[188:191], v1 offset:31744
  s_waitcnt vmcnt(10) lgkmcnt(2)
  v_mfma_f32_32x32x16_bf16 v[128:143], v[52:55], v[176:179], v[128:143]
  ds_read_b128 v[192:195], v1 offset:33792
  buffer_load_dwordx4 v[84:87], v1, s[44:47], s90 offen offset:1024 sc1
  v_mfma_f32_32x32x16_bf16 v[144:159], v[52:55], v[180:183], v[144:159]
  ds_read_b128 v[196:199], v1 offset:34816
  s_waitcnt vmcnt(10) lgkmcnt(2)
  v_mfma_f32_32x32x16_bf16 v[128:143], v[56:59], v[184:187], v[128:143]
  ds_read_b128 v[176:179], v1 offset:36864
  buffer_load_dwordx4 v[88:91], v1, s[44:47], s90 offen offset:2048 sc1
  v_mfma_f32_32x32x16_bf16 v[144:159], v[56:59], v[188:191], v[144:159]
  ds_read_b128 v[180:183], v1 offset:37888
  s_waitcnt vmcnt(9) lgkmcnt(2)
  v_mfma_f32_32x32x16_bf16 v[128:143], v[60:63], v[192:195], v[128:143]
  ds_read_b128 v[184:187], v1 offset:39936
  buffer_load_dwordx4 v[92:95], v1, s[44:47], s90 offen offset:3072 sc1
  v_mfma_f32_32x32x16_bf16 v[144:159], v[60:63], v[196:199], v[144:159]
  ds_read_b128 v[188:191], v1 offset:40960
  s_waitcnt vmcnt(9) lgkmcnt(2)
  v_mfma_f32_32x32x16_bf16 v[128:143], v[64:67], v[176:179], v[128:143]
  ds_read_b128 v[192:195], v1 offset:43008
  s_add_u32 s90, s90, 4096
  buffer_load_dwordx4 v[96:99], v1, s[44:47], s90 offen offset:0 sc1
  v_mfma_f32_32x32x16_bf16 v[144:159], v[64:67], v[180:183], v[144:159]
  ds_read_b128 v[196:199], v1 offset:44032
  s_waitcnt vmcnt(8) lgkmcnt(2)
  v_mfma_f32_32x32x16_bf16 v[128:143], v[68:71], v[184:187], v[128:143]
  ds_read_b128 v[176:179], v1 offset:46080
  buffer_load_dwordx4 v[100:103], v1, s[44:47], s90 offen offset:1024 sc1
  v_mfma_f32_32x32x16_bf16 v[144:159], v[68:71], v[188:191], v[144:159]
  ds_read_b128 v[180:183], v1 offset:47104
  s_waitcnt vmcnt(8) lgkmcnt(2)
  v_mfma_f32_32x32x16_bf16 v[128:143], v[72:75], v[192:195], v[128:143]
  ds_read_b128 v[184:187], v1 offset:49152
  buffer_load_dwordx4 v[104:107], v1, s[44:47], s90 offen offset:2048 sc1
  v_mfma_f32_32x32x16_bf16 v[144:159], v[72:75], v[196:199], v[144:159]
  ds_read_b128 v[188:191], v1 offset:50176
  s_waitcnt vmcnt(8)
  s_waitcnt vmcnt(7) lgkmcnt(2)
  v_mfma_f32_32x32x16_bf16 v[128:143], v[76:79], v[176:179], v[128:143]
  ds_read_b128 v[192:195], v1 offset:52224
  buffer_load_dwordx4 v[108:111], v1, s[44:47], s90 offen offset:3072 sc1
  v_add_f32 v216, v216, v218
  v_add_f32 v217, v217, v219
  v_add_f32 v216, v216, v220
  v_add_f32 v217, v217, v221
  v_add_f32_e64 v216, v216, v222
  v_mfma_f32_32x32x16_bf16 v[144:159], v[76:79], v[180:183], v[144:159]
  ds_read_b128 v[196:199], v1 offset:53248
  v_add_f32 v217, v217, v223
  v_add_f32 v216, v216, v224
  v_add_f32 v217, v217, v225
  v_add_f32 v216, v216, v226
  v_add_f32_e64 v217, v217, v227
  v_add_f32 v216, v216, v228
  s_waitcnt vmcnt(7) lgkmcnt(2)
  v_mfma_f32_32x32x16_bf16 v[128:143], v[80:83], v[184:187], v[128:143]
  ds_read_b128 v[176:179], v1 offset:55296
  s_add_u32 s90, s90, 4096
  buffer_load_dwordx4 v[112:115], v1, s[44:47], s90 offen offset:0 sc1
  v_add_f32 v217, v217, v229
  v_mov_b32 v218, v216
  v_mov_b32_e64 v219, v217
  s_nop 0
  v_permlane32_swap_b32 v216, v218
  v_mfma_f32_32x32x16_bf16 v[144:159], v[80:83], v[188:191], v[144:159]
  ds_read_b128 v[180:183], v1 offset:56320
  v_permlane32_swap_b32 v217, v219
  v_add_f32 v216, v216, v218
  v_add_f32_e64 v217, v217, v219
  v_mul_f32 v216, 0x3b124925, v216
  v_mul_f32 v217, 0x3b124925, v217
  v_fma_f32 v217, -v216, v216, v217
  s_waitcnt vmcnt(7) lgkmcnt(2)
  v_mfma_f32_32x32x16_bf16 v[128:143], v[84:87], v[192:195], v[128:143]
  ds_read_b128 v[184:187], v1 offset:58368
  buffer_load_dwordx4 v[116:119], v1, s[44:47], s90 offen offset:1024 sc1
  v_max_f32 v217, 0, v217
  v_add_f32 v217, 0x3727c5ac, v217
  v_rsq_f32_e64 v248, v217
  v_cvt_pk_bf16_f32 v200, -v216, -v216
  v_mfma_f32_32x32x16_bf16 v[144:159], v[84:87], v[196:199], v[144:159]
  ds_read_b128 v[188:191], v1 offset:59392
  v_mul_f32_e64 v250, v217, v248
  v_mul_f32 v249, 0x3fb8aa3b, v248
  v_mov_b32 v201, v200
  v_mov_b32 v202, v200
  v_mov_b32 v203, v200
  s_waitcnt vmcnt(7) lgkmcnt(2)
  v_mfma_f32_32x32x16_bf16 v[128:143], v[88:91], v[176:179], v[128:143]
  ds_read_b128 v[192:195], v1 offset:61440
  buffer_load_dwordx4 v[120:123], v1, s[44:47], s90 offen offset:2048 sc1
  v_mfma_f32_32x32x16_bf16 v[144:159], v[88:91], v[180:183], v[144:159]
  ds_read_b128 v[196:199], v1 offset:62464
  s_waitcnt vmcnt(7) lgkmcnt(2)
  v_mfma_f32_32x32x16_bf16 v[128:143], v[92:95], v[184:187], v[128:143]
  ds_read_b128 v[176:179], v1 offset:64512
  buffer_load_dwordx4 v[124:127], v1, s[44:47], s90 offen offset:3072 sc1
  v_mfma_f32_32x32x16_bf16 v[144:159], v[92:95], v[188:191], v[144:159]
  ds_read_b128 v[180:183], v2 offset:0
  s_waitcnt vmcnt(7) lgkmcnt(2)
  v_mfma_f32_32x32x16_bf16 v[128:143], v[96:99], v[192:195], v[128:143]
  v_and_b32 v205, 3, v0
  v_lshlrev_b32 v205, 7, v205
  ds_read_b128 v[184:187], v2 offset:2048
  global_load_dword v212, v205, s[100:101]
  v_mfma_f32_32x32x16_bf16 v[144:159], v[96:99], v[196:199], v[144:159]
  ds_read_b128 v[188:191], v2 offset:3072
  s_waitcnt vmcnt(7) lgkmcnt(2)
  v_mfma_f32_32x32x16_bf16 v[128:143], v[100:103], v[176:179], v[128:143]
  s_add_u32 m0, s65, 106496
  ds_read_b128 v[192:195], v2 offset:5120
  buffer_load_dwordx4 v204, s[4:7], m0 offen offset:0 sc1 lds
  v_mfma_f32_32x32x16_bf16 v[144:159], v[100:103], v[180:183], v[144:159]
  ds_read_b128 v[196:199], v2 offset:6144
  s_waitcnt vmcnt(7) lgkmcnt(2)
  v_mfma_f32_32x32x16_bf16 v[128:143], v[104:107], v[184:187], v[128:143]
  ds_read_b128 v[176:179], v2 offset:8192
  buffer_load_dwordx4 v204, s[4:7], m0 offen offset:1024 sc1 lds
  v_mfma_f32_32x32x16_bf16 v[144:159], v[104:107], v[188:191], v[144:159]
  ds_read_b128 v[180:183], v2 offset:9216
  s_waitcnt vmcnt(7) lgkmcnt(2)
  v_mfma_f32_32x32x16_bf16 v[128:143], v[108:111], v[192:195], v[128:143]
  s_add_u32 m0, s65, 114688
  ds_read_b128 v[184:187], v2 offset:11264
  buffer_load_dwordx4 v204, s[4:7], m0 offen offset:0 sc1 lds
  v_mfma_f32_32x32x16_bf16 v[144:159], v[108:111], v[196:199], v[144:159]
  ds_read_b128 v[188:191], v2 offset:12288
  ds_write2_b32 v208, v248, v249 offset0:0 offset1:32
  s_waitcnt vmcnt(7) lgkmcnt(3)
  v_mfma_f32_32x32x16_bf16 v[128:143], v[112:115], v[176:179], v[128:143]
  ds_read_b128 v[192:195], v2 offset:14336
  buffer_load_dwordx4 v204, s[4:7], m0 offen offset:1024 sc1 lds
  v_mfma_f32_32x32x16_bf16 v[144:159], v[112:115], v[180:183], v[144:159]
  ds_read_b128 v[196:199], v2 offset:15360
  ds_read_b128 v[160:163], v209 offset:0
  ds_read_b128 v[216:219], v209 offset:128
  s_waitcnt vmcnt(7) lgkmcnt(5)
  v_mfma_f32_32x32x16_bf16 v[128:143], v[116:119], v[184:187], v[128:143]
  s_add_u32 m0, s65, 122880
  ds_read_b128 v[176:179], v2 offset:17408
  buffer_load_dwordx4 v204, s[4:7], m0 offen offset:0 sc1 lds
  v_mfma_f32_32x32x16_bf16 v[144:159], v[116:119], v[188:191], v[144:159]
  ds_read_b128 v[180:183], v2 offset:18432
  ds_read_b128 v[164:167], v209 offset:32
  ds_read_b128 v[220:223], v209 offset:160
  s_waitcnt vmcnt(7) lgkmcnt(6)
  v_mfma_f32_32x32x16_bf16 v[128:143], v[120:123], v[192:195], v[128:143]
  v_add_u32 v252, 0x15000, v5
  ds_read2_b32 v[184:185], v252 offset0:0 offset1:32
  ds_read2_b32 v[186:187], v252 offset0:64 offset1:96
  buffer_load_dwordx4 v204, s[4:7], m0 offen offset:1024 sc1 lds
  v_mfma_f32_32x32x16_bf16 v[144:159], v[120:123], v[196:199], v[144:159]
  v_add_u32 v253, 0x15400, v5
  ds_read2_b32 v[188:189], v253 offset0:0 offset1:32
  ds_read2_b32 v[190:191], v253 offset0:64 offset1:96
  ds_read_b128 v[168:171], v209 offset:64
  ds_read_b128 v[224:227], v209 offset:192
  s_waitcnt vmcnt(7) lgkmcnt(8)
  v_mfma_f32_32x32x16_bf16 v[128:143], v[124:127], v[176:179], v[128:143]
  s_add_u32 m0, s65, 131072
  s_nop 0
  buffer_load_dwordx4 v204, s[4:7], m0 offen offset:0 sc1 lds
  v_mfma_f32_32x32x16_bf16 v[144:159], v[124:127], v[180:183], v[144:159]
  ds_read_b128 v[172:175], v209 offset:96
  ds_read_b128 v[228:231], v209 offset:224
  s_waitcnt lgkmcnt(4)
  v_mfma_f32_32x32x16_bf16 v[128:143], v[200:203], v[184:187], v[128:143]
  buffer_load_dwordx4 v204, s[4:7], m0 offen offset:1024 sc1 lds
  v_mfma_f32_32x32x16_bf16 v[144:159], v[200:203], v[188:191], v[144:159]
  ds_read_b128 v[176:179], v1 offset:2048
  ds_read_b128 v[180:183], v1 offset:5120
  ds_read_b128 v[184:187], v1 offset:8192
  ds_read_b128 v[188:191], v1 offset:11264
  s_lshl_b32 s87, s50, 12
  s_add_u32 s87, s87, s64
  s_waitcnt lgkmcnt(4)
  v_pk_mul_f32 v[128:129], v[128:129], v[216:217]
  v_pk_mul_f32 v[130:131], v[130:131], v[218:219]
  v_pk_mul_f32 v[132:133], v[132:133], v[220:221]
  v_pk_mul_f32 v[134:135], v[134:135], v[222:223]
  v_pk_mul_f32 v[136:137], v[136:137], v[224:225]
  v_pk_mul_f32 v[138:139], v[138:139], v[226:227]
  v_pk_mul_f32 v[140:141], v[140:141], v[228:229]
  v_pk_mul_f32 v[142:143], v[142:143], v[230:231]
  v_exp_f32_e64 v216, v128 clamp
  v_max_f32_e64 v128, 0, v128
  s_add_u32 m0, s65, 139264
  s_nop 0
  buffer_load_dwordx4 v204, s[4:7], m0 offen offset:0 sc1 lds
  v_exp_f32_e64 v217, v129 clamp
  v_max_f32 v129, 0, v129
  v_exp_f32_e64 v218, v130 clamp
  v_max_f32_e64 v130, 0, v130
  v_exp_f32_e64 v219, v131 clamp
  v_max_f32_e64 v131, 0, v131
  v_exp_f32_e64 v220, v132 clamp
  v_max_f32_e64 v132, 0, v132
  v_exp_f32_e64 v221, v133 clamp
  v_max_f32_e64 v133, 0, v133
  buffer_load_dwordx4 v204, s[4:7], m0 offen offset:1024 sc1 lds
  v_exp_f32_e64 v222, v134 clamp
  v_max_f32_e64 v134, 0, v134
  v_exp_f32_e64 v223, v135 clamp
  v_max_f32_e64 v135, 0, v135
  v_exp_f32_e64 v224, v136 clamp
  v_max_f32_e64 v136, 0, v136
  v_exp_f32_e64 v225, v137 clamp
  v_max_f32_e64 v137, 0, v137
  v_exp_f32_e64 v226, v138 clamp
  v_max_f32_e64 v138, 0, v138
  s_add_u32 m0, s65, 147456
  s_nop 0
  buffer_load_dwordx4 v204, s[4:7], m0 offen offset:0 sc1 lds
  v_exp_f32_e64 v227, v139 clamp
  v_max_f32 v139, 0, v139
  v_exp_f32_e64 v228, v140 clamp
  v_max_f32_e64 v140, 0, v140
  v_exp_f32_e64 v229, v141 clamp
  v_max_f32_e64 v141, 0, v141
  v_exp_f32_e64 v230, v142 clamp
  v_max_f32_e64 v142, 0, v142
  v_exp_f32_e64 v231, v143 clamp
  v_max_f32_e64 v143, 0, v143
  buffer_load_dwordx4 v204, s[4:7], m0 offen offset:1024 sc1 lds
  v_pk_fma_f32 v[144:145], v[144:145], v[160:161], v[210:211]
  v_pk_fma_f32 v[216:217], v[128:129], s[60:61], v[216:217]
  v_pk_fma_f32 v[146:147], v[146:147], v[162:163], v[210:211]
  v_pk_fma_f32 v[218:219], v[130:131], s[60:61], v[218:219]
  v_pk_fma_f32 v[148:149], v[148:149], v[164:165], v[210:211]
  v_pk_fma_f32 v[220:221], v[132:133], s[60:61], v[220:221]
  v_pk_fma_f32 v[150:151], v[150:151], v[166:167], v[210:211]
  v_pk_fma_f32 v[222:223], v[134:135], s[60:61], v[222:223]
  v_pk_fma_f32 v[152:153], v[152:153], v[168:169], v[210:211]
  v_pk_fma_f32 v[224:225], v[136:137], s[60:61], v[224:225]
  v_pk_fma_f32 v[154:155], v[154:155], v[170:171], v[210:211]
  v_pk_fma_f32 v[226:227], v[138:139], s[60:61], v[226:227]
  v_pk_fma_f32 v[156:157], v[156:157], v[172:173], v[210:211]
  v_pk_fma_f32 v[228:229], v[140:141], s[60:61], v[228:229]
  v_pk_fma_f32 v[158:159], v[158:159], v[174:175], v[210:211]
  v_pk_fma_f32 v[230:231], v[142:143], s[60:61], v[230:231]
  s_add_u32 m0, s65, 155648
  s_nop 0
  buffer_load_dwordx4 v204, s[4:7], m0 offen offset:0 sc1 lds
  v_pk_add_f32 v[216:217], v[216:217], s[62:63]
  v_cvt_pk_bf16_f32 v144, v144, v145
  v_pk_add_f32 v[218:219], v[218:219], s[62:63]
  v_cvt_pk_bf16_f32 v145, v146, v147
  v_pk_add_f32 v[220:221], v[220:221], s[62:63]
  v_cvt_pk_bf16_f32 v146, v148, v149
  v_pk_add_f32 v[222:223], v[222:223], s[62:63]
  v_cvt_pk_bf16_f32 v147, v150, v151
  v_pk_add_f32 v[224:225], v[224:225], s[62:63]
  v_cvt_pk_bf16_f32 v148, v152, v153
  v_pk_add_f32 v[226:227], v[226:227], s[62:63]
  v_cvt_pk_bf16_f32 v149, v154, v155
  v_pk_add_f32 v[228:229], v[228:229], s[62:63]
  v_cvt_pk_bf16_f32 v150, v156, v157
  v_pk_add_f32 v[230:231], v[230:231], s[62:63]
  v_cvt_pk_bf16_f32 v151, v158, v159
  buffer_load_dwordx4 v204, s[4:7], m0 offen offset:1024 sc1 lds
  v_cvt_pk_bf16_f32 v128, v216, v217
  v_cvt_pk_bf16_f32 v129, v218, v219
  v_cvt_pk_bf16_f32 v130, v220, v221
  v_cvt_pk_bf16_f32 v131, v222, v223
  s_nop 1
  v_mfma_f32_32x32x16_bf16 v[232:247], v[128:131], v[144:147], 0
  v_cvt_pk_bf16_f32 v132, v224, v225
  v_cvt_pk_bf16_f32 v133, v226, v227
  v_cvt_pk_bf16_f32 v134, v228, v229
  v_cvt_pk_bf16_f32 v135, v230, v231
  s_add_u32 s86, s66, 90112
  v_add_u32_e64 v208, s86, v1
  v_mfma_f32_32x32x16_bf16 v[232:247], v[132:135], v[148:151], v[232:247]
  s_add_u32 s86, s64, 90112
  v_add_u32 v209, s86, v6
  s_waitcnt lgkmcnt(3)
  v_mfma_f32_32x32x16_bf16 v[160:175], v[176:179], v[16:19], 0
  ds_read_b128 v[192:195], v1 offset:14336
  s_nop 2
  ds_write_b128 v208, v[232:235] offset:0
  ds_write_b128 v208, v[236:239] offset:1024
  ds_write_b128 v208, v[240:243] offset:2048
  ds_write_b128 v208, v[244:247] offset:3072
  s_waitcnt lgkmcnt(7)
  v_mfma_f32_32x32x16_bf16 v[160:175], v[180:183], v[20:23], v[160:175]
  ds_read_b128 v[196:199], v1 offset:17408
  s_waitcnt lgkmcnt(1)
  s_barrier
  ds_read2st64_b32 v[216:217], v209 offset0:0 offset1:1
  ds_read2st64_b32 v[218:219], v209 offset0:2 offset1:3
  ds_read2st64_b32 v[220:221], v209 offset0:16 offset1:17
  ds_read2st64_b32 v[222:223], v209 offset0:18 offset1:19
  ds_read2st64_b32 v[224:225], v209 offset0:32 offset1:33
  ds_read2st64_b32 v[226:227], v209 offset0:34 offset1:35
  ds_read2st64_b32 v[228:229], v209 offset0:48 offset1:49
  ds_read2st64_b32 v[230:231], v209 offset0:50 offset1:51
  v_mfma_f32_32x32x16_bf16 v[160:175], v[184:187], v[24:27], v[160:175]
  ds_read_b128 v[176:179], v1 offset:20480
  s_waitcnt lgkmcnt(1)
  v_add_f32 v216, v216, v220
  v_add_f32 v224, v224, v228
  v_add_f32 v217, v217, v221
  v_add_f32 v225, v225, v229
  v_add_f32 v218, v218, v222
  v_add_f32 v226, v226, v230
  v_add_f32 v219, v219, v223
  v_add_f32 v227, v227, v231
  v_add_f32 v216, v216, v224
  v_add_f32 v217, v217, v225
  v_add_f32 v218, v218, v226
  v_add_f32_e64 v219, v219, v227
  buffer_atomic_add_f32 v216, v6, s[40:43], s87 offen offset:0
  buffer_atomic_add_f32 v217, v6, s[40:43], s87 offen offset:256
  buffer_atomic_add_f32 v218, v6, s[40:43], s87 offen offset:512
  buffer_atomic_add_f32 v219, v6, s[40:43], s87 offen offset:768
  v_mfma_f32_32x32x16_bf16 v[160:175], v[188:191], v[28:31], v[160:175]
  ds_read_b128 v[180:183], v1 offset:23552
  s_add_u32 s91, s69, 0
  buffer_load_dwordx4 v[16:19], v206, s[4:7], s91 offen offset:0 sc1
  s_lshl_b32 s73, s50, 8
  s_lshl_b32 s87, s71, 4
  s_add_u32 s73, s73, s87
  s_add_u32 s73, s73, 65536
  v_mfma_f32_32x32x16_bf16 v[160:175], v[192:195], v[32:35], v[160:175]
  ds_read_b128 v[184:187], v1 offset:26624
  s_cmp_lg_u32 s48, 3
  s_cselect_b32 s73, 0x40000000, s73
  s_lshl_b32 s86, s56, 15
  s_lshl_b32 s87, s50, 11
  s_add_u32 s86, s86, s87
  s_add_u32 s86, s86, 17825792
  s_lshl_b32 s94, s56, 9
  v_mfma_f32_32x32x16_bf16 v[160:175], v[196:199], v[36:39], v[160:175]
  ds_read_b128 v[188:191], v1 offset:29696
  buffer_load_dwordx4 v[20:23], v207, s[4:7], s91 offen offset:0 sc1
  s_lshl_b32 s87, s50, 5
  s_add_u32 s94, s94, s87
  s_add_u32 s94, s94, 98304
  v_lshlrev_b32_e64 v208, 12, v0
  v_mov_b32 v209, 1
  s_waitcnt lgkmcnt(3)
  v_mfma_f32_32x32x16_bf16 v[160:175], v[176:179], v[40:43], v[160:175]
  ds_read_b128 v[192:195], v1 offset:32768
  v_mov_b32_e64 v251, v249
  v_mov_b32 v135, 0
  s_waitcnt lgkmcnt(3)
  v_mfma_f32_32x32x16_bf16 v[160:175], v[180:183], v[44:47], v[160:175]
  ds_read_b128 v[196:199], v1 offset:35840
  buffer_load_dwordx4 v[24:27], v206, s[4:7], s91 offen offset:2048 sc1
  s_waitcnt lgkmcnt(3)
  v_mfma_f32_32x32x16_bf16 v[160:175], v[184:187], v[48:51], v[160:175]
  ds_read_b128 v[176:179], v1 offset:38912
  s_waitcnt lgkmcnt(3)
  v_mfma_f32_32x32x16_bf16 v[160:175], v[188:191], v[52:55], v[160:175]
  ds_read_b128 v[180:183], v1 offset:41984
  buffer_load_dwordx4 v[28:31], v207, s[4:7], s91 offen offset:2048 sc1
  s_waitcnt lgkmcnt(3)
  v_mfma_f32_32x32x16_bf16 v[160:175], v[192:195], v[56:59], v[160:175]
  ds_read_b128 v[184:187], v1 offset:45056
  s_waitcnt lgkmcnt(3)
  v_mfma_f32_32x32x16_bf16 v[160:175], v[196:199], v[60:63], v[160:175]
  ds_read_b128 v[188:191], v1 offset:48128
  s_add_u32 s91, s69, 4096
  buffer_load_dwordx4 v[32:35], v206, s[4:7], s91 offen offset:0 sc1
  s_waitcnt lgkmcnt(3)
  v_mfma_f32_32x32x16_bf16 v[160:175], v[176:179], v[64:67], v[160:175]
  ds_read_b128 v[192:195], v1 offset:51200
  s_waitcnt lgkmcnt(3)
  v_mfma_f32_32x32x16_bf16 v[160:175], v[180:183], v[68:71], v[160:175]
  ds_read_b128 v[196:199], v1 offset:54272
  buffer_load_dwordx4 v[36:39], v207, s[4:7], s91 offen offset:0 sc1
  s_waitcnt lgkmcnt(3)
  v_mfma_f32_32x32x16_bf16 v[160:175], v[184:187], v[72:75], v[160:175]
  ds_read_b128 v[176:179], v1 offset:57344
  s_waitcnt lgkmcnt(3)
  v_mfma_f32_32x32x16_bf16 v[160:175], v[188:191], v[76:79], v[160:175]
  ds_read_b128 v[180:183], v1 offset:60416
  buffer_load_dwordx4 v[40:43], v206, s[4:7], s91 offen offset:2048 sc1
  s_waitcnt lgkmcnt(3)
  v_mfma_f32_32x32x16_bf16 v[160:175], v[192:195], v[80:83], v[160:175]
  ds_read_b128 v[184:187], v1 offset:63488
  s_waitcnt lgkmcnt(3)
  v_mfma_f32_32x32x16_bf16 v[160:175], v[196:199], v[84:87], v[160:175]
  ds_read_b128 v[188:191], v2 offset:1024
  buffer_load_dwordx4 v[44:47], v207, s[4:7], s91 offen offset:2048 sc1
  s_waitcnt lgkmcnt(3)
  v_mfma_f32_32x32x16_bf16 v[160:175], v[176:179], v[88:91], v[160:175]
  ds_read_b128 v[192:195], v2 offset:4096
  s_waitcnt lgkmcnt(3)
  v_mfma_f32_32x32x16_bf16 v[160:175], v[180:183], v[92:95], v[160:175]
  ds_read_b128 v[196:199], v2 offset:7168
  s_add_u32 s91, s69, 8192
  buffer_load_dwordx4 v[48:51], v206, s[4:7], s91 offen offset:0 sc1
  s_waitcnt lgkmcnt(3)
  v_mfma_f32_32x32x16_bf16 v[160:175], v[184:187], v[96:99], v[160:175]
  ds_read_b128 v[176:179], v2 offset:10240
  s_waitcnt lgkmcnt(3)
  v_mfma_f32_32x32x16_bf16 v[160:175], v[188:191], v[100:103], v[160:175]
  ds_read_b128 v[180:183], v2 offset:13312
  buffer_load_dwordx4 v[52:55], v207, s[4:7], s91 offen offset:0 sc1
  s_waitcnt lgkmcnt(3)
  v_mfma_f32_32x32x16_bf16 v[160:175], v[192:195], v[104:107], v[160:175]
  ds_read_b128 v[184:187], v2 offset:16384
  s_waitcnt vmcnt(10)
  s_barrier
  s_mov_b64 exec, 15
  buffer_store_dword v209, v208, s[40:43], s73 offen sc1
  s_mov_b64 exec, -1
  s_waitcnt lgkmcnt(3)
  v_mfma_f32_32x32x16_bf16 v[160:175], v[196:199], v[108:111], v[160:175]
  ds_read_b128 v[188:191], v2 offset:19456
  buffer_load_dwordx4 v[56:59], v206, s[4:7], s91 offen offset:2048 sc1
  s_waitcnt lgkmcnt(3)
  v_mfma_f32_32x32x16_bf16 v[160:175], v[176:179], v[112:115], v[160:175]
  v_add_u32 v252, 0x15800, v5
  ds_read2_b32 v[192:193], v252 offset0:0 offset1:32
  ds_read2_b32 v[194:195], v252 offset0:64 offset1:96
  s_waitcnt lgkmcnt(4)
  v_mfma_f32_32x32x16_bf16 v[160:175], v[180:183], v[116:119], v[160:175]
  buffer_load_dwordx4 v[60:63], v207, s[4:7], s91 offen offset:2048 sc1
  s_waitcnt lgkmcnt(3)
  v_mfma_f32_32x32x16_bf16 v[160:175], v[184:187], v[120:123], v[160:175]
  s_waitcnt lgkmcnt(2)
  v_mfma_f32_32x32x16_bf16 v[160:175], v[188:191], v[124:127], v[160:175]
  s_add_u32 s91, s69, 12288
  buffer_load_dwordx4 v[64:67], v206, s[4:7], s91 offen offset:0 sc1
  s_waitcnt lgkmcnt(0)
  v_mfma_f32_32x32x16_bf16 v[160:175], v[192:195], v[200:203], v[160:175]
  s_nop 4
  s_nop 6
  v_pk_mul_f32 v[160:161], v[160:161], v[250:251] op_sel:[0,1] op_sel_hi:[1,1]
  v_pk_mul_f32 v[162:163], v[162:163], v[250:251] op_sel:[0,1] op_sel_hi:[1,1]
  v_pk_mul_f32 v[164:165], v[164:165], v[250:251] op_sel:[0,1] op_sel_hi:[1,1]
  v_pk_mul_f32 v[166:167], v[166:167], v[250:251] op_sel:[0,1] op_sel_hi:[1,1]
  v_pk_mul_f32 v[168:169], v[168:169], v[250:251] op_sel:[0,1] op_sel_hi:[1,1]
  v_pk_mul_f32 v[170:171], v[170:171], v[250:251] op_sel:[0,1] op_sel_hi:[1,1]
  v_pk_mul_f32 v[172:173], v[172:173], v[250:251] op_sel:[0,1] op_sel_hi:[1,1]
  v_exp_f32_e64 v216, v160 clamp
  v_max_f32 v160, 0, v160
  v_exp_f32_e64 v217, v161 clamp
  v_max_f32_e64 v161, 0, v161
  v_exp_f32_e64 v218, v162 clamp
  v_max_f32_e64 v162, 0, v162
  v_exp_f32_e64 v219, v163 clamp
  v_max_f32_e64 v163, 0, v163
  v_exp_f32_e64 v220, v164 clamp
  v_max_f32_e64 v164, 0, v164
  v_exp_f32_e64 v221, v165 clamp
  v_max_f32_e64 v165, 0, v165
  v_exp_f32_e64 v222, v166 clamp
  v_max_f32_e64 v166, 0, v166
  v_exp_f32_e64 v223, v167 clamp
  v_max_f32_e64 v167, 0, v167
  v_exp_f32_e64 v224, v168 clamp
  v_max_f32_e64 v168, 0, v168
  v_exp_f32_e64 v225, v169 clamp
  v_max_f32_e64 v169, 0, v169
  v_exp_f32_e64 v226, v170 clamp
  v_max_f32_e64 v170, 0, v170
  v_exp_f32_e64 v227, v171 clamp
  v_max_f32_e64 v171, 0, v171
  v_exp_f32_e64 v228, v172 clamp
  v_max_f32_e64 v172, 0, v172
  v_exp_f32_e64 v229, v173 clamp
  v_max_f32_e64 v173, 0, v173
  v_pk_fma_f32 v[216:217], v[160:161], s[60:61], v[216:217]
  v_pk_fma_f32 v[218:219], v[162:163], s[60:61], v[218:219]
  v_pk_fma_f32 v[220:221], v[164:165], s[60:61], v[220:221]
  v_pk_fma_f32 v[222:223], v[166:167], s[60:61], v[222:223]
  v_pk_fma_f32 v[224:225], v[168:169], s[60:61], v[224:225]
  v_pk_fma_f32 v[226:227], v[170:171], s[60:61], v[226:227]
  v_pk_fma_f32 v[228:229], v[172:173], s[60:61], v[228:229]
  v_pk_add_f32 v[216:217], v[216:217], s[62:63]
  v_pk_add_f32 v[218:219], v[218:219], s[62:63]
  v_pk_add_f32 v[220:221], v[220:221], s[62:63]
  v_pk_add_f32 v[222:223], v[222:223], s[62:63]
  v_pk_add_f32 v[224:225], v[224:225], s[62:63]
  v_pk_add_f32 v[226:227], v[226:227], s[62:63]
  v_pk_add_f32 v[228:229], v[228:229], s[62:63]
  v_cvt_pk_bf16_f32 v128, v216, v217
  v_cvt_pk_bf16_f32 v129, v218, v219
  v_cvt_pk_bf16_f32 v130, v220, v221
  v_cvt_pk_bf16_f32 v131, v222, v223
  v_cvt_pk_bf16_f32 v132, v224, v225
  v_cvt_pk_bf16_f32 v133, v226, v227
  v_cvt_pk_bf16_f32 v134, v228, v229
  buffer_store_dwordx4 v[128:131], v1, s[44:47], s86 offen sc1
  buffer_store_dwordx4 v[132:135], v1, s[44:47], s86 offen offset:1024 sc1
  s_mov_b32 s44, s40
  s_mov_b32 s45, s41
  buffer_load_dwordx4 v[68:71], v207, s[4:7], s91 offen offset:0 sc1
  buffer_load_dwordx4 v[72:75], v206, s[4:7], s91 offen offset:2048 sc1
  buffer_load_dwordx4 v[76:79], v207, s[4:7], s91 offen offset:2048 sc1
  s_barrier
  s_waitcnt vmcnt(3)
  v_mov_b32 v254, 1
  s_mov_b64 exec, 1
  buffer_store_dword v254, off, s[40:43], s94 offset:0 sc1
  s_mov_b64 exec, -1
  s_add_u32 s86, s68, 0xe000
  v_add_u32 v4, s86, v1
  v_and_b32 v240, 3, v0
  v_lshlrev_b32 v240, 5, v240
  v_bfe_u32 v241, v0, 2, 1
  v_lshl_add_u32 v240, v241, 9, v240
  s_lshl_b32 s88, s57, 9
  s_lshl_b32 s86, s48, 7
  s_add_u32 s88, s88, s86
  s_add_u32 s88, s88, 98304
  s_lshl_b32 s90, s58, 15
  s_lshl_b32 s86, s48, 13
  s_add_u32 s90, s90, s86
  s_add_u32 s90, s90, 1048576
  s_xor_b32 s91, s90, 0x8000
  s_add_u32 s74, s72, s64
  s_add_u32 s74, s74, 65536
  s_lshl_b32 s89, s48, 14
  s_branch L_layer_s
L_final_s:
  v_and_b32 v18, 31, v0
  v_lshrrev_b32_e64 v19, 5, v0
  v_mul_u32_u24 v4, 896, v18
  v_lshl_add_u32 v4, v19, 4, v4
  s_mul_i32 s86, s58, 28672
  s_lshl_b32 s87, s59, 6
  s_add_u32 s86, s86, s87
  buffer_store_dwordx4 v[8:11], v4, s[32:35], s86 offen
  buffer_store_dwordx4 v[12:15], v4, s[32:35], s86 offen offset:32
  s_branch L_done
Lc_65:
  s_nop 7
  s_nop 3
  s_add_u32 m0, s65, 0
  s_nop 0
  buffer_load_dwordx4 v4, s[4:7], m0 offen offset:0 sc1 lds
  buffer_load_dwordx4 v4, s[4:7], m0 offen offset:1024 sc1 lds
  s_add_u32 m0, s65, 8192
  s_nop 0
  buffer_load_dwordx4 v4, s[4:7], m0 offen offset:0 sc1 lds
  buffer_load_dwordx4 v4, s[4:7], m0 offen offset:1024 sc1 lds
  s_add_u32 m0, s65, 16384
  s_nop 0
  buffer_load_dwordx4 v4, s[4:7], m0 offen offset:0 sc1 lds
  buffer_load_dwordx4 v4, s[4:7], m0 offen offset:1024 sc1 lds
  s_add_u32 m0, s65, 24576
  s_nop 0
  buffer_load_dwordx4 v4, s[4:7], m0 offen offset:0 sc1 lds
  buffer_load_dwordx4 v4, s[4:7], m0 offen offset:1024 sc1 lds
  s_add_u32 m0, s65, 32768
  s_nop 0
  buffer_load_dwordx4 v4, s[4:7], m0 offen offset:0 sc1 lds
  buffer_load_dwordx4 v4, s[4:7], m0 offen offset:1024 sc1 lds
  s_add_u32 m0, s65, 40960
  s_nop 0
  buffer_load_dwordx4 v4, s[4:7], m0 offen offset:0 sc1 lds
  buffer_load_dwordx4 v4, s[4:7], m0 offen offset:1024 sc1 lds
  s_add_u32 m0, s65, 49152
  s_nop 0
  buffer_load_dwordx4 v4, s[4:7], m0 offen offset:0 sc1 lds
  buffer_load_dwordx4 v4, s[4:7], m0 offen offset:1024 sc1 lds
  v_and_b32 v240, 15, v0
  v_min_u32_e64 v240, 13, v240
  v_lshlrev_b32 v240, 5, v240
  s_lshl_b32 s88, s56, 9
  s_add_u32 s88, s88, 131072
  s_lshl_b32 s89, s56, 12
  s_add_u32 s89, s89, 262144
  s_mul_i32 s90, s56, 28672
  s_add_u32 s90, s90, 3145728
  s_add_u32 s86, s68, 0xe000
  v_add_u32 v229, s86, v1
  s_add_u32 s86, s68, 0xac00
  v_add_u32 v228, s86, v1
  s_cmp_lg_u32 s53, 0
  s_cselect_b32 s86, 0x40000000, s67
  v_add_u32 v243, s86, v1
  s_mul_i32 s73, s56, 114688
  s_mul_i32 s86, s50, 7168
  s_add_u32 s73, s73, s86
  s_add_u32 s73, s73, 7340032
  s_add_u32 s74, s73, 4096
  s_lshl_b32 s94, s56, 9
  s_lshl_b32 s86, s50, 2
  s_add_u32 s94, s94, s86
  s_add_u32 s94, s94, 196608
  s_waitcnt vmcnt(0)
  s_nop 4
  s_branch L_p2skipNone_s
Lc_68:
  s_nop 7
  s_nop 3
Lpoll_70:
  buffer_load_dword v254, v1, s[40:43], s74 offen offset:0 sc1
  s_sub_u32 s54, s54, 1
  s_max_i32 s54, s54, 0
  s_cselect_b64 s[92:93], exec, 0
  s_waitcnt vmcnt(0)
  v_cmp_ne_u32 vcc, 1, v254
  s_nop 0
  s_and_b64 exec, s[92:93], vcc
  s_cbranch_scc1 Lpoll_70
  s_mov_b64 exec, -1
  s_nop 4
  s_branch Lr_69
Lc_74:
  s_nop 7
  s_nop 3
  v_mul_f32 v160, v160, v249
  v_mul_f32 v161, v161, v249
  v_mul_f32 v162, v162, v249
  v_mul_f32 v163, v163, v249
  v_mul_f32 v164, v164, v249
  v_mul_f32 v165, v165, v249
  v_mul_f32 v166, v166, v249
  v_mul_f32 v167, v167, v249
  v_exp_f32_e64 v160, -v160
  v_exp_f32_e64 v161, -v161
  v_exp_f32_e64 v162, -v162
  v_fma_f32 v160, v160, v250, v250
  v_exp_f32_e64 v163, -v163
  v_fma_f32 v161, v161, v250, v250
  v_exp_f32_e64 v164, -v164
  v_fma_f32 v162, v162, v250, v250
  v_exp_f32_e64 v165, -v165
  v_fma_f32 v163, v163, v250, v250
  v_exp_f32_e64 v166, -v166
  v_fma_f32 v164, v164, v250, v250
  v_exp_f32_e64 v167, -v167
  v_fma_f32 v165, v165, v250, v250
  v_fma_f32 v166, v166, v250, v250
  v_fma_f32 v167, v167, v250, v250
  v_rcp_f32 v160, v160
  v_rcp_f32 v161, v161
  v_rcp_f32 v162, v162
  v_mul_f32 v160, v160, v168
  v_rcp_f32 v163, v163
  v_mul_f32 v161, v161, v169
  v_rcp_f32 v164, v164
  v_mul_f32 v162, v162, v170
  v_rcp_f32 v165, v165
  v_mul_f32 v163, v163, v171
  v_rcp_f32 v166, v166
  v_mul_f32 v164, v164, v172
  v_rcp_f32 v167, v167
  v_mul_f32 v165, v165, v173
  v_mul_f32 v166, v166, v174
  v_mul_f32 v167, v167, v175
  v_cvt_pk_bf16_f32 v168, v160, v161
  v_cvt_pk_bf16_f32 v169, v162, v163
  v_cvt_pk_bf16_f32 v170, v164, v165
  v_cvt_pk_bf16_f32 v171, v166, v167
  buffer_store_dwordx4 v[168:171], v1, s[44:47], s74 offen offset:2048 sc1
  s_waitcnt vmcnt(7)
  v_mov_b32_e64 v254, 1
  s_mov_b64 exec, 1
  buffer_store_dword v254, off, s[40:43], s94 offset:128 sc1
  s_mov_b64 exec, -1
  s_barrier
  s_waitcnt vmcnt(0)
  v_mov_b32_e64 v254, 1
  s_mov_b64 exec, 1
  buffer_store_dword v254, off, s[40:43], s94 offset:192 sc1
  s_mov_b64 exec, -1
  s_add_u32 m0, s65, 0
  s_nop 0
  buffer_load_dwordx4 v243, s[4:7], m0 offen offset:0 sc1 lds
  buffer_load_dwordx4 v243, s[4:7], m0 offen offset:1024 sc1 lds
  s_add_u32 m0, s65, 8192
  s_nop 0
  buffer_load_dwordx4 v243, s[4:7], m0 offen offset:0 sc1 lds
  buffer_load_dwordx4 v243, s[4:7], m0 offen offset:1024 sc1 lds
  s_add_u32 m0, s65, 16384
  s_nop 0
  buffer_load_dwordx4 v243, s[4:7], m0 offen offset:0 sc1 lds
  buffer_load_dwordx4 v243, s[4:7], m0 offen offset:1024 sc1 lds
  s_add_u32 m0, s65, 24576
  s_nop 0
  buffer_load_dwordx4 v243, s[4:7], m0 offen offset:0 sc1 lds
  buffer_load_dwordx4 v243, s[4:7], m0 offen offset:1024 sc1 lds
  s_add_u32 m0, s65, 32768
  s_nop 0
  buffer_load_dwordx4 v243, s[4:7], m0 offen offset:0 sc1 lds
  buffer_load_dwordx4 v243, s[4:7], m0 offen offset:1024 sc1 lds
  s_add_u32 m0, s65, 40960
  s_nop 0
  buffer_load_dwordx4 v243, s[4:7], m0 offen offset:0 sc1 lds
  buffer_load_dwordx4 v243, s[4:7], m0 offen offset:1024 sc1 lds
  s_add_u32 m0, s65, 49152
  s_nop 0
  buffer_load_dwordx4 v243, s[4:7], m0 offen offset:0 sc1 lds
  buffer_load_dwordx4 v243, s[4:7], m0 offen offset:1024 sc1 lds
  s_add_u32 m0, s65, 57344
  s_nop 0
  buffer_load_dwordx4 v243, s[4:7], m0 offen offset:0 sc1 lds
  buffer_load_dwordx4 v243, s[4:7], m0 offen offset:1024 sc1 lds
  s_add_u32 m0, s65, 65536
  s_nop 0
  buffer_load_dwordx4 v243, s[4:7], m0 offen offset:0 sc1 lds
  buffer_load_dwordx4 v243, s[4:7], m0 offen offset:1024 sc1 lds
  s_add_u32 m0, s65, 73728
  s_nop 0
  buffer_load_dwordx4 v243, s[4:7], m0 offen offset:0 sc1 lds
  buffer_load_dwordx4 v243, s[4:7], m0 offen offset:1024 sc1 lds
  s_add_u32 m0, s65, 81920
  s_nop 0
  buffer_load_dwordx4 v243, s[4:7], m0 offen offset:0 sc1 lds
  buffer_load_dwordx4 v243, s[4:7], m0 offen offset:1024 sc1 lds
  v_and_b32 v240, 15, v0
  v_min_u32_e64 v240, 13, v240
  v_lshlrev_b32 v240, 5, v240
  s_lshl_b32 s88, s56, 9
  s_add_u32 s88, s88, 16941056
  s_lshl_b32 s89, s56, 12
  s_add_u32 s89, s89, 17301504
  s_mul_i32 s90, s56, 28672
  s_add_u32 s90, s90, 22020096
  s_and_b32 s86, s64, 0x400
  v_add_u32 v206, s86, v1
  v_xor_b32 v207, 0x400, v206
  v_and_b32_e64 v210, 27, v0
  v_cmp_eq_u32 vcc, 26, v210
  s_nop 1
  v_cndmask_b32 v210, 0, 1.0, vcc
  v_mov_b32_e64 v211, v210
  s_add_u32 s86, s66, 90112
  v_and_b32_e64 v208, 31, v0
  v_lshl_add_u32 v208, v208, 2, s86
  v_lshrrev_b32_e64 v209, 5, v0
  v_lshl_add_u32 v209, v209, 4, s86
  s_add_u32 s86, s68, 0xfffe6000
  v_add_u32 v204, s86, v1
  s_waitcnt vmcnt(0)
  s_nop 4
  s_branch L_p4skipNone_s
Lc_75:
  s_nop 7
  s_nop 3
  v_mul_f32 v176, v160, v249
  v_mul_f32 v177, v161, v249
  v_mul_f32 v178, v162, v249
  v_mul_f32 v179, v163, v249
  v_mul_f32 v180, v164, v249
  v_mul_f32 v181, v165, v249
  v_mul_f32 v182, v166, v249
  v_mul_f32 v183, v167, v249
  v_exp_f32_e64 v176, -v176
  v_exp_f32_e64 v177, -v177
  v_exp_f32_e64 v178, -v178
  v_fma_f32 v176, v176, v250, v250
  v_exp_f32_e64 v179, -v179
  v_fma_f32 v177, v177, v250, v250
  v_exp_f32_e64 v180, -v180
  v_fma_f32 v178, v178, v250, v250
  v_exp_f32_e64 v181, -v181
  v_fma_f32 v179, v179, v250, v250
  v_exp_f32_e64 v182, -v182
  v_fma_f32 v180, v180, v250, v250
  v_exp_f32_e64 v183, -v183
  v_fma_f32 v181, v181, v250, v250
  v_fma_f32 v182, v182, v250, v250
  v_fma_f32 v183, v183, v250, v250
  v_rcp_f32 v176, v176
  v_rcp_f32 v177, v177
  v_rcp_f32 v178, v178
  v_mul_f32 v176, v176, v168
  v_rcp_f32 v179, v179
  v_mul_f32 v177, v177, v169
  v_rcp_f32 v180, v180
  v_mul_f32 v178, v178, v170
  v_rcp_f32 v181, v181
  v_mul_f32 v179, v179, v171
  v_rcp_f32 v182, v182
  v_mul_f32 v180, v180, v172
  v_rcp_f32 v183, v183
  v_mul_f32 v181, v181, v173
  v_mul_f32 v182, v182, v174
  v_mul_f32 v183, v183, v175
  v_cvt_pk_bf16_f32 v184, v176, v177
  v_cvt_pk_bf16_f32 v185, v178, v179
  v_cvt_pk_bf16_f32 v186, v180, v181
  v_cvt_pk_bf16_f32 v187, v182, v183
  buffer_store_dwordx4 v[184:187], v1, s[44:47], s74 offen offset:2048 sc1
  s_waitcnt vmcnt(0)
  v_mov_b32_e64 v254, 1
  s_mov_b64 exec, 1
  buffer_store_dword v254, off, s[40:43], s94 offset:128 sc1
  s_mov_b64 exec, -1
  v_mov_b32_e64 v254, 1
  s_mov_b64 exec, 1
  buffer_store_dword v254, off, s[40:43], s94 offset:192 sc1
  s_mov_b64 exec, -1
Lpoll_77:
  buffer_load_dword v254, v244, s[40:43], 0 offen offset:64 sc1
  s_sub_u32 s54, s54, 1
  s_max_i32 s54, s54, 0
  s_cselect_b64 s[92:93], exec, 0
  s_waitcnt vmcnt(0)
  v_cmp_ne_u32 vcc, 1, v254
  s_nop 0
  s_and_b64 exec, s[92:93], vcc
  s_cbranch_scc1 Lpoll_77
  s_mov_b64 exec, -1
  s_mov_b32 s90, 0
  buffer_load_dwordx4 v[16:19], v245, s[44:47], s90 offen sc1
  buffer_load_dwordx4 v[20:23], v246, s[44:47], s90 offen sc1
  s_mov_b32 s90, 7168
  buffer_load_dwordx4 v[24:27], v245, s[44:47], s90 offen sc1
  buffer_load_dwordx4 v[28:31], v246, s[44:47], s90 offen sc1
  s_mov_b32 s90, 14336
  buffer_load_dwordx4 v[32:35], v245, s[44:47], s90 offen sc1
  buffer_load_dwordx4 v[36:39], v246, s[44:47], s90 offen sc1
  s_mov_b32 s90, 21504
  buffer_load_dwordx4 v[40:43], v245, s[44:47], s90 offen sc1
  buffer_load_dwordx4 v[44:47], v246, s[44:47], s90 offen sc1
  s_mov_b32 s90, 1024
  buffer_load_dwordx4 v[48:51], v245, s[44:47], s90 offen sc1
  buffer_load_dwordx4 v[52:55], v246, s[44:47], s90 offen sc1
  s_mov_b32 s90, 8192
  buffer_load_dwordx4 v[56:59], v245, s[44:47], s90 offen sc1
  buffer_load_dwordx4 v[60:63], v246, s[44:47], s90 offen sc1
  s_mov_b32 s90, 15360
  buffer_load_dwordx4 v[64:67], v245, s[44:47], s90 offen sc1
  buffer_load_dwordx4 v[68:71], v246, s[44:47], s90 offen sc1
  s_waitcnt vmcnt(0)
  s_nop 4
  s_branch Lr_76
Lc_79:
  s_nop 7
  s_nop 3
  s_waitcnt vmcnt(0)
  v_mov_b32_e64 v254, 1
  s_mov_b64 exec, 1
  buffer_store_dword v254, off, s[40:43], s94 offset:128 sc1
  s_mov_b64 exec, -1
  v_mov_b32_e64 v254, 1
  s_mov_b64 exec, 1
  buffer_store_dword v254, off, s[40:43], s94 offset:192 sc1
  s_mov_b64 exec, -1
Lpoll_81:
  buffer_load_dword v254, v244, s[40:43], 0 offen offset:256 sc1
  s_sub_u32 s54, s54, 1
  s_max_i32 s54, s54, 0
  s_cselect_b64 s[92:93], exec, 0
  s_waitcnt vmcnt(0)
  v_cmp_ne_u32 vcc, 1, v254
  s_nop 0
  s_and_b64 exec, s[92:93], vcc
  s_cbranch_scc1 Lpoll_81
  s_mov_b64 exec, -1
  s_nop 4
  s_branch Lr_80
Lc_83:
  s_nop 7
  s_nop 3
  s_waitcnt vmcnt(0)
  v_mov_b32_e64 v254, 1
  s_mov_b64 exec, 1
  buffer_store_dword v254, off, s[40:43], s94 offset:128 sc1
  s_mov_b64 exec, -1
  v_mov_b32_e64 v254, 1
  s_mov_b64 exec, 1
  buffer_store_dword v254, off, s[40:43], s94 offset:192 sc1
  s_mov_b64 exec, -1
Lpoll_85:
  buffer_load_dword v254, v244, s[40:43], 0 offen offset:128 sc1
  s_sub_u32 s54, s54, 1
  s_max_i32 s54, s54, 0
  s_cselect_b64 s[92:93], exec, 0
  s_waitcnt vmcnt(0)
  v_cmp_ne_u32 vcc, 1, v254
  s_nop 0
  s_and_b64 exec, s[92:93], vcc
  s_cbranch_scc1 Lpoll_85
  s_mov_b64 exec, -1
  s_nop 4
  s_branch Lr_84
Lc_87:
  s_nop 7
  s_nop 3
  s_waitcnt vmcnt(0)
  v_mov_b32_e64 v254, 1
  s_mov_b64 exec, 1
  buffer_store_dword v254, off, s[40:43], s94 offset:128 sc1
  s_mov_b64 exec, -1
  v_mov_b32_e64 v254, 1
  s_mov_b64 exec, 1
  buffer_store_dword v254, off, s[40:43], s94 offset:192 sc1
  s_mov_b64 exec, -1
Lpoll_89:
  buffer_load_dword v254, v244, s[40:43], 0 offen offset:192 sc1
  s_sub_u32 s54, s54, 1
  s_max_i32 s54, s54, 0
  s_cselect_b64 s[92:93], exec, 0
  s_waitcnt vmcnt(0)
  v_cmp_ne_u32 vcc, 1, v254
  s_nop 0
  s_and_b64 exec, s[92:93], vcc
  s_cbranch_scc1 Lpoll_89
  s_mov_b64 exec, -1
  s_nop 4
  s_branch Lr_88
.section .rodata,"a"
.p2align 6
.amdhsa_kernel interleave_layers__linear_attn_block__glu_gated_glu__prompt_kernel
  .amdhsa_next_free_vgpr 512
  .amdhsa_next_free_sgpr 102
  .amdhsa_accum_offset 256
  .amdhsa_group_segment_fixed_size 0
  .amdhsa_kernarg_size 80
  .amdhsa_user_sgpr_count 2
  .amdhsa_user_sgpr_kernarg_segment_ptr 1
  .amdhsa_system_sgpr_workgroup_id_x 1
  .amdhsa_float_denorm_mode_32 3
.end_amdhsa_kernel
```
